```python
import torch

def _softmax(x, axis=-1):
    return torch.softmax(x, dim=axis)
def _gelu(x):
    return torch.nn.functional.gelu(x, approximate="tanh")
def _silu(x):
    return torch.nn.functional.silu(x)
def _sigmoid(x):
    return torch.sigmoid(x)
def _layernorm(x, axis=-1, eps=1e-5):
    m = x.mean(dim=axis, keepdim=True)
    v = x.var(dim=axis, keepdim=True, unbiased=False)
    return (x - m) / torch.sqrt(v + eps)
def _scatter_add(tgt, idx, src, axis=0):
    return tgt.clone().index_add_(axis, idx, src)
def _segment_sum(src, seg, n):
    out = torch.zeros((n,) + src.shape[1:], dtype=src.dtype)
    return out.index_add_(0, seg, src)
def _pad(x, pw):
    flat = tuple(v for pair in reversed(pw) for v in pair)
    return torch.nn.functional.pad(x, flat)

kernel_name = 'parallel_sum__ssm_conv_h3__swiglu_ffn__prompt'

def setup_inputs():

    _w = (lambda a: (lambda t: t.to(torch.bfloat16) if t.is_floating_point() else t)(torch.as_tensor(a)))
    def _A_setup():
        B, S, D = 1, 2048, 640
        ks = 4
        return {
            "q": _w((lambda *s: torch.randn(*s, dtype=torch.bfloat16) * 0.05)(B, S, D)),
            "k": _w((lambda *s: torch.randn(*s, dtype=torch.bfloat16) * 0.8)(B, S, D)),
            "v": _w((lambda *s: torch.randn(*s, dtype=torch.bfloat16) * 0.4)(B, S, D)),
            "shift_k": _w((lambda *s: torch.randn(*s, dtype=torch.bfloat16) * 0.8)(D, ks) * 0.5),
            "ssm_k": _w((lambda *s: torch.randn(*s, dtype=torch.bfloat16) * 0.8)(D, S) * (1.0 / S ** 0.5)),
            "ssm_D": _w((lambda *s: torch.randn(*s, dtype=torch.bfloat16) * 0.4)(D)),
        }
    _A_in = _A_setup()

    def _B_setup():
        B, S, D, F = 1, 2048, 640, 1728
        return {
            "x": _w((lambda *s: torch.randn(*s, dtype=torch.bfloat16) * 0.05)(B, S, D)),
            "w_gate": _w((lambda *s: torch.randn(*s, dtype=torch.bfloat16) * 0.05)(D, F)),
            "w_up": _w((lambda *s: torch.randn(*s, dtype=torch.bfloat16) * 0.05)(D, F)),
            "w_down": _w((lambda *s: torch.randn(*s, dtype=torch.bfloat16) * 0.05)(F, D)),
        }
    _B_in = _B_setup()

    return {
        "A_q": _A_in["q"],
        "A_k": _A_in["k"],
        "A_v": _A_in["v"],
        "A_shift_k": _A_in["shift_k"],
        "A_ssm_k": _A_in["ssm_k"],
        "A_ssm_D": _A_in["ssm_D"],
        "B_x": _B_in["x"],
        "B_w_gate": _B_in["w_gate"],
        "B_w_up": _B_in["w_up"],
        "B_w_down": _B_in["w_down"],
    }

def reference(A_q, A_k, A_v, A_shift_k, A_ssm_k, A_ssm_D, B_x, B_w_gate, B_w_up, B_w_down):
    def _A_ref(q, k, v, shift_k, ssm_k, ssm_D):
        B, S, D = q.shape
        ks = shift_k.shape[-1]
        k_pad = _pad(k, ((0, 0), (ks - 1, 0), (0, 0)))
        k_shift = torch.zeros_like(k)
        for t in range(ks):
            k_shift = k_shift + k_pad[:, t:t + S, :] * shift_k[:, ks - 1 - t][None, None, :]
        kv = k_shift * v
        L = 2 * S
        kv_pad = _pad(kv, ((0, 0), (0, S), (0, 0)))
        kf_pad = _pad(ssm_k, ((0, 0), (0, S)))
        kv_f = (lambda x, axes=(-2,-1): torch.fft.rfft2(x.float(), dim=axes))(kv_pad[:, None, :, :], axes=(1, 2))
        kf_f = (lambda x, axes=(-2,-1): torch.fft.rfft2(x.float(), dim=axes))(kf_pad[:, None, :], axes=(1, 2))
        kf_f = (lambda x, *d: x.permute(*d))(kf_f, 1, 2, 0)
        y_f = kv_f * kf_f[None, :, :, :]
        y = (lambda x, s, axes=(-2,-1): torch.fft.irfft2(x, s=s, dim=axes).to(torch.bfloat16))(y_f, (1, L), axes=(1, 2))[:, 0, :S, :]
        y = y + kv * ssm_D[None, None, :]
        return q * y

    def _B_ref(x, w_gate, w_up, w_down):
        g = _silu(x @ w_gate)
        u = x @ w_up
        return (g * u) @ w_down

    x = A_q
    xn = _layernorm(x, axis=-1)
    return x + _A_ref(xn, A_k, A_v, A_shift_k, A_ssm_k, A_ssm_D) + _B_ref(xn, B_w_gate, B_w_up, B_w_down)
```

```asm
; @launch grid=(256,1,1) block=(256,1,1) lds=163840
.amdgcn_target "amdgcn-amd-amdhsa--gfx950"
.text
.globl parallel_sum__ssm_conv_h3__swiglu_ffn__prompt_kernel
.p2align 8
.type parallel_sum__ssm_conv_h3__swiglu_ffn__prompt_kernel,@function
parallel_sum__ssm_conv_h3__swiglu_ffn__prompt_kernel:
    s_cmp_ge_u32 s2, 256
    s_cbranch_scc1 L_end
    s_load_dwordx16 s[4:19], s[0:1], 0
    s_load_dwordx8 s[20:27], s[0:1], 64
    s_load_dwordx2 s[28:29], s[0:1], 96
    s_getpc_b64 s[72:73]
L_pc:
    s_bfe_u32 s31, s2, 0x30003
    s_mul_i32 s31, s31, 5632
    v_lshlrev_b32 v14, 7, v0
    v_lshrrev_b32 v1, 6, v0
    s_mov_b32 s74, L_codeend-L_pc
    s_mov_b32 s75, 0x20000
    v_lshl_add_u32 v14, v1, 28, v14
    v_add_u32 v14, s31, v14
    buffer_load_dword v254, v14, s[72:75], 0 offen
    v_and_b32 v0, 63, v0
    s_and_b32 s31, s2, 7
    v_readfirstlane_b32 s30, v1
    s_lshr_b32 s34, s2, 3
    s_lshl_b32 s68, s31, 2
    s_lshr_b32 s35, s34, 3
    s_add_u32 s68, s68, s35
    s_and_b32 s69, s34, 7
    s_mul_i32 s49, s30, 14
    s_cmp_eq_u32 s30, 3
    s_cselect_b32 s49, 41, s49
    s_mov_b32 s51, 0
    v_lshlrev_b32 v5, 4, v0
    s_lshr_b32 s35, s31, 2
    s_and_b32 s36, s31, 3
    s_cmp_eq_u32 s36, 3
    s_cselect_b32 s37, 8, 4
    s_cmp_lt_u32 s34, s37
    s_cbranch_scc1 L_helper
    s_sub_u32 s34, s34, s37
    s_and_b32 s32, s34, 3
    s_lshr_b32 s33, s34, 2
    s_add_u32 s64, s32, s33
    s_and_b32 s64, s64, 1
    s_mul_i32 s64, s64, 1
    s_mul_i32 s38, s36, 2
    s_add_u32 s64, s64, s38
    s_mul_i32 s38, s35, 5
    s_add_u32 s64, s64, s38
    s_cmp_ge_u32 s64, 10
    s_cselect_b32 s38, 10, 0
    s_sub_u32 s64, s64, s38
    s_mul_i32 s65, s36, 28
    s_add_u32 s65, s65, s34
    s_mul_i32 s66, s35, 108
    s_add_u32 s66, s66, s65
    s_mov_b32 s67, s35
    s_lshl_b32 s35, s35, 2
    s_add_u32 s32, s32, s35
    s_mul_i32 s36, s36, 7
    s_add_u32 s33, s33, s36
    v_lshrrev_b32 v2, 3, v0
    v_and_b32 v3, 7, v0
    v_lshrrev_b32 v4, 4, v0
    v_xor_b32 v6, v3, v4
    v_lshlrev_b32 v6, 4, v6
    v_mul_u32_u24 v7, 1280, v2
    v_add_u32 v220, v7, v6
    v_xor_b32 v6, 64, v6
    v_add_u32 v7, v7, v6
    v_add_u32 v221, 9216, v7
    v_add_u32 v222, 18432, v220
    v_add_u32 v223, 27648, v7
    v_and_b32 v4, 1, v4
    v_lshlrev_b32 v4, 1, v4
    v_xor_b32 v6, v3, v4
    v_mul_u32_u24 v7, 3456, v2
    v_lshl_add_u32 v224, v6, 4, v7
    v_xor_b32 v6, 64, v224
    v_add_u32 v225, 26624, v6
    v_add_u32 v226, 53248, v224
    v_add_u32 v227, 79872, v6
    s_lshl_b32 s31, s32, 2
    s_add_u32 s34, s31, s30
    s_mul_i32 s60, s34, 81920
    s_lshl_b32 s31, s64, 7
    s_add_u32 s60, s60, s31
    s_and_b32 s31, s30, 1
    s_lshl_b32 s31, s31, 5
    s_lshl_b32 s35, s64, 6
    s_add_u32 s31, s31, s35
    s_mul_i32 s61, s31, 3456
    s_lshl_b32 s31, s33, 7
    s_add_u32 s61, s61, s31
    s_lshl_b32 s62, s30, 13
    s_lshl_b32 s63, s30, 12
    s_sub_u32 s64, 9, s64
    s_mov_b32 s37, -40832
    s_mov_b32 s38, 221184
    s_mov_b32 s46, 0x21c000
    s_mov_b32 s47, 0x20000
    s_mov_b32 s42, 0x280000
    s_mov_b32 s43, 0x20000
    s_and_b32 s39, s66, 1
    s_lshl_b32 s39, s39, 2
    s_add_u32 s39, s39, s30
    s_lshr_b32 s31, s66, 1
    s_mul_i32 s77, s31, 5
    s_add_u32 s77, s77, s39
    s_cmp_gt_u32 s39, 3
    s_subb_u32 s77, s77, 0
    s_bitcmp1_b32 0xc8, s39
    s_cselect_b32 s76, 0x40000000, 0
    s_cselect_b32 s77, 0, s77
    v_mul_u32_u24 v9, 1280, v2
    v_lshl_add_u32 v9, v3, 4, v9
    v_add_u32 v242, s76, v9
    v_add_u32 v243, s76, v5
    s_mul_i32 s31, s77, 1214
    s_lshr_b32 s31, s31, 16
    s_mul_i32 s35, s31, 54
    s_sub_u32 s35, s77, s35
    s_mul_i32 s71, s35, 5120
    s_lshl_b32 s77, s31, 2
    s_mul_i32 s35, s35, 40960
    s_lshl_b32 s48, s31, 7
    s_add_u32 s48, s48, s35
    s_mov_b32 s74, 0x21c000
    s_cmp_ge_u32 s30, 2
    s_waitcnt lgkmcnt(0)
    s_cselect_b32 s44, s20, s18
    s_cselect_b32 s45, s21, s19
    s_mov_b32 s40, s4
    s_mov_b32 s41, s5
    s_mov_b32 s72, s22
    s_mov_b32 s73, s23
    s_add_u32 m0, s63, 81920
    s_nop 0
    buffer_load_dwordx4 v224, s[44:47], s61 offen offset:0 lds
    buffer_load_dwordx4 v225, s[44:47], s61 offen offset:1024 lds
    buffer_load_dwordx4 v226, s[44:47], s61 offen offset:2048 lds
    buffer_load_dwordx4 v227, s[44:47], s61 offen offset:3072 lds
    s_add_u32 m0, s62, 49152
    s_nop 0
    buffer_load_dwordx4 v220, s[40:43], s60 offen offset:0 lds
    buffer_load_dwordx4 v221, s[40:43], s60 offen offset:1024 lds
    s_add_u32 s22, s71, 0x700000
    s_lshl_b32 s23, s66, 7
    s_add_u32 s23, s23, 0x1010000
    s_mov_b32 s52, s28
    s_mov_b32 s53, s29
    s_mov_b32 s54, 0x1053000
    s_mov_b32 s55, 0x20000
    s_mov_b32 s56, s26
    s_mov_b32 s57, s27
    s_mov_b32 s58, 0x100
    s_mov_b32 s59, 0x20000
    s_lshl_b32 s70, s66, 1
    s_lshr_b32 s31, s30, 1
    s_add_u32 s70, s70, s31
    s_mul_i32 s71, s31, 21248
    s_add_u32 s71, s71, 98304
    s_mul_i32 s31, s34, 54
    s_lshl_b32 s35, s33, 1
    s_add_u32 s31, s31, s35
    s_lshl_b32 s78, s31, 12
    s_add_u32 s79, s78, 4096
    s_lshl_b32 s31, s34, 5
    s_add_u32 s31, s31, s33
    s_lshl_b32 s31, s31, 7
    s_add_u32 s21, s31, 0x1033000
    s_lshl_b32 s3, s34, 8
    s_add_u32 s3, s3, 0x1000000
    s_and_b32 s8, s30, 1
    s_lshr_b32 s31, s70, 1
    s_lshl_b32 s31, s31, 2
    s_load_dword s50, s[14:15], s31
    s_lshl_b32 s31, s70, 1
    s_add_u32 s31, s31, s8
    s_lshl_b32 s31, s31, 11
    s_add_u32 s6, s31, 0xd00000
    v_accvgpr_write_b32 a236, -1
    v_accvgpr_write_b32 a237, -1
    v_accvgpr_write_b32 a238, -1
    v_accvgpr_write_b32 a239, -1
    s_add_u32 s76, s63, 147456
    s_add_u32 s31, s77, 0
    s_mul_i32 s35, s31, 52
    s_lshr_b32 s35, s35, 8
    s_mul_i32 s35, s35, 271360
    s_lshl_b32 s31, s31, 10
    s_add_u32 s31, s31, s35
    s_add_u32 s4, s31, s22
    s_add_u32 s31, s77, 1
    s_mul_i32 s35, s31, 52
    s_lshr_b32 s35, s35, 8
    s_mul_i32 s35, s35, 271360
    s_lshl_b32 s31, s31, 10
    s_add_u32 s31, s31, s35
    s_add_u32 s5, s31, s22
    s_add_u32 s31, s77, 2
    s_mul_i32 s35, s31, 52
    s_lshr_b32 s35, s35, 8
    s_mul_i32 s35, s35, 271360
    s_lshl_b32 s31, s31, 10
    s_add_u32 s31, s31, s35
    s_add_u32 s9, s31, s22
    s_add_u32 s31, s77, 3
    s_mul_i32 s35, s31, 52
    s_lshr_b32 s35, s35, 8
    s_mul_i32 s35, s35, 271360
    s_lshl_b32 s31, s31, 10
    s_add_u32 s31, s31, s35
    s_add_u32 s10, s31, s22
    s_add_u32 s31, s65, s65
    s_lshr_b32 s35, s65, 1
    s_xor_b32 s31, s31, s35
    s_mul_i32 s39, s33, 37
    s_lshr_b32 s39, s39, 7
    s_xor_b32 s31, s31, s39
    s_and_b32 s31, s31, 2
    s_and_b32 s35, s35, 1
    s_or_b32 s31, s31, s35
    s_lshl_b32 s31, s31, 3
    s_cmp_eq_u32 s67, 0
    s_mov_b32 s35, 0x40a0201
    s_cselect_b32 s35, s35, 0x40a0201
    s_lshr_b32 s7, s35, s31
    s_lshl_b32 s11, s33, 12
    s_lshl_b32 s31, s30, 7
    s_add_u32 s11, s11, s31
    s_add_u32 s11, s11, 0x1018000
    s_lshl_b32 s36, s32, 9
    s_add_u32 s36, s36, s11
    v_and_b32 v1, 15, v0
    v_lshrrev_b32 v2, 4, v0
    v_bfe_u32 v3, v0, 1, 3
    v_xor_b32 v3, v3, v2
    v_lshlrev_b32 v4, 7, v1
    v_add_u32 v4, s62, v4
    v_lshl_add_u32 v200, v3, 4, v4
    v_xor_b32 v201, 64, v200
    v_add_u32 v202, 98304, v200
    v_add_u32 v203, 98304, v201
    v_lshlrev_b32 v204, 10, v2
    v_bfe_u32 v3, v0, 2, 2
    v_lshl_add_u32 v204, v3, 7, v204
    v_bfe_u32 v3, v0, 3, 2
    v_lshl_add_u32 v204, v3, 5, v204
    v_and_b32 v4, 3, v0
    v_lshl_add_u32 v204, v4, 3, v204
    v_add_u32 v204, 32768, v204
    v_xor_b32 v205, 32, v204
    v_xor_b32 v206, 64, v204
    v_xor_b32 v207, 96, v204
    v_add_u32 v208, 98304, v204
    v_add_u32 v209, 98304, v205
    v_add_u32 v210, 98304, v206
    v_add_u32 v211, 98304, v207
    s_lshl_b32 s31, s8, 6
    v_xor_b32 v232, s31, v204
    s_lshr_b32 s31, s30, 1
    s_lshl_b32 s31, s31, 13
    v_add_u32 v232, s31, v232
    v_xor_b32 v233, 32, v232
    v_add_u32 v234, 98304, v232
    v_add_u32 v235, 98304, v233
    v_lshrrev_b32 v6, 2, v0
    v_lshlrev_b32 v12, 7, v6
    v_lshl_add_u32 v12, v4, 3, v12
    v_add_u32 v244, s76, v12
    v_bfe_u32 v4, v0, 3, 1
    v_lshlrev_b32 v8, 6, v4
    v_and_b32 v1, 48, v0
    v_add_u32 v8, v8, v1
    v_and_b32 v1, 7, v0
    v_lshl_add_u32 v245, v1, 25, v8
    v_cmp_eq_u32 vcc, 0, v4
    s_mov_b32 s39, 0x3f803f80
    v_mov_b32 v1, s39
    v_cndmask_b32 v240, 0, v1, vcc
    v_xor_b32 v241, v1, v240
    s_cmp_eq_u32 s30, 1
    s_cbranch_scc1 G_pv1
    s_cmp_ge_u32 s30, 2
    s_cbranch_scc1 G_pv2
    s_mul_i32 s31, s69, 5
    s_lshr_b32 s31, s31, 2
    s_mul_i32 s31, s31, 707832
    s_lshr_b32 s31, s31, 15
    v_min_u32 v195, 43, v0
    v_add_u32 v195, s31, v195
    v_min_u32 v195, 215, v195
    s_branch G_pv3
G_pv1:
    s_and_b32 s31, s65, -4
    v_and_b32 v1, 3, v0
    v_bfe_u32 v3, v0, 2, 1
    v_mul_u32_u24 v3, 108, v3
    v_add3_u32 v195, v3, v1, s31
    s_mul_i32 s31, s67, 44
    s_lshl_b32 s35, s32, 4
    s_add_u32 s31, s31, s35
    s_sub_u32 s31, s31, 8
    v_add_u32 v2, s31, v0
    v_cmp_gt_u32 vcc, 8, v0
    s_nop 1
    v_cndmask_b32 v195, v2, v195, vcc
    s_lshr_b32 s31, s68, 4
    s_mul_i32 s31, s31, 44
    s_lshl_b32 s35, s68, 2
    s_add_u32 s31, s31, s35
    s_sub_u32 s31, s31, 24
    v_min_u32 v2, 27, v0
    v_add_u32 v2, s31, v2
    v_cmp_gt_u32 vcc, 24, v0
    s_nop 1
    v_cndmask_b32 v195, v2, v195, vcc
    s_branch G_pv3
G_pv2:
    s_lshr_b32 s31, s66, 6
    s_add_u32 s31, s31, 216
    v_min_u32 v2, 7, v0
    v_mad_u32_u24 v195, v2, 5, s31
G_pv3:
    v_lshlrev_b32 v195, 7, v195
    v_add_u32 v195, 0x1010000, v195
    buffer_load_dwordx4 v222, s[40:43], s60 offen offset:2048 lds
    buffer_load_dwordx4 v223, s[40:43], s60 offen offset:3072 lds
    v_bfe_u32 v14, v0, 2, 2
    v_mul_u32_u24 v251, 4160, v14
    v_and_b32 v14, 3, v0
    v_lshl_add_u32 v251, v14, 3, v251
    v_and_b32 v15, 48, v0
    v_sub_u32 v251, v251, v15
    s_add_u32 m0, s62, 53248
    s_add_u32 s60, s60, 40960
    buffer_load_dwordx4 v220, s[40:43], s60 offen offset:0 lds
    v_and_b32 v253, 15, v0
    v_lshl_add_u32 v253, v253, 5, v15
    s_lshl_b32 s35, s8, 8
    s_add_u32 s31, s35, s71
    s_add_u32 s31, s31, 56
    v_add_u32 v251, s31, v251
    s_sub_u32 s31, s71, s35
    s_add_u32 s31, s31, 16928
    v_add_u32 v253, s31, v253
    buffer_load_dwordx4 v221, s[40:43], s60 offen offset:1024 lds
    v_accvgpr_write_b32 a232, 0
    v_accvgpr_write_b32 a233, 0
    v_accvgpr_write_b32 a234, 0
    v_accvgpr_write_b32 a235, 0
    v_bfe_u32 v193, v0, 1, 2
    v_mul_u32_u24 v193, 4160, v193
    v_and_b32 v14, 1, v0
    buffer_load_dwordx4 v222, s[40:43], s60 offen offset:2048 lds
    v_lshl_add_u32 v193, v14, 4, v193
    v_add_u32 v14, 16640, v5
    v_cmp_gt_u32 vcc, 32, v0
    s_nop 1
    v_cndmask_b32 v193, v193, v14, vcc
    v_add_u32 v193, s71, v193
    v_lshrrev_b32 v212, 3, v0
    v_and_b32 v215, 7, v0
    v_lshlrev_b32 v215, 4, v215
    v_lshl_add_u32 v212, v212, 9, v215
    s_lshl_b32 s31, s30, 7
    s_add_u32 s31, s31, 159744
    v_add_u32 v215, s31, v215
    v_and_b32 v194, 48, v0
    v_add_u32 v194, 159744, v194
    buffer_load_dwordx4 v223, s[40:43], s60 offen offset:3072 lds
    s_mov_b32 s31, 0
    s_and_b32 s93, s31, 1
    s_mul_i32 s31, s93, 6
    s_add_u32 s31, s31, s49
    s_mul_i32 s89, s69, 54
    s_add_u32 s89, s89, s31
    s_mul_i32 s89, s89, 5120
    s_add_u32 s89, s89, 0x700000
    s_lshl_b32 s31, s70, 12
    s_add_u32 s84, s12, s31
    s_addc_u32 s85, s13, 0
    s_mov_b32 s86, 4096
    s_mov_b32 s87, 0x20000
    s_add_u32 s95, s31, 0xa00000
    s_lshl_b32 s31, s8, 11
    v_add_u32 v11, s31, v5
    s_add_u32 s1, s31, s71
    v_add_u32 v213, -8, v11
    v_cmp_gt_i32 vcc, 0, v213
    v_bfrev_b32 v14, 1
    v_add_u32 v192, s1, v5
    v_cndmask_b32 v213, v213, v14, vcc
    v_min_u32 v250, 6, v0
    s_lshr_b32 s31, s49, 1
    v_add_lshl_u32 v250, v250, s31, 7
    s_cmp_eq_u32 s64, 0
    s_cselect_b32 s18, -1990656, s38
    s_cselect_b32 s19, -42112, s37
    s_lshl_b32 s31, s68, 12
    s_add_u32 s31, s31, 0x1033000
    v_add_u32 v250, s31, v250
    s_mul_i32 s31, s69, 80
    s_mul_i32 s35, s30, 20
    s_add_u32 s31, s31, s35
    s_sub_u32 s31, s31, 32
    v_min_u32 v14, 51, v0
    v_add_u32 v14, s31, v14
    v_lshrrev_b32 v15, 2, v14
    v_add_u32 v15, 88, v15
    s_add_u32 s61, s61, s18
    s_add_u32 s60, s60, s19
    v_cmp_gt_u32 vcc, 512, v14
    v_lshrrev_b32 v14, 1, v14
    s_nop 0
    v_cndmask_b32 v14, v15, v14, vcc
    v_lshlrev_b32 v14, 7, v14
    v_add_u32 v14, 0x1010040, v14
    v_cmp_gt_u32 vcc, 32, v0
    s_nop 1
    v_cndmask_b32 v250, v14, v250, vcc
    s_add_u32 m0, s63, 131072
    s_nop 0
    buffer_load_dwordx4 v224, s[44:47], s61 offen offset:0 lds
    s_lshl_b32 s31, s30, 10
    v_add_u32 v1, s31, v5
    v_xor_b32 v2, 1024, v1
    v_xor_b32 v3, 2048, v1
    v_xor_b32 v4, 3072, v1
    buffer_load_dwordx4 v225, s[44:47], s61 offen offset:1024 lds
    v_add_u32 v14, 0, v0
    v_mul_u32_u24 v15, 205, v14
    v_lshrrev_b32 v15, 11, v15
    v_mul_u32_u24 v6, 1120, v15
    v_lshl_add_u32 v6, v14, 4, v6
    v_add_u32 v14, 64, v0
    v_mul_u32_u24 v15, 205, v14
    v_lshrrev_b32 v15, 11, v15
    buffer_load_dwordx4 v226, s[44:47], s61 offen offset:2048 lds
    v_mul_u32_u24 v7, 1120, v15
    v_lshl_add_u32 v7, v14, 4, v7
    v_add_u32 v14, 128, v0
    v_mul_u32_u24 v15, 205, v14
    v_lshrrev_b32 v15, 11, v15
    v_mul_u32_u24 v8, 1120, v15
    v_lshl_add_u32 v8, v14, 4, v8
    buffer_load_dwordx4 v227, s[44:47], s61 offen offset:3072 lds
    v_lshrrev_b32 v15, 3, v0
    v_lshlrev_b32 v12, 12, v15
    v_and_b32 v15, 7, v0
    v_lshl_add_u32 v12, v15, 4, v12
    v_lshrrev_b32 v14, 5, v0
    v_lshl_add_u32 v8, v14, 30, v8
    v_lshl_add_u32 v13, v14, 30, v12
    v_and_b32 v10, 15, v0
    v_lshlrev_b32 v9, 4, v10
    s_add_u32 m0, s62, 98304
    s_nop 0
    buffer_load_dwordx4 v220, s[40:43], s60 offen offset:0 lds
    s_lshl_b32 s31, s68, 2
    s_add_u32 s31, s31, s30
    s_mul_i32 s94, s31, 20480
    s_lshl_b32 s92, s68, 8
    s_lshl_b32 s31, s30, 2
    s_add_u32 s92, s92, s31
    s_add_u32 s92, s92, 0x1000000
    s_mul_i32 s31, s69, 160
    s_add_u32 s94, s94, s31
    s_mul_i32 s88, s30, 3072
    s_add_u32 s88, s88, 147456
    buffer_load_dwordx4 v221, s[40:43], s60 offen offset:1024 lds
    s_mul_i32 s96, s69, 80
    s_mul_i32 s31, s30, 20
    s_add_u32 s96, s96, s31
    s_lshl_b32 s96, s96, 12
    s_lshl_b32 s31, s68, 7
    s_add_u32 s96, s96, s31
    buffer_load_dwordx4 v222, s[40:43], s60 offen offset:2048 lds
    s_add_u32 s96, s96, 0xd00000
    s_add_u32 s97, s96, 0x8000
    s_add_u32 s0, s96, 0x10000
    s_mul_i32 s31, s68, 54
    s_add_u32 s31, s31, s49
    s_add_u32 s31, s31, 13
    s_lshl_b32 s91, s31, 12
    s_mov_b32 s90, s91
    s_mov_b32 s80, s28
    s_mov_b32 s81, s29
    s_mov_b32 s83, 0x20000
    buffer_load_dwordx4 v223, s[40:43], s60 offen offset:3072 lds
    s_cmp_lt_u32 s30, 2
    s_cselect_b32 s82, 0x1053000, 0
    s_lshl_b32 s31, s67, 8
    s_lshl_b32 s35, s65, 2
    s_add_u32 s31, s31, s35
    s_add_u32 s31, s31, s30
    s_cmp_lt_u32 s65, 64
    s_cselect_b32 s35, 0, 0x40000000
    s_cselect_b32 s31, s31, 0
    s_lshl_b32 s27, s31, 4
    s_add_u32 s27, s27, 0x1000000
    s_lshr_b32 s26, s31, 4
    s_mul_i32 s26, s26, 48
    s_add_u32 s26, s26, s31
    s_mul_i32 s26, s26, 1280
    v_lshrrev_b32 v15, 4, v0
    v_mul_u32_u24 v14, 20480, v15
    v_add3_u32 v14, v14, v9, s35
    v_lshlrev_b32 v197, 25, v10
    v_lshl_add_u32 v197, v15, 2, v197
    v_add_u32 v197, s35, v197
    v_mov_b32 v15, 0
    v_lshlrev_b32 v252, 25, v0
    s_add_u32 m0, s62, 102400
    s_add_u32 s60, s60, 40960
    buffer_load_dwordx4 v220, s[40:43], s60 offen offset:0 lds
    buffer_load_dwordx4 v221, s[40:43], s60 offen offset:1024 lds
    buffer_load_dwordx4 v222, s[40:43], s60 offen offset:2048 lds
    buffer_load_dwordx4 v223, s[40:43], s60 offen offset:3072 lds
    s_cmp_eq_u32 s64, 1
    s_cselect_b32 s18, -1990656, s38
    s_cselect_b32 s19, -42112, s37
    s_add_u32 s61, s61, s18
    s_add_u32 s60, s60, s19
    s_add_u32 m0, s76, 0
    s_add_u32 s35, s48, 0
    buffer_load_dwordx4 v242, s[72:75], s35 offen lds
    s_add_u32 m0, s76, 1024
    s_add_u32 s35, s48, 10240
    buffer_load_dwordx4 v242, s[72:75], s35 offen lds
    s_add_u32 m0, s76, 2048
    s_add_u32 s35, s48, 20480
    buffer_load_dwordx4 v242, s[72:75], s35 offen lds
    s_add_u32 m0, s76, 3072
    s_add_u32 s35, s48, 30720
    buffer_load_dwordx4 v242, s[72:75], s35 offen lds
    buffer_load_dwordx2 v[198:199], v15, s[56:59], 0 offen sc1
    s_waitcnt vmcnt(17) lgkmcnt(0)
    s_barrier
    s_lshl_b32 s31, s30, 25
    v_or_b32 v254, s31, v252
    ds_read_b128 a[192:195], v200 offset:49152
    ds_read_b128 a[196:199], v200 offset:51200
    ds_read_b128 a[200:203], v200 offset:53248
    ds_read_b128 a[204:207], v200 offset:55296
    ds_read_b64_tr_b16 v[144:145], v204 offset:49152
    ds_read_b64_tr_b16 v[146:147], v204 offset:49664
    ds_read_b64_tr_b16 v[148:149], v205 offset:49152
    ds_read_b64_tr_b16 v[150:151], v205 offset:49664
    ds_read_b64_tr_b16 v[152:153], v206 offset:49152
    ds_read_b64_tr_b16 v[154:155], v206 offset:49664
    ds_read_b64_tr_b16 v[156:157], v207 offset:49152
    ds_read_b64_tr_b16 v[158:159], v207 offset:49664
    ds_read_b64_tr_b16 v[160:161], v204 offset:57344
    ds_read_b64_tr_b16 v[162:163], v204 offset:57856
    s_waitcnt lgkmcnt(8)
    ds_read_b64_tr_b16 v[164:165], v205 offset:57344
    ds_read_b64_tr_b16 v[166:167], v205 offset:57856
    ds_read_b64_tr_b16 v[168:169], v206 offset:57344
    ds_read_b64_tr_b16 v[170:171], v206 offset:57856
    ds_read_b64_tr_b16 v[172:173], v207 offset:57344
    ds_read_b64_tr_b16 v[174:175], v207 offset:57856
    s_waitcnt lgkmcnt(12)
    v_mfma_f32_16x16x32_bf16 v[16:19], v[144:147], a[192:195], 0
    s_add_u32 m0, s63, 32768
    s_nop 0
    buffer_load_dwordx4 v224, s[44:47], s61 offen offset:0 lds
    v_mfma_f32_16x16x32_bf16 v[20:23], v[144:147], a[196:199], 0
    ds_read_b128 a[208:211], v201 offset:49152
    v_mfma_f32_16x16x32_bf16 v[24:27], v[144:147], a[200:203], 0
    s_bitcmp1_b32 s7, 0
    s_cselect_b32 s20, -1, 0
    v_mfma_f32_16x16x32_bf16 v[28:31], v[144:147], a[204:207], 0
    ds_read_b64_tr_b16 v[144:145], v204 offset:53248
    ds_read_b64_tr_b16 a[176:177], v232 offset:49152
    v_mfma_f32_16x16x32_bf16 v[32:35], v[148:151], a[192:195], 0
    ds_read_b64_tr_b16 v[146:147], v204 offset:53760
    ds_read_b64_tr_b16 a[178:179], v232 offset:49664
    v_mfma_f32_16x16x32_bf16 v[36:39], v[148:151], a[196:199], 0
    buffer_load_dwordx4 v225, s[44:47], s61 offen offset:1024 lds
    v_and_b32 v216, s20, v240
    v_mfma_f32_16x16x32_bf16 v[40:43], v[148:151], a[200:203], 0
    buffer_load_dwordx4 v226, s[44:47], s61 offen offset:2048 lds
    v_mfma_f32_16x16x32_bf16 v[44:47], v[148:151], a[204:207], 0
    ds_read_b64_tr_b16 v[148:149], v205 offset:53248
    s_waitcnt lgkmcnt(14)
    v_mfma_f32_16x16x32_bf16 v[48:51], v[152:155], a[192:195], 0
    ds_read_b64_tr_b16 v[150:151], v205 offset:53760
    v_and_b32 v217, s20, v240
    v_mfma_f32_16x16x32_bf16 v[52:55], v[152:155], a[196:199], 0
    ds_read_b128 a[212:215], v201 offset:51200
    ds_read_b64_tr_b16 a[180:181], v233 offset:49152
    v_mfma_f32_16x16x32_bf16 v[56:59], v[152:155], a[200:203], 0
    buffer_load_dwordx4 v227, s[44:47], s61 offen offset:3072 lds
    v_and_b32 v218, s20, v240
    v_mfma_f32_16x16x32_bf16 v[60:63], v[152:155], a[204:207], 0
    ds_read_b64_tr_b16 v[152:153], v206 offset:53248
    ds_read_b64_tr_b16 a[182:183], v233 offset:49664
    v_mfma_f32_16x16x32_bf16 v[64:67], v[156:159], a[192:195], 0
    ds_read_b64_tr_b16 v[154:155], v206 offset:53760
    v_and_b32 v219, s20, v240
    v_mfma_f32_16x16x32_bf16 v[68:71], v[156:159], a[196:199], 0
    s_add_u32 m0, s62, 0
    s_nop 0
    buffer_load_dwordx4 v220, s[40:43], s60 offen offset:0 lds
    v_mfma_f32_16x16x32_bf16 v[72:75], v[156:159], a[200:203], 0
    buffer_load_dwordx4 v221, s[40:43], s60 offen offset:1024 lds
    ds_read_b64_tr_b16 a[184:185], v232 offset:53248
    v_mfma_f32_16x16x32_bf16 v[76:79], v[156:159], a[204:207], 0
    ds_read_b64_tr_b16 v[156:157], v207 offset:53248
    s_waitcnt lgkmcnt(15)
    v_mfma_f32_16x16x32_bf16 v[80:83], v[160:163], a[192:195], 0
    ds_read_b64_tr_b16 v[158:159], v207 offset:53760
    v_and_b32 v236, s20, v241
    v_mfma_f32_16x16x32_bf16 v[84:87], v[160:163], a[196:199], 0
    ds_read_b128 a[216:219], v201 offset:53248
    ds_read_b64_tr_b16 a[186:187], v232 offset:53760
    v_mfma_f32_16x16x32_bf16 v[88:91], v[160:163], a[200:203], 0
    buffer_load_dwordx4 v222, s[40:43], s60 offen offset:2048 lds
    v_and_b32 v237, s20, v241
    v_mfma_f32_16x16x32_bf16 v[92:95], v[160:163], a[204:207], 0
    ds_read_b64_tr_b16 v[160:161], v204 offset:61440
    ds_read_b64_tr_b16 a[188:189], v233 offset:53248
    v_mfma_f32_16x16x32_bf16 v[96:99], v[164:167], a[192:195], 0
    ds_read_b64_tr_b16 v[162:163], v204 offset:61952
    ds_read_b64_tr_b16 a[190:191], v233 offset:53760
    v_mfma_f32_16x16x32_bf16 v[100:103], v[164:167], a[196:199], 0
    buffer_load_dwordx4 v223, s[40:43], s60 offen offset:3072 lds
    v_and_b32 v238, s20, v241
    v_mfma_f32_16x16x32_bf16 v[104:107], v[164:167], a[200:203], 0
    s_add_u32 m0, s62, 4096
    s_add_u32 s60, s60, 40960
    buffer_load_dwordx4 v220, s[40:43], s60 offen offset:0 lds
    v_mfma_f32_16x16x32_bf16 v[108:111], v[164:167], a[204:207], 0
    ds_read_b64_tr_b16 v[164:165], v205 offset:61440
    s_waitcnt lgkmcnt(15)
    v_mfma_f32_16x16x32_bf16 v[112:115], v[168:171], a[192:195], 0
    ds_read_b64_tr_b16 v[166:167], v205 offset:61952
    v_and_b32 v239, s20, v241
    v_mfma_f32_16x16x32_bf16 v[116:119], v[168:171], a[196:199], 0
    ds_read_b128 a[220:223], v201 offset:55296
    v_mfma_f32_16x16x32_bf16 v[120:123], v[168:171], a[200:203], 0
    buffer_load_dwordx4 v221, s[40:43], s60 offen offset:1024 lds
    v_mfma_f32_16x16x32_bf16 v[124:127], v[168:171], a[204:207], 0
    ds_read_b64_tr_b16 v[168:169], v206 offset:61440
    v_mfma_f32_16x16x32_bf16 v[128:131], v[172:175], a[192:195], 0
    ds_read_b64_tr_b16 v[170:171], v206 offset:61952
    s_waitcnt lgkmcnt(5)
    v_mfma_f32_16x16x32_bf16 v[228:231], a[176:179], v[216:219], 0
    v_mfma_f32_16x16x32_bf16 v[132:135], v[172:175], a[196:199], 0
    buffer_load_dwordx4 v222, s[40:43], s60 offen offset:2048 lds
    v_mfma_f32_16x16x32_bf16 v[136:139], v[172:175], a[200:203], 0
    v_mfma_f32_16x16x32_bf16 v[140:143], v[172:175], a[204:207], 0
    ds_read_b64_tr_b16 v[172:173], v207 offset:61440
    ds_read_b64_tr_b16 v[174:175], v207 offset:61952
    v_mfma_f32_16x16x32_bf16 v[228:231], a[180:183], v[236:239], v[228:231]
    s_waitcnt lgkmcnt(4)
    v_mfma_f32_16x16x32_bf16 v[16:19], v[144:147], a[208:211], v[16:19]
    buffer_load_dwordx4 v223, s[40:43], s60 offen offset:3072 lds
    v_mfma_f32_16x16x32_bf16 v[20:23], v[144:147], a[212:215], v[20:23]
    v_mfma_f32_16x16x32_bf16 v[24:27], v[144:147], a[216:219], v[24:27]
    s_cmp_eq_u32 s64, 2
    s_cselect_b32 s18, -1990656, s38
    s_cselect_b32 s19, -42112, s37
    v_mfma_f32_16x16x32_bf16 v[228:231], a[184:187], v[216:219], v[228:231]
    v_mfma_f32_16x16x32_bf16 v[28:31], v[144:147], a[220:223], v[28:31]
    v_mfma_f32_16x16x32_bf16 v[32:35], v[148:151], a[208:211], v[32:35]
    v_mfma_f32_16x16x32_bf16 v[36:39], v[148:151], a[212:215], v[36:39]
    s_add_u32 s61, s61, s18
    s_add_u32 s60, s60, s19
    v_mfma_f32_16x16x32_bf16 v[228:231], a[188:191], v[236:239], v[228:231]
    v_mfma_f32_16x16x32_bf16 v[40:43], v[148:151], a[216:219], v[40:43]
    v_mfma_f32_16x16x32_bf16 v[44:47], v[148:151], a[220:223], v[44:47]
    s_waitcnt vmcnt(17) lgkmcnt(0)
    s_barrier
    ds_read_b64_tr_b16 v[144:145], v208 offset:0
    s_waitcnt lgkmcnt(14)
    v_mfma_f32_16x16x32_bf16 v[48:51], v[152:155], a[208:211], v[48:51]
    ds_read_b64_tr_b16 v[146:147], v208 offset:512
    v_mfma_f32_16x16x32_bf16 v[52:55], v[152:155], a[212:215], v[52:55]
    ds_read_b64_tr_b16 v[148:149], v209 offset:0
    v_mfma_f32_16x16x32_bf16 v[56:59], v[152:155], a[216:219], v[56:59]
    ds_read_b64_tr_b16 v[150:151], v209 offset:512
    v_mfma_f32_16x16x32_bf16 v[60:63], v[152:155], a[220:223], v[60:63]
    ds_read_b64_tr_b16 v[152:153], v210 offset:0
    s_add_u32 m0, s63, 81920
    s_nop 0
    buffer_load_dwordx4 v224, s[44:47], s61 offen offset:0 lds
    v_mfma_f32_16x16x32_bf16 v[64:67], v[156:159], a[208:211], v[64:67]
    ds_read_b64_tr_b16 v[154:155], v210 offset:512
    v_mfma_f32_16x16x32_bf16 v[68:71], v[156:159], a[212:215], v[68:71]
    ds_read_b128 a[192:195], v202 offset:0
    v_mfma_f32_16x16x32_bf16 v[72:75], v[156:159], a[216:219], v[72:75]
    buffer_load_dwordx4 v225, s[44:47], s61 offen offset:1024 lds
    v_mfma_f32_16x16x32_bf16 v[76:79], v[156:159], a[220:223], v[76:79]
    ds_read_b64_tr_b16 v[156:157], v211 offset:0
    s_waitcnt lgkmcnt(13)
    v_mfma_f32_16x16x32_bf16 v[80:83], v[160:163], a[208:211], v[80:83]
    ds_read_b64_tr_b16 v[158:159], v211 offset:512
    v_mfma_f32_16x16x32_bf16 v[84:87], v[160:163], a[212:215], v[84:87]
    ds_read_b128 a[196:199], v202 offset:2048
    v_mfma_f32_16x16x32_bf16 v[88:91], v[160:163], a[216:219], v[88:91]
    buffer_load_dwordx4 v226, s[44:47], s61 offen offset:2048 lds
    v_mfma_f32_16x16x32_bf16 v[92:95], v[160:163], a[220:223], v[92:95]
    ds_read_b64_tr_b16 v[160:161], v208 offset:8192
    v_mfma_f32_16x16x32_bf16 v[96:99], v[164:167], a[208:211], v[96:99]
    ds_read_b64_tr_b16 v[162:163], v208 offset:8704
    v_mfma_f32_16x16x32_bf16 v[100:103], v[164:167], a[212:215], v[100:103]
    ds_read_b128 a[200:203], v202 offset:4096
    v_mfma_f32_16x16x32_bf16 v[104:107], v[164:167], a[216:219], v[104:107]
    buffer_load_dwordx4 v227, s[44:47], s61 offen offset:3072 lds
    v_mfma_f32_16x16x32_bf16 v[108:111], v[164:167], a[220:223], v[108:111]
    ds_read_b64_tr_b16 v[164:165], v209 offset:8192
    s_waitcnt lgkmcnt(14)
    v_mfma_f32_16x16x32_bf16 v[112:115], v[168:171], a[208:211], v[112:115]
    ds_read_b64_tr_b16 v[166:167], v209 offset:8704
    v_mfma_f32_16x16x32_bf16 v[116:119], v[168:171], a[212:215], v[116:119]
    ds_read_b128 a[204:207], v202 offset:6144
    v_mfma_f32_16x16x32_bf16 v[120:123], v[168:171], a[216:219], v[120:123]
    v_mfma_f32_16x16x32_bf16 v[124:127], v[168:171], a[220:223], v[124:127]
    ds_read_b64_tr_b16 v[168:169], v210 offset:8192
    v_mfma_f32_16x16x32_bf16 v[128:131], v[172:175], a[208:211], v[128:131]
    ds_read_b64_tr_b16 v[170:171], v210 offset:8704
    v_mfma_f32_16x16x32_bf16 v[132:135], v[172:175], a[212:215], v[132:135]
    s_add_u32 m0, s62, 49152
    s_nop 0
    buffer_load_dwordx4 v220, s[40:43], s60 offen offset:0 lds
    v_mfma_f32_16x16x32_bf16 v[136:139], v[172:175], a[216:219], v[136:139]
    v_mfma_f32_16x16x32_bf16 v[140:143], v[172:175], a[220:223], v[140:143]
    ds_read_b64_tr_b16 v[172:173], v211 offset:8192
    ds_read_b64_tr_b16 v[174:175], v211 offset:8704
    s_waitcnt lgkmcnt(4)
    v_mfma_f32_16x16x32_bf16 v[16:19], v[144:147], a[192:195], v[16:19]
    buffer_load_dwordx4 v221, s[40:43], s60 offen offset:1024 lds
    v_mfma_f32_16x16x32_bf16 v[20:23], v[144:147], a[196:199], v[20:23]
    ds_read_b128 a[208:211], v203 offset:0
    v_mfma_f32_16x16x32_bf16 v[24:27], v[144:147], a[200:203], v[24:27]
    s_bitcmp1_b32 s7, 1
    s_cselect_b32 s20, -1, 0
    v_mfma_f32_16x16x32_bf16 v[28:31], v[144:147], a[204:207], v[28:31]
    ds_read_b64_tr_b16 v[144:145], v208 offset:4096
    ds_read_b64_tr_b16 a[176:177], v234 offset:0
    v_mfma_f32_16x16x32_bf16 v[32:35], v[148:151], a[192:195], v[32:35]
    ds_read_b64_tr_b16 v[146:147], v208 offset:4608
    v_mfma_f32_16x16x32_bf16 v[36:39], v[148:151], a[196:199], v[36:39]
    buffer_load_dwordx4 v222, s[40:43], s60 offen offset:2048 lds
    ds_read_b64_tr_b16 a[178:179], v234 offset:512
    v_mfma_f32_16x16x32_bf16 v[40:43], v[148:151], a[200:203], v[40:43]
    v_and_b32 v216, s20, v240
    s_waitcnt vmcnt(20)
    v_mfma_f32_16x16x32_bf16 v[44:47], v[148:151], a[204:207], v[44:47]
    ds_read_b64_tr_b16 v[148:149], v209 offset:4096
    s_waitcnt lgkmcnt(15)
    v_mfma_f32_16x16x32_bf16 v[48:51], v[152:155], a[192:195], v[48:51]
    ds_read_b64_tr_b16 v[150:151], v209 offset:4608
    v_and_b32 v217, s20, v240
    v_mfma_f32_16x16x32_bf16 v[52:55], v[152:155], a[196:199], v[52:55]
    ds_read_b128 a[212:215], v203 offset:2048
    ds_read_b64_tr_b16 a[180:181], v235 offset:0
    v_mfma_f32_16x16x32_bf16 v[56:59], v[152:155], a[200:203], v[56:59]
    buffer_load_dwordx4 v223, s[40:43], s60 offen offset:3072 lds
    v_and_b32 v218, s20, v240
    v_mfma_f32_16x16x32_bf16 v[60:63], v[152:155], a[204:207], v[60:63]
    ds_read_b64_tr_b16 v[152:153], v210 offset:4096
    ds_read_b64_tr_b16 a[182:183], v235 offset:512
    v_mfma_f32_16x16x32_bf16 v[64:67], v[156:159], a[192:195], v[64:67]
    ds_read_b64_tr_b16 v[154:155], v210 offset:4608
    ds_read_b64_tr_b16 a[240:241], v244 offset:0
    v_mfma_f32_16x16x32_bf16 v[68:71], v[156:159], a[196:199], v[68:71]
    v_and_b32 v219, s20, v240
    ds_read_b64_tr_b16 a[184:185], v234 offset:4096
    ds_read_b64_tr_b16 a[242:243], v244 offset:2048
    v_mfma_f32_16x16x32_bf16 v[72:75], v[156:159], a[200:203], v[72:75]
    s_add_u32 m0, s62, 53248
    s_add_u32 s60, s60, 40960
    buffer_load_dwordx4 v220, s[40:43], s60 offen offset:0 lds
    v_mfma_f32_16x16x32_bf16 v[76:79], v[156:159], a[204:207], v[76:79]
    ds_read_b64_tr_b16 v[156:157], v211 offset:4096
    s_waitcnt lgkmcnt(15)
    v_mfma_f32_16x16x32_bf16 v[80:83], v[160:163], a[192:195], v[80:83]
    ds_read_b64_tr_b16 v[158:159], v211 offset:4608
    v_and_b32 v236, s20, v241
    v_mfma_f32_16x16x32_bf16 v[84:87], v[160:163], a[196:199], v[84:87]
    ds_read_b128 a[216:219], v203 offset:4096
    ds_read_b64_tr_b16 a[186:187], v234 offset:4608
    v_mfma_f32_16x16x32_bf16 v[88:91], v[160:163], a[200:203], v[88:91]
    buffer_load_dwordx4 v221, s[40:43], s60 offen offset:1024 lds
    v_and_b32 v237, s20, v241
    v_mfma_f32_16x16x32_bf16 v[92:95], v[160:163], a[204:207], v[92:95]
    ds_read_b64_tr_b16 v[160:161], v208 offset:12288
    ds_read_b64_tr_b16 a[188:189], v235 offset:4096
    v_mfma_f32_16x16x32_bf16 v[96:99], v[164:167], a[192:195], v[96:99]
    ds_read_b64_tr_b16 v[162:163], v208 offset:12800
    ds_read_b64_tr_b16 a[244:245], v244 offset:32
    v_mfma_f32_16x16x32_bf16 v[100:103], v[164:167], a[196:199], v[100:103]
    v_and_b32 v238, s20, v241
    ds_read_b64_tr_b16 a[190:191], v235 offset:4608
    ds_read_b64_tr_b16 a[246:247], v244 offset:2080
    v_mfma_f32_16x16x32_bf16 v[104:107], v[164:167], a[200:203], v[104:107]
    buffer_load_dwordx4 v222, s[40:43], s60 offen offset:2048 lds
    v_and_b32 v239, s20, v241
    v_mfma_f32_16x16x32_bf16 v[108:111], v[164:167], a[204:207], v[108:111]
    ds_read_b64_tr_b16 v[164:165], v209 offset:12288
    s_waitcnt lgkmcnt(15)
    v_mfma_f32_16x16x32_bf16 v[112:115], v[168:171], a[192:195], v[112:115]
    ds_read_b64_tr_b16 v[166:167], v209 offset:12800
    ds_read_b64_tr_b16 a[248:249], v244 offset:64
    v_mfma_f32_16x16x32_bf16 v[116:119], v[168:171], a[196:199], v[116:119]
    ds_read_b128 a[220:223], v203 offset:6144
    v_mfma_f32_16x16x32_bf16 v[120:123], v[168:171], a[200:203], v[120:123]
    buffer_load_dwordx4 v223, s[40:43], s60 offen offset:3072 lds
    v_mfma_f32_16x16x32_bf16 v[124:127], v[168:171], a[204:207], v[124:127]
    ds_read_b64_tr_b16 v[168:169], v210 offset:12288
    v_mfma_f32_16x16x32_bf16 v[128:131], v[172:175], a[192:195], v[128:131]
    ds_read_b64_tr_b16 v[170:171], v210 offset:12800
    s_waitcnt lgkmcnt(7)
    v_mfma_f32_16x16x32_bf16 v[228:231], a[176:179], v[216:219], v[228:231]
    v_mfma_f32_16x16x32_bf16 v[132:135], v[172:175], a[196:199], v[132:135]
    ds_read_b64_tr_b16 a[250:251], v244 offset:2112
    v_mfma_f32_16x16x32_bf16 v[136:139], v[172:175], a[200:203], v[136:139]
    ds_read_b64_tr_b16 a[252:253], v244 offset:96
    v_mfma_f32_16x16x32_bf16 v[140:143], v[172:175], a[204:207], v[140:143]
    ds_read_b64_tr_b16 v[172:173], v211 offset:12288
    ds_read_b64_tr_b16 v[174:175], v211 offset:12800
    v_mfma_f32_16x16x32_bf16 v[228:231], a[180:183], v[236:239], v[228:231]
    s_waitcnt lgkmcnt(6)
    v_mfma_f32_16x16x32_bf16 v[16:19], v[144:147], a[208:211], v[16:19]
    s_cmp_eq_u32 s64, 3
    s_cselect_b32 s18, -1990656, s38
    s_cselect_b32 s19, -42112, s37
    v_mfma_f32_16x16x32_bf16 v[20:23], v[144:147], a[212:215], v[20:23]
    v_mfma_f32_16x16x32_bf16 v[24:27], v[144:147], a[216:219], v[24:27]
    v_mfma_f32_16x16x32_bf16 v[228:231], a[184:187], v[216:219], v[228:231]
    v_mfma_f32_16x16x32_bf16 v[28:31], v[144:147], a[220:223], v[28:31]
    ds_read_b64_tr_b16 a[254:255], v244 offset:2144
    v_mfma_f32_16x16x32_bf16 v[32:35], v[148:151], a[208:211], v[32:35]
    s_add_u32 s61, s61, s18
    s_add_u32 s60, s60, s19
    v_mfma_f32_16x16x32_bf16 v[36:39], v[148:151], a[212:215], v[36:39]
    v_mfma_f32_16x16x32_bf16 v[228:231], a[188:191], v[236:239], v[228:231]
    buffer_load_dwordx4 v[176:179], v14, s[40:43], s26 offen offset:0
    v_mfma_f32_16x16x32_bf16 v[40:43], v[148:151], a[216:219], v[40:43]
    v_mfma_f32_16x16x32_bf16 v[44:47], v[148:151], a[220:223], v[44:47]
    s_waitcnt vmcnt(13) lgkmcnt(0)
    s_barrier
    ds_read_b64_tr_b16 v[144:145], v204 offset:0
    s_waitcnt lgkmcnt(15)
    v_mfma_f32_16x16x32_bf16 v[48:51], v[152:155], a[208:211], v[48:51]
    ds_read_b64_tr_b16 v[146:147], v204 offset:512
    v_mfma_f32_16x16x32_bf16 v[52:55], v[152:155], a[212:215], v[52:55]
    ds_read_b64_tr_b16 v[148:149], v205 offset:0
    buffer_load_dwordx4 v[180:183], v14, s[40:43], s26 offen offset:256
    v_mfma_f32_16x16x32_bf16 v[56:59], v[152:155], a[216:219], v[56:59]
    ds_read_b64_tr_b16 v[150:151], v205 offset:512
    v_mfma_f32_16x16x32_bf16 v[60:63], v[152:155], a[220:223], v[60:63]
    ds_read_b64_tr_b16 v[152:153], v206 offset:0
    s_add_u32 m0, s63, 131072
    s_nop 0
    buffer_load_dwordx4 v224, s[44:47], s61 offen offset:0 lds
    v_mfma_f32_16x16x32_bf16 v[64:67], v[156:159], a[208:211], v[64:67]
    ds_read_b64_tr_b16 v[154:155], v206 offset:512
    buffer_load_dwordx4 v[184:187], v14, s[40:43], s26 offen offset:512
    v_mfma_f32_16x16x32_bf16 v[68:71], v[156:159], a[212:215], v[68:71]
    ds_read_b128 a[192:195], v200 offset:0
    v_mfma_f32_16x16x32_bf16 v[72:75], v[156:159], a[216:219], v[72:75]
    buffer_load_dwordx4 v225, s[44:47], s61 offen offset:1024 lds
    buffer_load_dwordx4 v[188:191], v14, s[40:43], s26 offen offset:768
    v_mfma_f32_16x16x32_bf16 v[76:79], v[156:159], a[220:223], v[76:79]
    ds_read_b64_tr_b16 v[156:157], v207 offset:0
    s_waitcnt lgkmcnt(15)
    v_mfma_f32_16x16x32_bf16 v[80:83], v[160:163], a[208:211], v[80:83]
    ds_read_b64_tr_b16 v[158:159], v207 offset:512
    v_mfma_f32_16x16x32_bf16 v[84:87], v[160:163], a[212:215], v[84:87]
    ds_read_b128 a[196:199], v200 offset:2048
    v_mfma_f32_16x16x32_bf16 v[88:91], v[160:163], a[216:219], v[88:91]
    buffer_load_dwordx4 v226, s[44:47], s61 offen offset:2048 lds
    v_mfma_f32_16x16x32_bf16 v[92:95], v[160:163], a[220:223], v[92:95]
    ds_read_b64_tr_b16 v[160:161], v204 offset:8192
    buffer_load_dwordx4 a[160:163], v14, s[40:43], s26 offen offset:1024
    v_mfma_f32_16x16x32_bf16 v[96:99], v[164:167], a[208:211], v[96:99]
    ds_read_b64_tr_b16 v[162:163], v204 offset:8704
    v_mfma_f32_16x16x32_bf16 v[100:103], v[164:167], a[212:215], v[100:103]
    ds_read_b128 a[200:203], v200 offset:4096
    v_mfma_f32_16x16x32_bf16 v[104:107], v[164:167], a[216:219], v[104:107]
    buffer_load_dwordx4 v227, s[44:47], s61 offen offset:3072 lds
    v_mfma_f32_16x16x32_bf16 v[108:111], v[164:167], a[220:223], v[108:111]
    ds_read_b64_tr_b16 v[164:165], v205 offset:8192
    s_waitcnt lgkmcnt(15)
    v_mfma_f32_16x16x32_bf16 v[112:115], v[168:171], a[208:211], v[112:115]
    ds_read_b64_tr_b16 v[166:167], v205 offset:8704
    v_mfma_f32_16x16x32_bf16 v[116:119], v[168:171], a[212:215], v[116:119]
    ds_read_b128 a[204:207], v200 offset:6144
    v_mfma_f32_16x16x32_bf16 v[120:123], v[168:171], a[216:219], v[120:123]
    v_mfma_f32_16x16x32_bf16 v[124:127], v[168:171], a[220:223], v[124:127]
    ds_read_b64_tr_b16 v[168:169], v206 offset:8192
    v_mfma_f32_16x16x32_bf16 v[128:131], v[172:175], a[208:211], v[128:131]
    ds_read_b64_tr_b16 v[170:171], v206 offset:8704
    v_mfma_f32_16x16x32_bf16 v[132:135], v[172:175], a[212:215], v[132:135]
    s_add_u32 m0, s62, 98304
    s_nop 0
    buffer_load_dwordx4 v220, s[40:43], s60 offen offset:0 lds
    v_mfma_f32_16x16x32_bf16 v[136:139], v[172:175], a[216:219], v[136:139]
    s_waitcnt lgkmcnt(15)
    buffer_store_dwordx4 a[240:243], v243, s[52:55], s4 offen sc1
    v_mfma_f32_16x16x32_bf16 v[140:143], v[172:175], a[220:223], v[140:143]
    ds_read_b64_tr_b16 v[172:173], v207 offset:8192
    ds_read_b64_tr_b16 v[174:175], v207 offset:8704
    s_waitcnt lgkmcnt(4)
    v_mfma_f32_16x16x32_bf16 v[16:19], v[144:147], a[192:195], v[16:19]
    buffer_load_dwordx4 v221, s[40:43], s60 offen offset:1024 lds
    v_mfma_f32_16x16x32_bf16 v[20:23], v[144:147], a[196:199], v[20:23]
    ds_read_b128 a[208:211], v201 offset:0
    v_mfma_f32_16x16x32_bf16 v[24:27], v[144:147], a[200:203], v[24:27]
    s_bitcmp1_b32 s7, 2
    s_cselect_b32 s20, -1, 0
    v_mfma_f32_16x16x32_bf16 v[28:31], v[144:147], a[204:207], v[28:31]
    ds_read_b64_tr_b16 v[144:145], v204 offset:4096
    ds_read_b64_tr_b16 a[176:177], v232 offset:0
    v_mfma_f32_16x16x32_bf16 v[32:35], v[148:151], a[192:195], v[32:35]
    ds_read_b64_tr_b16 v[146:147], v204 offset:4608
    v_mfma_f32_16x16x32_bf16 v[36:39], v[148:151], a[196:199], v[36:39]
    buffer_load_dwordx4 v222, s[40:43], s60 offen offset:2048 lds
    ds_read_b64_tr_b16 a[178:179], v232 offset:512
    v_mfma_f32_16x16x32_bf16 v[40:43], v[148:151], a[200:203], v[40:43]
    v_and_b32 v216, s20, v240
    v_mfma_f32_16x16x32_bf16 v[44:47], v[148:151], a[204:207], v[44:47]
    ds_read_b64_tr_b16 v[148:149], v205 offset:4096
    s_waitcnt lgkmcnt(15)
    v_mfma_f32_16x16x32_bf16 v[48:51], v[152:155], a[192:195], v[48:51]
    ds_read_b64_tr_b16 v[150:151], v205 offset:4608
    v_and_b32 v217, s20, v240
    v_mfma_f32_16x16x32_bf16 v[52:55], v[152:155], a[196:199], v[52:55]
    ds_read_b128 a[212:215], v201 offset:2048
    ds_read_b64_tr_b16 a[180:181], v233 offset:0
    v_mfma_f32_16x16x32_bf16 v[56:59], v[152:155], a[200:203], v[56:59]
    buffer_load_dwordx4 v223, s[40:43], s60 offen offset:3072 lds
    v_and_b32 v218, s20, v240
    v_mfma_f32_16x16x32_bf16 v[60:63], v[152:155], a[204:207], v[60:63]
    ds_read_b64_tr_b16 v[152:153], v206 offset:4096
    ds_read_b64_tr_b16 a[182:183], v233 offset:512
    v_mfma_f32_16x16x32_bf16 v[64:67], v[156:159], a[192:195], v[64:67]
    ds_read_b64_tr_b16 v[154:155], v206 offset:4608
    v_mfma_f32_16x16x32_bf16 v[68:71], v[156:159], a[196:199], v[68:71]
    v_and_b32 v219, s20, v240
    ds_read_b64_tr_b16 a[184:185], v232 offset:4096
    v_mfma_f32_16x16x32_bf16 v[72:75], v[156:159], a[200:203], v[72:75]
    s_add_u32 m0, s62, 102400
    s_add_u32 s60, s60, 40960
    buffer_load_dwordx4 v220, s[40:43], s60 offen offset:0 lds
    v_mfma_f32_16x16x32_bf16 v[76:79], v[156:159], a[204:207], v[76:79]
    ds_read_b64_tr_b16 v[156:157], v207 offset:4096
    s_waitcnt lgkmcnt(15)
    v_mfma_f32_16x16x32_bf16 v[80:83], v[160:163], a[192:195], v[80:83]
    ds_read_b64_tr_b16 v[158:159], v207 offset:4608
    v_and_b32 v236, s20, v241
    v_mfma_f32_16x16x32_bf16 v[84:87], v[160:163], a[196:199], v[84:87]
    ds_read_b128 a[216:219], v201 offset:4096
    ds_read_b64_tr_b16 a[186:187], v232 offset:4608
    v_mfma_f32_16x16x32_bf16 v[88:91], v[160:163], a[200:203], v[88:91]
    buffer_load_dwordx4 v221, s[40:43], s60 offen offset:1024 lds
    v_and_b32 v237, s20, v241
    v_mfma_f32_16x16x32_bf16 v[92:95], v[160:163], a[204:207], v[92:95]
    ds_read_b64_tr_b16 v[160:161], v204 offset:12288
    ds_read_b64_tr_b16 a[188:189], v233 offset:4096
    v_mfma_f32_16x16x32_bf16 v[96:99], v[164:167], a[192:195], v[96:99]
    ds_read_b64_tr_b16 v[162:163], v204 offset:12800
    v_mfma_f32_16x16x32_bf16 v[100:103], v[164:167], a[196:199], v[100:103]
    v_and_b32 v238, s20, v241
    ds_read_b64_tr_b16 a[190:191], v233 offset:4608
    v_mfma_f32_16x16x32_bf16 v[104:107], v[164:167], a[200:203], v[104:107]
    buffer_load_dwordx4 v222, s[40:43], s60 offen offset:2048 lds
    v_and_b32 v239, s20, v241
    v_mfma_f32_16x16x32_bf16 v[108:111], v[164:167], a[204:207], v[108:111]
    ds_read_b64_tr_b16 v[164:165], v205 offset:12288
    s_waitcnt lgkmcnt(15)
    v_mfma_f32_16x16x32_bf16 v[112:115], v[168:171], a[192:195], v[112:115]
    ds_read_b64_tr_b16 v[166:167], v205 offset:12800
    v_mfma_f32_16x16x32_bf16 v[116:119], v[168:171], a[196:199], v[116:119]
    ds_read_b128 a[220:223], v201 offset:6144
    v_mfma_f32_16x16x32_bf16 v[120:123], v[168:171], a[200:203], v[120:123]
    buffer_load_dwordx4 v223, s[40:43], s60 offen offset:3072 lds
    v_mfma_f32_16x16x32_bf16 v[124:127], v[168:171], a[204:207], v[124:127]
    ds_read_b64_tr_b16 v[168:169], v206 offset:12288
    v_mfma_f32_16x16x32_bf16 v[128:131], v[172:175], a[192:195], v[128:131]
    ds_read_b64_tr_b16 v[170:171], v206 offset:12800
    s_waitcnt lgkmcnt(5)
    v_mfma_f32_16x16x32_bf16 v[228:231], a[176:179], v[216:219], v[228:231]
    v_mfma_f32_16x16x32_bf16 v[132:135], v[172:175], a[196:199], v[132:135]
    v_mfma_f32_16x16x32_bf16 v[136:139], v[172:175], a[200:203], v[136:139]
    buffer_store_dwordx4 a[244:247], v243, s[52:55], s5 offen sc1
    v_mfma_f32_16x16x32_bf16 v[140:143], v[172:175], a[204:207], v[140:143]
    ds_read_b64_tr_b16 v[172:173], v207 offset:12288
    ds_read_b64_tr_b16 v[174:175], v207 offset:12800
    v_mfma_f32_16x16x32_bf16 v[228:231], a[180:183], v[236:239], v[228:231]
    s_waitcnt lgkmcnt(4)
    v_mfma_f32_16x16x32_bf16 v[16:19], v[144:147], a[208:211], v[16:19]
    s_cmp_eq_u32 s64, 4
    s_cselect_b32 s18, -1990656, s38
    s_cselect_b32 s19, -42112, s37
    v_mfma_f32_16x16x32_bf16 v[20:23], v[144:147], a[212:215], v[20:23]
    v_mfma_f32_16x16x32_bf16 v[24:27], v[144:147], a[216:219], v[24:27]
    v_mfma_f32_16x16x32_bf16 v[228:231], a[184:187], v[216:219], v[228:231]
    v_mfma_f32_16x16x32_bf16 v[28:31], v[144:147], a[220:223], v[28:31]
    v_mfma_f32_16x16x32_bf16 v[32:35], v[148:151], a[208:211], v[32:35]
    s_add_u32 s61, s61, s18
    s_add_u32 s60, s60, s19
    v_mfma_f32_16x16x32_bf16 v[36:39], v[148:151], a[212:215], v[36:39]
    v_mfma_f32_16x16x32_bf16 v[228:231], a[188:191], v[236:239], v[228:231]
    v_mfma_f32_16x16x32_bf16 v[40:43], v[148:151], a[216:219], v[40:43]
    v_mfma_f32_16x16x32_bf16 v[44:47], v[148:151], a[220:223], v[44:47]
    s_waitcnt vmcnt(19) lgkmcnt(0)
    s_barrier
    ds_read_b64_tr_b16 v[144:145], v204 offset:49152
    s_waitcnt lgkmcnt(14)
    v_mfma_f32_16x16x32_bf16 v[48:51], v[152:155], a[208:211], v[48:51]
    ds_read_b64_tr_b16 v[146:147], v204 offset:49664
    v_mfma_f32_16x16x32_bf16 v[52:55], v[152:155], a[212:215], v[52:55]
    ds_read_b64_tr_b16 v[148:149], v205 offset:49152
    v_mfma_f32_16x16x32_bf16 v[56:59], v[152:155], a[216:219], v[56:59]
    ds_read_b64_tr_b16 v[150:151], v205 offset:49664
    v_mov_b32 v246, 0
    v_mfma_f32_16x16x32_bf16 v[60:63], v[152:155], a[220:223], v[60:63]
    ds_read_b64_tr_b16 v[152:153], v206 offset:49152
    s_add_u32 m0, s63, 32768
    s_nop 0
    buffer_load_dwordx4 v224, s[44:47], s61 offen offset:0 lds
    v_mfma_f32_16x16x32_bf16 v[64:67], v[156:159], a[208:211], v[64:67]
    ds_read_b64_tr_b16 v[154:155], v206 offset:49664
    v_mfma_f32_16x16x32_bf16 v[68:71], v[156:159], a[212:215], v[68:71]
    ds_read_b128 a[192:195], v200 offset:49152
    v_mov_b32 v247, 0
    v_mfma_f32_16x16x32_bf16 v[72:75], v[156:159], a[216:219], v[72:75]
    buffer_load_dwordx4 v225, s[44:47], s61 offen offset:1024 lds
    v_mfma_f32_16x16x32_bf16 v[76:79], v[156:159], a[220:223], v[76:79]
    ds_read_b64_tr_b16 v[156:157], v207 offset:49152
    s_waitcnt lgkmcnt(13)
    v_mfma_f32_16x16x32_bf16 v[80:83], v[160:163], a[208:211], v[80:83]
    ds_read_b64_tr_b16 v[158:159], v207 offset:49664
    v_mov_b32 v248, 0
    v_mfma_f32_16x16x32_bf16 v[84:87], v[160:163], a[212:215], v[84:87]
    ds_read_b128 a[196:199], v200 offset:51200
    v_mfma_f32_16x16x32_bf16 v[88:91], v[160:163], a[216:219], v[88:91]
    buffer_load_dwordx4 v226, s[44:47], s61 offen offset:2048 lds
    v_mov_b32 v249, 0
    v_mfma_f32_16x16x32_bf16 v[92:95], v[160:163], a[220:223], v[92:95]
    ds_read_b64_tr_b16 v[160:161], v204 offset:57344
    v_mfma_f32_16x16x32_bf16 v[96:99], v[164:167], a[208:211], v[96:99]
    ds_read_b64_tr_b16 v[162:163], v204 offset:57856
    s_waitcnt vmcnt(14)
    v_dot2c_f32_bf16 v246, s39, v176
    v_dot2c_f32_bf16 v248, v176, v176
    v_dot2c_f32_bf16 v247, s39, v177
    v_dot2c_f32_bf16 v249, v177, v177
    v_dot2c_f32_bf16 v246, s39, v178
    v_dot2c_f32_bf16 v248, v178, v178
    v_dot2c_f32_bf16 v247, s39, v179
    v_dot2c_f32_bf16 v249, v179, v179
    v_dot2c_f32_bf16 v246, s39, v180
    v_dot2c_f32_bf16 v248, v180, v180
    v_dot2c_f32_bf16 v247, s39, v181
    v_dot2c_f32_bf16 v249, v181, v181
    v_dot2c_f32_bf16 v246, s39, v182
    v_dot2c_f32_bf16 v248, v182, v182
    v_dot2c_f32_bf16 v247, s39, v183
    v_dot2c_f32_bf16 v249, v183, v183
    v_dot2c_f32_bf16 v246, s39, v184
    v_dot2c_f32_bf16 v248, v184, v184
    v_dot2c_f32_bf16 v247, s39, v185
    v_dot2c_f32_bf16 v249, v185, v185
    v_accvgpr_read_b32 v176, a160
    v_accvgpr_read_b32 v177, a161
    v_accvgpr_read_b32 v178, a162
    v_accvgpr_read_b32 v179, a163
    v_dot2c_f32_bf16 v246, s39, v186
    v_dot2c_f32_bf16 v248, v186, v186
    v_dot2c_f32_bf16 v247, s39, v187
    v_dot2c_f32_bf16 v249, v187, v187
    v_dot2c_f32_bf16 v246, s39, v188
    v_dot2c_f32_bf16 v248, v188, v188
    v_dot2c_f32_bf16 v247, s39, v189
    v_dot2c_f32_bf16 v249, v189, v189
    v_dot2c_f32_bf16 v246, s39, v190
    v_dot2c_f32_bf16 v248, v190, v190
    v_dot2c_f32_bf16 v247, s39, v191
    v_dot2c_f32_bf16 v249, v191, v191
    v_dot2c_f32_bf16 v246, s39, v176
    v_dot2c_f32_bf16 v248, v176, v176
    v_dot2c_f32_bf16 v247, s39, v177
    v_dot2c_f32_bf16 v249, v177, v177
    v_dot2c_f32_bf16 v246, s39, v178
    v_dot2c_f32_bf16 v248, v178, v178
    v_dot2c_f32_bf16 v247, s39, v179
    v_dot2c_f32_bf16 v249, v179, v179
    v_mfma_f32_16x16x32_bf16 v[100:103], v[164:167], a[212:215], v[100:103]
    ds_read_b128 a[200:203], v200 offset:53248
    v_mfma_f32_16x16x32_bf16 v[104:107], v[164:167], a[216:219], v[104:107]
    buffer_load_dwordx4 v227, s[44:47], s61 offen offset:3072 lds
    v_mfma_f32_16x16x32_bf16 v[108:111], v[164:167], a[220:223], v[108:111]
    ds_read_b64_tr_b16 v[164:165], v205 offset:57344
    s_waitcnt lgkmcnt(14)
    v_mfma_f32_16x16x32_bf16 v[112:115], v[168:171], a[208:211], v[112:115]
    ds_read_b64_tr_b16 v[166:167], v205 offset:57856
    v_mfma_f32_16x16x32_bf16 v[116:119], v[168:171], a[212:215], v[116:119]
    ds_read_b128 a[204:207], v200 offset:55296
    v_mfma_f32_16x16x32_bf16 v[120:123], v[168:171], a[216:219], v[120:123]
    v_add_f32 v246, v246, v247
    v_add_f32 v248, v248, v249
    v_mfma_f32_16x16x32_bf16 v[124:127], v[168:171], a[220:223], v[124:127]
    ds_read_b64_tr_b16 v[168:169], v206 offset:57344
    v_mfma_f32_16x16x32_bf16 v[128:131], v[172:175], a[208:211], v[128:131]
    ds_read_b64_tr_b16 v[170:171], v206 offset:57856
    s_nop 0
    v_add_f32_dpp v246, v246, v246 quad_perm:[1,0,3,2] row_mask:0xf bank_mask:0xf
    v_add_f32_dpp v248, v248, v248 quad_perm:[1,0,3,2] row_mask:0xf bank_mask:0xf
    v_mfma_f32_16x16x32_bf16 v[132:135], v[172:175], a[212:215], v[132:135]
    s_add_u32 m0, s62, 0
    s_nop 0
    buffer_load_dwordx4 v220, s[40:43], s60 offen offset:0 lds
    v_mfma_f32_16x16x32_bf16 v[136:139], v[172:175], a[216:219], v[136:139]
    buffer_store_dwordx4 a[248:251], v243, s[52:55], s9 offen sc1
    s_nop 0
    v_add_f32_dpp v246, v246, v246 quad_perm:[2,3,0,1] row_mask:0xf bank_mask:0xf
    v_add_f32_dpp v248, v248, v248 quad_perm:[2,3,0,1] row_mask:0xf bank_mask:0xf
    v_mfma_f32_16x16x32_bf16 v[140:143], v[172:175], a[220:223], v[140:143]
    ds_read_b64_tr_b16 v[172:173], v207 offset:57344
    ds_read_b64_tr_b16 v[174:175], v207 offset:57856
    s_waitcnt lgkmcnt(4)
    v_mfma_f32_16x16x32_bf16 v[16:19], v[144:147], a[192:195], v[16:19]
    buffer_load_dwordx4 v221, s[40:43], s60 offen offset:1024 lds
    v_mfma_f32_16x16x32_bf16 v[20:23], v[144:147], a[196:199], v[20:23]
    ds_read_b128 a[208:211], v201 offset:49152
    s_nop 0
    v_add_f32_dpp v246, v246, v246 row_half_mirror row_mask:0xf bank_mask:0xf
    v_add_f32_dpp v248, v248, v248 row_half_mirror row_mask:0xf bank_mask:0xf
    v_mfma_f32_16x16x32_bf16 v[24:27], v[144:147], a[200:203], v[24:27]
    s_bitcmp1_b32 s7, 3
    s_cselect_b32 s20, -1, 0
    v_mfma_f32_16x16x32_bf16 v[28:31], v[144:147], a[204:207], v[28:31]
    ds_read_b64_tr_b16 v[144:145], v204 offset:53248
    ds_read_b64_tr_b16 a[176:177], v232 offset:49152
    v_mfma_f32_16x16x32_bf16 v[32:35], v[148:151], a[192:195], v[32:35]
    ds_read_b64_tr_b16 v[146:147], v204 offset:53760
    s_nop 0
    v_add_f32_dpp v246, v246, v246 row_mirror row_mask:0xf bank_mask:0xf
    v_add_f32_dpp v248, v248, v248 row_mirror row_mask:0xf bank_mask:0xf
    v_mfma_f32_16x16x32_bf16 v[36:39], v[148:151], a[196:199], v[36:39]
    buffer_load_dwordx4 v222, s[40:43], s60 offen offset:2048 lds
    ds_read_b64_tr_b16 a[178:179], v232 offset:49664
    v_mfma_f32_16x16x32_bf16 v[40:43], v[148:151], a[200:203], v[40:43]
    v_and_b32 v216, s20, v240
    v_mul_f32 v246, 0x3acccccd, v246
    v_mul_f32 v248, 0x3acccccd, v248
    v_mfma_f32_16x16x32_bf16 v[44:47], v[148:151], a[204:207], v[44:47]
    ds_read_b64_tr_b16 v[148:149], v205 offset:53248
    s_waitcnt lgkmcnt(15)
    v_mfma_f32_16x16x32_bf16 v[48:51], v[152:155], a[192:195], v[48:51]
    ds_read_b64_tr_b16 v[150:151], v205 offset:53760
    v_and_b32 v217, s20, v240
    v_mfma_f32_16x16x32_bf16 v[52:55], v[152:155], a[196:199], v[52:55]
    ds_read_b128 a[212:215], v201 offset:51200
    ds_read_b64_tr_b16 a[180:181], v233 offset:49152
    v_mfma_f32_16x16x32_bf16 v[56:59], v[152:155], a[200:203], v[56:59]
    buffer_load_dwordx4 v223, s[40:43], s60 offen offset:3072 lds
    v_and_b32 v218, s20, v240
    v_mfma_f32_16x16x32_bf16 v[60:63], v[152:155], a[204:207], v[60:63]
    ds_read_b64_tr_b16 v[152:153], v206 offset:53248
    ds_read_b64_tr_b16 a[182:183], v233 offset:49664
    v_mfma_f32_16x16x32_bf16 v[64:67], v[156:159], a[192:195], v[64:67]
    ds_read_b64_tr_b16 v[154:155], v206 offset:53760
    v_fma_f32 v248, -v246, v246, v248
    v_max_f32 v248, 0, v248
    v_mfma_f32_16x16x32_bf16 v[68:71], v[156:159], a[196:199], v[68:71]
    v_and_b32 v219, s20, v240
    ds_read_b64_tr_b16 a[184:185], v232 offset:53248
    v_mfma_f32_16x16x32_bf16 v[72:75], v[156:159], a[200:203], v[72:75]
    s_add_u32 m0, s62, 4096
    s_add_u32 s60, s60, 40960
    buffer_load_dwordx4 v220, s[40:43], s60 offen offset:0 lds
    v_mfma_f32_16x16x32_bf16 v[76:79], v[156:159], a[204:207], v[76:79]
    ds_read_b64_tr_b16 v[156:157], v207 offset:53248
    v_cvt_pk_bf16_f32 v248, v248, v248
    v_lshlrev_b32 v248, 16, v248
    s_waitcnt lgkmcnt(15)
    v_mfma_f32_16x16x32_bf16 v[80:83], v[160:163], a[192:195], v[80:83]
    ds_read_b64_tr_b16 v[158:159], v207 offset:53760
    v_and_b32 v236, s20, v241
    v_mfma_f32_16x16x32_bf16 v[84:87], v[160:163], a[196:199], v[84:87]
    ds_read_b128 a[216:219], v201 offset:53248
    ds_read_b64_tr_b16 a[186:187], v232 offset:53760
    v_mfma_f32_16x16x32_bf16 v[88:91], v[160:163], a[200:203], v[88:91]
    buffer_load_dwordx4 v221, s[40:43], s60 offen offset:1024 lds
    v_and_b32 v237, s20, v241
    v_mfma_f32_16x16x32_bf16 v[92:95], v[160:163], a[204:207], v[92:95]
    ds_read_b64_tr_b16 v[160:161], v204 offset:61440
    ds_read_b64_tr_b16 a[188:189], v233 offset:53248
    v_mfma_f32_16x16x32_bf16 v[96:99], v[164:167], a[192:195], v[96:99]
    ds_read_b64_tr_b16 v[162:163], v204 offset:61952
    v_add_f32 v248, 0x3727c5ac, v248
    v_cvt_pk_bf16_f32 v248, v248, v248
    v_mfma_f32_16x16x32_bf16 v[100:103], v[164:167], a[196:199], v[100:103]
    v_and_b32 v238, s20, v241
    ds_read_b64_tr_b16 a[190:191], v233 offset:53760
    v_lshlrev_b32 v248, 16, v248
    v_sqrt_f32 v248, v248
    v_mfma_f32_16x16x32_bf16 v[104:107], v[164:167], a[200:203], v[104:107]
    buffer_load_dwordx4 v222, s[40:43], s60 offen offset:2048 lds
    v_and_b32 v239, s20, v241
    v_mfma_f32_16x16x32_bf16 v[108:111], v[164:167], a[204:207], v[108:111]
    ds_read_b64_tr_b16 v[164:165], v205 offset:61440
    s_waitcnt lgkmcnt(15)
    v_mfma_f32_16x16x32_bf16 v[112:115], v[168:171], a[192:195], v[112:115]
    ds_read_b64_tr_b16 v[166:167], v205 offset:61952
    s_nop 0
    v_cvt_pk_bf16_f32 v246, v246, v248
    v_mfma_f32_16x16x32_bf16 v[116:119], v[168:171], a[196:199], v[116:119]
    ds_read_b128 a[220:223], v201 offset:55296
    v_mfma_f32_16x16x32_bf16 v[120:123], v[168:171], a[200:203], v[120:123]
    buffer_load_dwordx4 v223, s[40:43], s60 offen offset:3072 lds
    v_mfma_f32_16x16x32_bf16 v[124:127], v[168:171], a[204:207], v[124:127]
    ds_read_b64_tr_b16 v[168:169], v206 offset:61440
    buffer_store_dword v246, v197, s[52:55], s27 offen sc1
    v_mfma_f32_16x16x32_bf16 v[128:131], v[172:175], a[192:195], v[128:131]
    ds_read_b64_tr_b16 v[170:171], v206 offset:61952
    s_waitcnt lgkmcnt(5)
    v_mfma_f32_16x16x32_bf16 v[228:231], a[176:179], v[216:219], v[228:231]
    v_mfma_f32_16x16x32_bf16 v[132:135], v[172:175], a[196:199], v[132:135]
    v_mfma_f32_16x16x32_bf16 v[136:139], v[172:175], a[200:203], v[136:139]
    v_mfma_f32_16x16x32_bf16 v[140:143], v[172:175], a[204:207], v[140:143]
    ds_read_b64_tr_b16 v[172:173], v207 offset:61440
    ds_read_b64_tr_b16 v[174:175], v207 offset:61952
    v_mfma_f32_16x16x32_bf16 v[228:231], a[180:183], v[236:239], v[228:231]
    s_waitcnt lgkmcnt(4)
    v_mfma_f32_16x16x32_bf16 v[16:19], v[144:147], a[208:211], v[16:19]
    s_cmp_eq_u32 s64, 5
    s_cselect_b32 s18, -1990656, s38
    s_cselect_b32 s19, -42112, s37
    v_mfma_f32_16x16x32_bf16 v[20:23], v[144:147], a[212:215], v[20:23]
    buffer_store_dwordx4 a[252:255], v243, s[52:55], s10 offen sc1
    v_mfma_f32_16x16x32_bf16 v[24:27], v[144:147], a[216:219], v[24:27]
    v_mfma_f32_16x16x32_bf16 v[228:231], a[184:187], v[216:219], v[228:231]
    v_mfma_f32_16x16x32_bf16 v[28:31], v[144:147], a[220:223], v[28:31]
    v_mfma_f32_16x16x32_bf16 v[32:35], v[148:151], a[208:211], v[32:35]
    s_add_u32 s61, s61, s18
    s_add_u32 s60, s60, s19
    v_mfma_f32_16x16x32_bf16 v[36:39], v[148:151], a[212:215], v[36:39]
    v_mfma_f32_16x16x32_bf16 v[228:231], a[188:191], v[236:239], v[228:231]
    v_mfma_f32_16x16x32_bf16 v[40:43], v[148:151], a[216:219], v[40:43]
    v_mfma_f32_16x16x32_bf16 v[44:47], v[148:151], a[220:223], v[44:47]
    s_waitcnt vmcnt(16) lgkmcnt(0)
    s_barrier
    ds_read_b64_tr_b16 v[144:145], v208 offset:0
    s_waitcnt lgkmcnt(14)
    v_mfma_f32_16x16x32_bf16 v[48:51], v[152:155], a[208:211], v[48:51]
    ds_read_b64_tr_b16 v[146:147], v208 offset:512
    v_mfma_f32_16x16x32_bf16 v[52:55], v[152:155], a[212:215], v[52:55]
    ds_read_b64_tr_b16 v[148:149], v209 offset:0
    v_mfma_f32_16x16x32_bf16 v[56:59], v[152:155], a[216:219], v[56:59]
    ds_read_b64_tr_b16 v[150:151], v209 offset:512
    v_mfma_f32_16x16x32_bf16 v[60:63], v[152:155], a[220:223], v[60:63]
    ds_read_b64_tr_b16 v[152:153], v210 offset:0
    s_add_u32 m0, s63, 81920
    s_nop 0
    buffer_load_dwordx4 v224, s[44:47], s61 offen offset:0 lds
    v_mfma_f32_16x16x32_bf16 v[64:67], v[156:159], a[208:211], v[64:67]
    ds_read_b64_tr_b16 v[154:155], v210 offset:512
    v_mfma_f32_16x16x32_bf16 v[68:71], v[156:159], a[212:215], v[68:71]
    ds_read_b128 a[192:195], v202 offset:0
    v_mfma_f32_16x16x32_bf16 v[72:75], v[156:159], a[216:219], v[72:75]
    buffer_load_dwordx4 v225, s[44:47], s61 offen offset:1024 lds
    v_mfma_f32_16x16x32_bf16 v[76:79], v[156:159], a[220:223], v[76:79]
    ds_read_b64_tr_b16 v[156:157], v211 offset:0
    buffer_store_dwordx4 v[228:231], v245, s[52:55], s36 offen sc1
    s_waitcnt lgkmcnt(13)
    v_mfma_f32_16x16x32_bf16 v[80:83], v[160:163], a[208:211], v[80:83]
    ds_read_b64_tr_b16 v[158:159], v211 offset:512
    v_mfma_f32_16x16x32_bf16 v[84:87], v[160:163], a[212:215], v[84:87]
    ds_read_b128 a[196:199], v202 offset:2048
    v_mfma_f32_16x16x32_bf16 v[88:91], v[160:163], a[216:219], v[88:91]
    buffer_load_dwordx4 v226, s[44:47], s61 offen offset:2048 lds
    v_mfma_f32_16x16x32_bf16 v[92:95], v[160:163], a[220:223], v[92:95]
    ds_read_b64_tr_b16 v[160:161], v208 offset:8192
    v_mfma_f32_16x16x32_bf16 v[96:99], v[164:167], a[208:211], v[96:99]
    ds_read_b64_tr_b16 v[162:163], v208 offset:8704
    v_mfma_f32_16x16x32_bf16 v[100:103], v[164:167], a[212:215], v[100:103]
    ds_read_b128 a[200:203], v202 offset:4096
    v_mfma_f32_16x16x32_bf16 v[104:107], v[164:167], a[216:219], v[104:107]
    buffer_load_dwordx4 v227, s[44:47], s61 offen offset:3072 lds
    v_mfma_f32_16x16x32_bf16 v[108:111], v[164:167], a[220:223], v[108:111]
    ds_read_b64_tr_b16 v[164:165], v209 offset:8192
    s_waitcnt lgkmcnt(14)
    v_mfma_f32_16x16x32_bf16 v[112:115], v[168:171], a[208:211], v[112:115]
    ds_read_b64_tr_b16 v[166:167], v209 offset:8704
    v_mfma_f32_16x16x32_bf16 v[116:119], v[168:171], a[212:215], v[116:119]
    ds_read_b128 a[204:207], v202 offset:6144
    v_mfma_f32_16x16x32_bf16 v[120:123], v[168:171], a[216:219], v[120:123]
    v_mfma_f32_16x16x32_bf16 v[124:127], v[168:171], a[220:223], v[124:127]
    ds_read_b64_tr_b16 v[168:169], v210 offset:8192
    v_mfma_f32_16x16x32_bf16 v[128:131], v[172:175], a[208:211], v[128:131]
    ds_read_b64_tr_b16 v[170:171], v210 offset:8704
    v_mfma_f32_16x16x32_bf16 v[132:135], v[172:175], a[212:215], v[132:135]
    s_add_u32 m0, s62, 49152
    s_nop 0
    buffer_load_dwordx4 v220, s[40:43], s60 offen offset:0 lds
    v_mfma_f32_16x16x32_bf16 v[136:139], v[172:175], a[216:219], v[136:139]
    v_mfma_f32_16x16x32_bf16 v[140:143], v[172:175], a[220:223], v[140:143]
    ds_read_b64_tr_b16 v[172:173], v211 offset:8192
    ds_read_b64_tr_b16 v[174:175], v211 offset:8704
    s_waitcnt lgkmcnt(4)
    v_mfma_f32_16x16x32_bf16 v[16:19], v[144:147], a[192:195], v[16:19]
    buffer_load_dwordx4 v221, s[40:43], s60 offen offset:1024 lds
    v_mfma_f32_16x16x32_bf16 v[20:23], v[144:147], a[196:199], v[20:23]
    ds_read_b128 a[208:211], v203 offset:0
    v_mfma_f32_16x16x32_bf16 v[24:27], v[144:147], a[200:203], v[24:27]
    v_mfma_f32_16x16x32_bf16 v[28:31], v[144:147], a[204:207], v[28:31]
    ds_read_b64_tr_b16 v[144:145], v208 offset:4096
    v_mfma_f32_16x16x32_bf16 v[32:35], v[148:151], a[192:195], v[32:35]
    ds_read_b64_tr_b16 v[146:147], v208 offset:4608
    v_mfma_f32_16x16x32_bf16 v[36:39], v[148:151], a[196:199], v[36:39]
    buffer_load_dwordx4 v222, s[40:43], s60 offen offset:2048 lds
    v_mfma_f32_16x16x32_bf16 v[40:43], v[148:151], a[200:203], v[40:43]
    v_mfma_f32_16x16x32_bf16 v[44:47], v[148:151], a[204:207], v[44:47]
    ds_read_b64_tr_b16 v[148:149], v209 offset:4096
    s_waitcnt lgkmcnt(15)
    v_mfma_f32_16x16x32_bf16 v[48:51], v[152:155], a[192:195], v[48:51]
    ds_read_b64_tr_b16 v[150:151], v209 offset:4608
    v_mfma_f32_16x16x32_bf16 v[52:55], v[152:155], a[196:199], v[52:55]
    ds_read_b128 a[212:215], v203 offset:2048
    v_mfma_f32_16x16x32_bf16 v[56:59], v[152:155], a[200:203], v[56:59]
    buffer_load_dwordx4 v223, s[40:43], s60 offen offset:3072 lds
    v_mfma_f32_16x16x32_bf16 v[60:63], v[152:155], a[204:207], v[60:63]
    ds_read_b64_tr_b16 v[152:153], v210 offset:4096
    v_mfma_f32_16x16x32_bf16 v[64:67], v[156:159], a[192:195], v[64:67]
    ds_read_b64_tr_b16 v[154:155], v210 offset:4608
    v_mfma_f32_16x16x32_bf16 v[68:71], v[156:159], a[196:199], v[68:71]
    v_mfma_f32_16x16x32_bf16 v[72:75], v[156:159], a[200:203], v[72:75]
    s_add_u32 m0, s62, 53248
    s_add_u32 s60, s60, 40960
    buffer_load_dwordx4 v220, s[40:43], s60 offen offset:0 lds
    v_mfma_f32_16x16x32_bf16 v[76:79], v[156:159], a[204:207], v[76:79]
    ds_read_b64_tr_b16 v[156:157], v211 offset:4096
    s_waitcnt lgkmcnt(14)
    v_mfma_f32_16x16x32_bf16 v[80:83], v[160:163], a[192:195], v[80:83]
    ds_read_b64_tr_b16 v[158:159], v211 offset:4608
    v_mfma_f32_16x16x32_bf16 v[84:87], v[160:163], a[196:199], v[84:87]
    ds_read_b128 a[216:219], v203 offset:4096
    v_mfma_f32_16x16x32_bf16 v[88:91], v[160:163], a[200:203], v[88:91]
    buffer_load_dwordx4 v221, s[40:43], s60 offen offset:1024 lds
    v_mfma_f32_16x16x32_bf16 v[92:95], v[160:163], a[204:207], v[92:95]
    ds_read_b64_tr_b16 v[160:161], v208 offset:12288
    v_mfma_f32_16x16x32_bf16 v[96:99], v[164:167], a[192:195], v[96:99]
    ds_read_b64_tr_b16 v[162:163], v208 offset:12800
    v_mfma_f32_16x16x32_bf16 v[100:103], v[164:167], a[196:199], v[100:103]
    v_mfma_f32_16x16x32_bf16 v[104:107], v[164:167], a[200:203], v[104:107]
    buffer_load_dwordx4 v222, s[40:43], s60 offen offset:2048 lds
    v_mfma_f32_16x16x32_bf16 v[108:111], v[164:167], a[204:207], v[108:111]
    ds_read_b64_tr_b16 v[164:165], v209 offset:12288
    s_waitcnt lgkmcnt(14)
    v_mfma_f32_16x16x32_bf16 v[112:115], v[168:171], a[192:195], v[112:115]
    ds_read_b64_tr_b16 v[166:167], v209 offset:12800
    v_mfma_f32_16x16x32_bf16 v[116:119], v[168:171], a[196:199], v[116:119]
    ds_read_b128 a[220:223], v203 offset:6144
    v_mfma_f32_16x16x32_bf16 v[120:123], v[168:171], a[200:203], v[120:123]
    buffer_load_dwordx4 v223, s[40:43], s60 offen offset:3072 lds
    v_mfma_f32_16x16x32_bf16 v[124:127], v[168:171], a[204:207], v[124:127]
    ds_read_b64_tr_b16 v[168:169], v210 offset:12288
    v_mfma_f32_16x16x32_bf16 v[128:131], v[172:175], a[192:195], v[128:131]
    ds_read_b64_tr_b16 v[170:171], v210 offset:12800
    v_mfma_f32_16x16x32_bf16 v[132:135], v[172:175], a[196:199], v[132:135]
    v_mfma_f32_16x16x32_bf16 v[136:139], v[172:175], a[200:203], v[136:139]
    v_mfma_f32_16x16x32_bf16 v[140:143], v[172:175], a[204:207], v[140:143]
    ds_read_b64_tr_b16 v[172:173], v211 offset:12288
    ds_read_b64_tr_b16 v[174:175], v211 offset:12800
    s_waitcnt lgkmcnt(4)
    v_mfma_f32_16x16x32_bf16 v[16:19], v[144:147], a[208:211], v[16:19]
    s_cmp_eq_u32 s64, 6
    s_cselect_b32 s18, -1990656, s38
    s_cselect_b32 s19, -42112, s37
    v_mfma_f32_16x16x32_bf16 v[20:23], v[144:147], a[212:215], v[20:23]
    v_mfma_f32_16x16x32_bf16 v[24:27], v[144:147], a[216:219], v[24:27]
    v_mfma_f32_16x16x32_bf16 v[28:31], v[144:147], a[220:223], v[28:31]
    v_mfma_f32_16x16x32_bf16 v[32:35], v[148:151], a[208:211], v[32:35]
    s_add_u32 s61, s61, s18
    s_add_u32 s60, s60, s19
    v_mfma_f32_16x16x32_bf16 v[36:39], v[148:151], a[212:215], v[36:39]
    v_mfma_f32_16x16x32_bf16 v[40:43], v[148:151], a[216:219], v[40:43]
    v_mfma_f32_16x16x32_bf16 v[44:47], v[148:151], a[220:223], v[44:47]
    s_waitcnt vmcnt(10) lgkmcnt(0)
    s_barrier
    ds_read_b64_tr_b16 v[144:145], v204 offset:0
    s_waitcnt lgkmcnt(11)
    v_mfma_f32_16x16x32_bf16 v[48:51], v[152:155], a[208:211], v[48:51]
    ds_read_b64_tr_b16 v[146:147], v204 offset:512
    v_mfma_f32_16x16x32_bf16 v[52:55], v[152:155], a[212:215], v[52:55]
    ds_read_b64_tr_b16 v[148:149], v205 offset:0
    v_mfma_f32_16x16x32_bf16 v[56:59], v[152:155], a[216:219], v[56:59]
    ds_read_b64_tr_b16 v[150:151], v205 offset:512
    s_add_u32 m0, s63, 131072
    s_nop 0
    buffer_load_dwordx4 v224, s[44:47], s61 offen offset:0 lds
    v_mfma_f32_16x16x32_bf16 v[60:63], v[152:155], a[220:223], v[60:63]
    ds_read_b64_tr_b16 v[152:153], v206 offset:0
    v_mfma_f32_16x16x32_bf16 v[64:67], v[156:159], a[208:211], v[64:67]
    ds_read_b64_tr_b16 v[154:155], v206 offset:512
nc_g:
    v_readfirstlane_b32 s16, v198
    v_readfirstlane_b32 s17, v199
    s_nop 0
    s_cmp_eq_u32 s16, 0
    s_cbranch_scc1 nr_g
nk_g:
    buffer_store_dwordx2 v[198:199], v254, s[52:55], s23 offen sc1
    v_mfma_f32_16x16x32_bf16 v[68:71], v[156:159], a[212:215], v[68:71]
    ds_read_b128 a[192:195], v200 offset:0
    v_mfma_f32_16x16x32_bf16 v[72:75], v[156:159], a[216:219], v[72:75]
    buffer_load_dwordx4 v225, s[44:47], s61 offen offset:1024 lds
    v_mfma_f32_16x16x32_bf16 v[76:79], v[156:159], a[220:223], v[76:79]
    ds_read_b64_tr_b16 v[156:157], v207 offset:0
    s_waitcnt lgkmcnt(13)
    v_mfma_f32_16x16x32_bf16 v[80:83], v[160:163], a[208:211], v[80:83]
    ds_read_b64_tr_b16 v[158:159], v207 offset:512
    v_mfma_f32_16x16x32_bf16 v[84:87], v[160:163], a[212:215], v[84:87]
    ds_read_b128 a[196:199], v200 offset:2048
    v_mfma_f32_16x16x32_bf16 v[88:91], v[160:163], a[216:219], v[88:91]
    buffer_load_dwordx4 v226, s[44:47], s61 offen offset:2048 lds
    v_mfma_f32_16x16x32_bf16 v[92:95], v[160:163], a[220:223], v[92:95]
    ds_read_b64_tr_b16 v[160:161], v204 offset:8192
    v_mfma_f32_16x16x32_bf16 v[96:99], v[164:167], a[208:211], v[96:99]
    ds_read_b64_tr_b16 v[162:163], v204 offset:8704
    v_mfma_f32_16x16x32_bf16 v[100:103], v[164:167], a[212:215], v[100:103]
    ds_read_b128 a[200:203], v200 offset:4096
    v_mfma_f32_16x16x32_bf16 v[104:107], v[164:167], a[216:219], v[104:107]
    buffer_load_dwordx4 v227, s[44:47], s61 offen offset:3072 lds
    v_mfma_f32_16x16x32_bf16 v[108:111], v[164:167], a[220:223], v[108:111]
    ds_read_b64_tr_b16 v[164:165], v205 offset:8192
    s_waitcnt lgkmcnt(14)
    v_mfma_f32_16x16x32_bf16 v[112:115], v[168:171], a[208:211], v[112:115]
    ds_read_b64_tr_b16 v[166:167], v205 offset:8704
    v_mfma_f32_16x16x32_bf16 v[116:119], v[168:171], a[212:215], v[116:119]
    ds_read_b128 a[204:207], v200 offset:6144
    v_mfma_f32_16x16x32_bf16 v[120:123], v[168:171], a[216:219], v[120:123]
    s_add_u32 m0, s62, 98304
    s_nop 0
    buffer_load_dwordx4 v220, s[40:43], s60 offen offset:0 lds
    v_mfma_f32_16x16x32_bf16 v[124:127], v[168:171], a[220:223], v[124:127]
    ds_read_b64_tr_b16 v[168:169], v206 offset:8192
    v_mfma_f32_16x16x32_bf16 v[128:131], v[172:175], a[208:211], v[128:131]
    ds_read_b64_tr_b16 v[170:171], v206 offset:8704
    v_mfma_f32_16x16x32_bf16 v[132:135], v[172:175], a[212:215], v[132:135]
    buffer_load_dwordx4 v221, s[40:43], s60 offen offset:1024 lds
    v_mfma_f32_16x16x32_bf16 v[136:139], v[172:175], a[216:219], v[136:139]
    v_mfma_f32_16x16x32_bf16 v[140:143], v[172:175], a[220:223], v[140:143]
    ds_read_b64_tr_b16 v[172:173], v207 offset:8192
    ds_read_b64_tr_b16 v[174:175], v207 offset:8704
    s_waitcnt lgkmcnt(4)
    v_mfma_f32_16x16x32_bf16 v[16:19], v[144:147], a[192:195], v[16:19]
    buffer_load_dwordx4 v222, s[40:43], s60 offen offset:2048 lds
    v_mfma_f32_16x16x32_bf16 v[20:23], v[144:147], a[196:199], v[20:23]
    ds_read_b128 a[208:211], v201 offset:0
    v_mfma_f32_16x16x32_bf16 v[24:27], v[144:147], a[200:203], v[24:27]
    v_mfma_f32_16x16x32_bf16 v[28:31], v[144:147], a[204:207], v[28:31]
    ds_read_b64_tr_b16 v[144:145], v204 offset:4096
    v_mfma_f32_16x16x32_bf16 v[32:35], v[148:151], a[192:195], v[32:35]
    ds_read_b64_tr_b16 v[146:147], v204 offset:4608
    v_mfma_f32_16x16x32_bf16 v[36:39], v[148:151], a[196:199], v[36:39]
    buffer_load_dwordx4 v223, s[40:43], s60 offen offset:3072 lds
    v_mfma_f32_16x16x32_bf16 v[40:43], v[148:151], a[200:203], v[40:43]
    s_add_u32 m0, s62, 102400
    s_add_u32 s60, s60, 40960
    buffer_load_dwordx4 v220, s[40:43], s60 offen offset:0 lds
    v_mfma_f32_16x16x32_bf16 v[44:47], v[148:151], a[204:207], v[44:47]
    ds_read_b64_tr_b16 v[148:149], v205 offset:4096
    s_waitcnt lgkmcnt(15)
    v_mfma_f32_16x16x32_bf16 v[48:51], v[152:155], a[192:195], v[48:51]
    ds_read_b64_tr_b16 v[150:151], v205 offset:4608
    v_mfma_f32_16x16x32_bf16 v[52:55], v[152:155], a[196:199], v[52:55]
    ds_read_b128 a[212:215], v201 offset:2048
    v_mfma_f32_16x16x32_bf16 v[56:59], v[152:155], a[200:203], v[56:59]
    buffer_load_dwordx4 v221, s[40:43], s60 offen offset:1024 lds
    v_mfma_f32_16x16x32_bf16 v[60:63], v[152:155], a[204:207], v[60:63]
    ds_read_b64_tr_b16 v[152:153], v206 offset:4096
    v_mfma_f32_16x16x32_bf16 v[64:67], v[156:159], a[192:195], v[64:67]
    ds_read_b64_tr_b16 v[154:155], v206 offset:4608
    v_mfma_f32_16x16x32_bf16 v[68:71], v[156:159], a[196:199], v[68:71]
    v_mfma_f32_16x16x32_bf16 v[72:75], v[156:159], a[200:203], v[72:75]
    buffer_load_dwordx4 v222, s[40:43], s60 offen offset:2048 lds
    v_mfma_f32_16x16x32_bf16 v[76:79], v[156:159], a[204:207], v[76:79]
    ds_read_b64_tr_b16 v[156:157], v207 offset:4096
    s_waitcnt lgkmcnt(14)
    v_mfma_f32_16x16x32_bf16 v[80:83], v[160:163], a[192:195], v[80:83]
    ds_read_b64_tr_b16 v[158:159], v207 offset:4608
    v_mfma_f32_16x16x32_bf16 v[84:87], v[160:163], a[196:199], v[84:87]
    ds_read_b128 a[216:219], v201 offset:4096
    v_mfma_f32_16x16x32_bf16 v[88:91], v[160:163], a[200:203], v[88:91]
    buffer_load_dwordx4 v223, s[40:43], s60 offen offset:3072 lds
    v_mfma_f32_16x16x32_bf16 v[92:95], v[160:163], a[204:207], v[92:95]
    ds_read_b64_tr_b16 v[160:161], v204 offset:12288
    v_mfma_f32_16x16x32_bf16 v[96:99], v[164:167], a[192:195], v[96:99]
    ds_read_b64_tr_b16 v[162:163], v204 offset:12800
    v_mfma_f32_16x16x32_bf16 v[100:103], v[164:167], a[196:199], v[100:103]
    buffer_store_dwordx4 a[236:239], v5, s[52:55], s6 offen offset:0 sc1
    v_mfma_f32_16x16x32_bf16 v[104:107], v[164:167], a[200:203], v[104:107]
    s_cmp_eq_u32 s64, 7
    s_cselect_b32 s18, -1990656, s38
    s_cselect_b32 s19, -42112, s37
    v_mfma_f32_16x16x32_bf16 v[108:111], v[164:167], a[204:207], v[108:111]
    ds_read_b64_tr_b16 v[164:165], v205 offset:12288
    s_waitcnt lgkmcnt(14)
    v_mfma_f32_16x16x32_bf16 v[112:115], v[168:171], a[192:195], v[112:115]
    ds_read_b64_tr_b16 v[166:167], v205 offset:12800
    v_mfma_f32_16x16x32_bf16 v[116:119], v[168:171], a[196:199], v[116:119]
    ds_read_b128 a[220:223], v201 offset:6144
    v_mfma_f32_16x16x32_bf16 v[120:123], v[168:171], a[200:203], v[120:123]
    s_add_u32 s61, s61, s18
    s_add_u32 s60, s60, s19
    v_mfma_f32_16x16x32_bf16 v[124:127], v[168:171], a[204:207], v[124:127]
    ds_read_b64_tr_b16 v[168:169], v206 offset:12288
    v_mfma_f32_16x16x32_bf16 v[128:131], v[172:175], a[192:195], v[128:131]
    ds_read_b64_tr_b16 v[170:171], v206 offset:12800
    v_mfma_f32_16x16x32_bf16 v[132:135], v[172:175], a[196:199], v[132:135]
    s_add_u32 m0, s88, 0
    s_nop 0
    buffer_load_dwordx4 v6, s[40:43], s94 offen lds
    v_mfma_f32_16x16x32_bf16 v[136:139], v[172:175], a[200:203], v[136:139]
    v_mfma_f32_16x16x32_bf16 v[140:143], v[172:175], a[204:207], v[140:143]
    ds_read_b64_tr_b16 v[172:173], v207 offset:12288
    ds_read_b64_tr_b16 v[174:175], v207 offset:12800
    s_waitcnt lgkmcnt(4)
    v_mfma_f32_16x16x32_bf16 v[16:19], v[144:147], a[208:211], v[16:19]
    v_mfma_f32_16x16x32_bf16 v[20:23], v[144:147], a[212:215], v[20:23]
    s_add_u32 m0, s88, 1024
    s_nop 0
    buffer_load_dwordx4 v7, s[40:43], s94 offen lds
    v_mfma_f32_16x16x32_bf16 v[24:27], v[144:147], a[216:219], v[24:27]
    v_mfma_f32_16x16x32_bf16 v[28:31], v[144:147], a[220:223], v[28:31]
    v_mfma_f32_16x16x32_bf16 v[32:35], v[148:151], a[208:211], v[32:35]
    v_mfma_f32_16x16x32_bf16 v[36:39], v[148:151], a[212:215], v[36:39]
    s_add_u32 m0, s88, 2048
    s_nop 0
    buffer_load_dwordx4 v8, s[40:43], s94 offen lds
    v_mfma_f32_16x16x32_bf16 v[40:43], v[148:151], a[216:219], v[40:43]
    v_mfma_f32_16x16x32_bf16 v[44:47], v[148:151], a[220:223], v[44:47]
    s_waitcnt vmcnt(17) lgkmcnt(0)
    s_barrier
    ds_read_b64_tr_b16 v[144:145], v204 offset:49152
    s_waitcnt lgkmcnt(11)
    v_mfma_f32_16x16x32_bf16 v[48:51], v[152:155], a[208:211], v[48:51]
    ds_read_b64_tr_b16 v[146:147], v204 offset:49664
    v_mfma_f32_16x16x32_bf16 v[52:55], v[152:155], a[212:215], v[52:55]
    ds_read_b64_tr_b16 v[148:149], v205 offset:49152
    v_mfma_f32_16x16x32_bf16 v[56:59], v[152:155], a[216:219], v[56:59]
    ds_read_b64_tr_b16 v[150:151], v205 offset:49664
    v_mfma_f32_16x16x32_bf16 v[60:63], v[152:155], a[220:223], v[60:63]
    ds_read_b64_tr_b16 v[152:153], v206 offset:49152
    s_add_u32 m0, s63, 32768
    s_nop 0
    buffer_load_dwordx4 v224, s[44:47], s61 offen offset:0 lds
    v_mfma_f32_16x16x32_bf16 v[64:67], v[156:159], a[208:211], v[64:67]
    ds_read_b64_tr_b16 v[154:155], v206 offset:49664
    v_mfma_f32_16x16x32_bf16 v[68:71], v[156:159], a[212:215], v[68:71]
    ds_read_b128 a[192:195], v200 offset:49152
    v_mfma_f32_16x16x32_bf16 v[72:75], v[156:159], a[216:219], v[72:75]
    buffer_load_dwordx4 v225, s[44:47], s61 offen offset:1024 lds
    v_mfma_f32_16x16x32_bf16 v[76:79], v[156:159], a[220:223], v[76:79]
    ds_read_b64_tr_b16 v[156:157], v207 offset:49152
    s_waitcnt lgkmcnt(13)
    v_mfma_f32_16x16x32_bf16 v[80:83], v[160:163], a[208:211], v[80:83]
    ds_read_b64_tr_b16 v[158:159], v207 offset:49664
    v_mfma_f32_16x16x32_bf16 v[84:87], v[160:163], a[212:215], v[84:87]
    ds_read_b128 a[196:199], v200 offset:51200
    v_mfma_f32_16x16x32_bf16 v[88:91], v[160:163], a[216:219], v[88:91]
    buffer_load_dwordx4 v226, s[44:47], s61 offen offset:2048 lds
    v_mfma_f32_16x16x32_bf16 v[92:95], v[160:163], a[220:223], v[92:95]
    ds_read_b64_tr_b16 v[160:161], v204 offset:57344
    v_mfma_f32_16x16x32_bf16 v[96:99], v[164:167], a[208:211], v[96:99]
    ds_read_b64_tr_b16 v[162:163], v204 offset:57856
    v_mfma_f32_16x16x32_bf16 v[100:103], v[164:167], a[212:215], v[100:103]
    ds_read_b128 a[200:203], v200 offset:53248
    v_mfma_f32_16x16x32_bf16 v[104:107], v[164:167], a[216:219], v[104:107]
    buffer_load_dwordx4 v227, s[44:47], s61 offen offset:3072 lds
    v_mfma_f32_16x16x32_bf16 v[108:111], v[164:167], a[220:223], v[108:111]
    ds_read_b64_tr_b16 v[164:165], v205 offset:57344
    s_waitcnt lgkmcnt(14)
    v_mfma_f32_16x16x32_bf16 v[112:115], v[168:171], a[208:211], v[112:115]
    ds_read_b64_tr_b16 v[166:167], v205 offset:57856
    v_mfma_f32_16x16x32_bf16 v[116:119], v[168:171], a[212:215], v[116:119]
    ds_read_b128 a[204:207], v200 offset:55296
    v_mfma_f32_16x16x32_bf16 v[120:123], v[168:171], a[216:219], v[120:123]
    v_mfma_f32_16x16x32_bf16 v[124:127], v[168:171], a[220:223], v[124:127]
    ds_read_b64_tr_b16 v[168:169], v206 offset:57344
    v_mfma_f32_16x16x32_bf16 v[128:131], v[172:175], a[208:211], v[128:131]
    ds_read_b64_tr_b16 v[170:171], v206 offset:57856
    v_mfma_f32_16x16x32_bf16 v[132:135], v[172:175], a[212:215], v[132:135]
    s_add_u32 m0, s62, 0
    s_nop 0
    buffer_load_dwordx4 v220, s[40:43], s60 offen offset:0 lds
    v_mfma_f32_16x16x32_bf16 v[136:139], v[172:175], a[216:219], v[136:139]
    v_mfma_f32_16x16x32_bf16 v[140:143], v[172:175], a[220:223], v[140:143]
    ds_read_b64_tr_b16 v[172:173], v207 offset:57344
    ds_read_b64_tr_b16 v[174:175], v207 offset:57856
    s_waitcnt lgkmcnt(4)
    v_mfma_f32_16x16x32_bf16 v[16:19], v[144:147], a[192:195], v[16:19]
    buffer_load_dwordx4 v221, s[40:43], s60 offen offset:1024 lds
    v_mfma_f32_16x16x32_bf16 v[20:23], v[144:147], a[196:199], v[20:23]
    ds_read_b128 a[208:211], v201 offset:49152
    v_mfma_f32_16x16x32_bf16 v[24:27], v[144:147], a[200:203], v[24:27]
    v_mfma_f32_16x16x32_bf16 v[28:31], v[144:147], a[204:207], v[28:31]
    ds_read_b64_tr_b16 v[144:145], v204 offset:53248
    v_mfma_f32_16x16x32_bf16 v[32:35], v[148:151], a[192:195], v[32:35]
    ds_read_b64_tr_b16 v[146:147], v204 offset:53760
    v_mfma_f32_16x16x32_bf16 v[36:39], v[148:151], a[196:199], v[36:39]
    buffer_load_dwordx4 v222, s[40:43], s60 offen offset:2048 lds
    v_mfma_f32_16x16x32_bf16 v[40:43], v[148:151], a[200:203], v[40:43]
    buffer_store_dwordx4 a[236:239], v5, s[52:55], s6 offen offset:1024 sc1
    v_mfma_f32_16x16x32_bf16 v[44:47], v[148:151], a[204:207], v[44:47]
    ds_read_b64_tr_b16 v[148:149], v205 offset:53248
    s_waitcnt lgkmcnt(15)
    v_mfma_f32_16x16x32_bf16 v[48:51], v[152:155], a[192:195], v[48:51]
    ds_read_b64_tr_b16 v[150:151], v205 offset:53760
    v_mfma_f32_16x16x32_bf16 v[52:55], v[152:155], a[196:199], v[52:55]
    ds_read_b128 a[212:215], v201 offset:51200
    v_mfma_f32_16x16x32_bf16 v[56:59], v[152:155], a[200:203], v[56:59]
    buffer_load_dwordx4 v223, s[40:43], s60 offen offset:3072 lds
    v_mfma_f32_16x16x32_bf16 v[60:63], v[152:155], a[204:207], v[60:63]
    ds_read_b64_tr_b16 v[152:153], v206 offset:53248
    v_mfma_f32_16x16x32_bf16 v[64:67], v[156:159], a[192:195], v[64:67]
    ds_read_b64_tr_b16 v[154:155], v206 offset:53760
    v_mfma_f32_16x16x32_bf16 v[68:71], v[156:159], a[196:199], v[68:71]
    v_mfma_f32_16x16x32_bf16 v[72:75], v[156:159], a[200:203], v[72:75]
    s_add_u32 m0, s62, 4096
    s_add_u32 s60, s60, 40960
    buffer_load_dwordx4 v220, s[40:43], s60 offen offset:0 lds
    v_mfma_f32_16x16x32_bf16 v[76:79], v[156:159], a[204:207], v[76:79]
    ds_read_b64_tr_b16 v[156:157], v207 offset:53248
    s_waitcnt lgkmcnt(14)
    v_mfma_f32_16x16x32_bf16 v[80:83], v[160:163], a[192:195], v[80:83]
    ds_read_b64_tr_b16 v[158:159], v207 offset:53760
    v_mfma_f32_16x16x32_bf16 v[84:87], v[160:163], a[196:199], v[84:87]
    ds_read_b128 a[216:219], v201 offset:53248
    v_mfma_f32_16x16x32_bf16 v[88:91], v[160:163], a[200:203], v[88:91]
    buffer_load_dwordx4 v221, s[40:43], s60 offen offset:1024 lds
    v_mfma_f32_16x16x32_bf16 v[92:95], v[160:163], a[204:207], v[92:95]
    ds_read_b64_tr_b16 v[160:161], v204 offset:61440
    v_mfma_f32_16x16x32_bf16 v[96:99], v[164:167], a[192:195], v[96:99]
    ds_read_b64_tr_b16 v[162:163], v204 offset:61952
    v_mfma_f32_16x16x32_bf16 v[100:103], v[164:167], a[196:199], v[100:103]
    v_mfma_f32_16x16x32_bf16 v[104:107], v[164:167], a[200:203], v[104:107]
    buffer_load_dwordx4 v222, s[40:43], s60 offen offset:2048 lds
    v_mfma_f32_16x16x32_bf16 v[108:111], v[164:167], a[204:207], v[108:111]
    ds_read_b64_tr_b16 v[164:165], v205 offset:61440
    s_waitcnt lgkmcnt(14)
    v_mfma_f32_16x16x32_bf16 v[112:115], v[168:171], a[192:195], v[112:115]
    ds_read_b64_tr_b16 v[166:167], v205 offset:61952
    v_mfma_f32_16x16x32_bf16 v[116:119], v[168:171], a[196:199], v[116:119]
    ds_read_b128 a[220:223], v201 offset:55296
    v_mfma_f32_16x16x32_bf16 v[120:123], v[168:171], a[200:203], v[120:123]
    buffer_load_dwordx4 v223, s[40:43], s60 offen offset:3072 lds
    v_mfma_f32_16x16x32_bf16 v[124:127], v[168:171], a[204:207], v[124:127]
    ds_read_b64_tr_b16 v[168:169], v206 offset:61440
    v_mfma_f32_16x16x32_bf16 v[128:131], v[172:175], a[192:195], v[128:131]
    ds_read_b64_tr_b16 v[170:171], v206 offset:61952
    v_mfma_f32_16x16x32_bf16 v[132:135], v[172:175], a[196:199], v[132:135]
    v_mfma_f32_16x16x32_bf16 v[136:139], v[172:175], a[200:203], v[136:139]
    v_mfma_f32_16x16x32_bf16 v[140:143], v[172:175], a[204:207], v[140:143]
    ds_read_b64_tr_b16 v[172:173], v207 offset:61440
    ds_read_b64_tr_b16 v[174:175], v207 offset:61952
    s_waitcnt lgkmcnt(4)
    v_mfma_f32_16x16x32_bf16 v[16:19], v[144:147], a[208:211], v[16:19]
    s_cmp_eq_u32 s64, 8
    s_cselect_b32 s18, -1990656, s38
    s_cselect_b32 s19, -42112, s37
    v_mfma_f32_16x16x32_bf16 v[20:23], v[144:147], a[212:215], v[20:23]
    v_mfma_f32_16x16x32_bf16 v[24:27], v[144:147], a[216:219], v[24:27]
    v_mfma_f32_16x16x32_bf16 v[28:31], v[144:147], a[220:223], v[28:31]
    v_mfma_f32_16x16x32_bf16 v[32:35], v[148:151], a[208:211], v[32:35]
    s_add_u32 s61, s61, s18
    s_add_u32 s60, s60, s19
    v_mfma_f32_16x16x32_bf16 v[36:39], v[148:151], a[212:215], v[36:39]
    v_mfma_f32_16x16x32_bf16 v[40:43], v[148:151], a[216:219], v[40:43]
    v_mfma_f32_16x16x32_bf16 v[44:47], v[148:151], a[220:223], v[44:47]
    s_waitcnt vmcnt(17) lgkmcnt(0)
    s_barrier
    ds_read_b64_tr_b16 v[144:145], v208 offset:0
    s_waitcnt lgkmcnt(11)
    v_mfma_f32_16x16x32_bf16 v[48:51], v[152:155], a[208:211], v[48:51]
    ds_read_b64_tr_b16 v[146:147], v208 offset:512
    v_mfma_f32_16x16x32_bf16 v[52:55], v[152:155], a[212:215], v[52:55]
    ds_read_b64_tr_b16 v[148:149], v209 offset:0
    v_mfma_f32_16x16x32_bf16 v[56:59], v[152:155], a[216:219], v[56:59]
    ds_read_b64_tr_b16 v[150:151], v209 offset:512
    v_mfma_f32_16x16x32_bf16 v[60:63], v[152:155], a[220:223], v[60:63]
    ds_read_b64_tr_b16 v[152:153], v210 offset:0
    s_add_u32 m0, s63, 81920
    s_nop 0
    buffer_load_dwordx4 v224, s[44:47], s61 offen offset:0 lds
    v_mfma_f32_16x16x32_bf16 v[64:67], v[156:159], a[208:211], v[64:67]
    ds_read_b64_tr_b16 v[154:155], v210 offset:512
    v_mfma_f32_16x16x32_bf16 v[68:71], v[156:159], a[212:215], v[68:71]
    ds_read_b128 a[192:195], v202 offset:0
    v_mfma_f32_16x16x32_bf16 v[72:75], v[156:159], a[216:219], v[72:75]
    buffer_load_dwordx4 v225, s[44:47], s61 offen offset:1024 lds
    v_mfma_f32_16x16x32_bf16 v[76:79], v[156:159], a[220:223], v[76:79]
    ds_read_b64_tr_b16 v[156:157], v211 offset:0
    s_waitcnt lgkmcnt(13)
    v_mfma_f32_16x16x32_bf16 v[80:83], v[160:163], a[208:211], v[80:83]
    ds_read_b64_tr_b16 v[158:159], v211 offset:512
    v_mfma_f32_16x16x32_bf16 v[84:87], v[160:163], a[212:215], v[84:87]
    ds_read_b128 a[196:199], v202 offset:2048
    buffer_load_dwordx2 v[196:197], v195, s[52:55], 0 offen sc1
    v_mfma_f32_16x16x32_bf16 v[88:91], v[160:163], a[216:219], v[88:91]
    v_mfma_f32_16x16x32_bf16 v[92:95], v[160:163], a[220:223], v[92:95]
    ds_read_b64_tr_b16 v[160:161], v208 offset:8192
    v_mfma_f32_16x16x32_bf16 v[96:99], v[164:167], a[208:211], v[96:99]
    ds_read_b64_tr_b16 v[162:163], v208 offset:8704
    v_mfma_f32_16x16x32_bf16 v[100:103], v[164:167], a[212:215], v[100:103]
    ds_read_b128 a[200:203], v202 offset:4096
    v_mfma_f32_16x16x32_bf16 v[104:107], v[164:167], a[216:219], v[104:107]
    buffer_load_dwordx4 v226, s[44:47], s61 offen offset:2048 lds
    v_mfma_f32_16x16x32_bf16 v[108:111], v[164:167], a[220:223], v[108:111]
    ds_read_b64_tr_b16 v[164:165], v209 offset:8192
    s_waitcnt lgkmcnt(14)
    v_mfma_f32_16x16x32_bf16 v[112:115], v[168:171], a[208:211], v[112:115]
    ds_read_b64_tr_b16 v[166:167], v209 offset:8704
    v_mfma_f32_16x16x32_bf16 v[116:119], v[168:171], a[212:215], v[116:119]
    ds_read_b128 a[204:207], v202 offset:6144
    v_mfma_f32_16x16x32_bf16 v[120:123], v[168:171], a[216:219], v[120:123]
    buffer_load_dwordx4 v227, s[44:47], s61 offen offset:3072 lds
    v_mfma_f32_16x16x32_bf16 v[124:127], v[168:171], a[220:223], v[124:127]
    ds_read_b64_tr_b16 v[168:169], v210 offset:8192
    v_mfma_f32_16x16x32_bf16 v[128:131], v[172:175], a[208:211], v[128:131]
    ds_read_b64_tr_b16 v[170:171], v210 offset:8704
    v_mfma_f32_16x16x32_bf16 v[132:135], v[172:175], a[212:215], v[132:135]
    v_mfma_f32_16x16x32_bf16 v[136:139], v[172:175], a[216:219], v[136:139]
    v_mfma_f32_16x16x32_bf16 v[140:143], v[172:175], a[220:223], v[140:143]
    ds_read_b64_tr_b16 v[172:173], v211 offset:8192
    ds_read_b64_tr_b16 v[174:175], v211 offset:8704
    s_waitcnt lgkmcnt(4)
    v_mfma_f32_16x16x32_bf16 v[16:19], v[144:147], a[192:195], v[16:19]
    s_add_u32 m0, s62, 49152
    s_nop 0
    buffer_load_dwordx4 v220, s[40:43], s60 offen offset:0 lds
    v_mfma_f32_16x16x32_bf16 v[20:23], v[144:147], a[196:199], v[20:23]
    ds_read_b128 a[208:211], v203 offset:0
    v_mfma_f32_16x16x32_bf16 v[24:27], v[144:147], a[200:203], v[24:27]
    v_mfma_f32_16x16x32_bf16 v[28:31], v[144:147], a[204:207], v[28:31]
    ds_read_b64_tr_b16 v[144:145], v208 offset:4096
    v_mfma_f32_16x16x32_bf16 v[32:35], v[148:151], a[192:195], v[32:35]
    ds_read_b64_tr_b16 v[146:147], v208 offset:4608
    v_mfma_f32_16x16x32_bf16 v[36:39], v[148:151], a[196:199], v[36:39]
    buffer_load_dwordx4 v221, s[40:43], s60 offen offset:1024 lds
    v_mfma_f32_16x16x32_bf16 v[40:43], v[148:151], a[200:203], v[40:43]
    v_mfma_f32_16x16x32_bf16 v[44:47], v[148:151], a[204:207], v[44:47]
    ds_read_b64_tr_b16 v[148:149], v209 offset:4096
    s_waitcnt lgkmcnt(15)
    v_mfma_f32_16x16x32_bf16 v[48:51], v[152:155], a[192:195], v[48:51]
    ds_read_b64_tr_b16 v[150:151], v209 offset:4608
    v_mfma_f32_16x16x32_bf16 v[52:55], v[152:155], a[196:199], v[52:55]
    ds_read_b128 a[212:215], v203 offset:2048
    v_mfma_f32_16x16x32_bf16 v[56:59], v[152:155], a[200:203], v[56:59]
    buffer_load_dwordx4 v222, s[40:43], s60 offen offset:2048 lds
    v_mfma_f32_16x16x32_bf16 v[60:63], v[152:155], a[204:207], v[60:63]
    ds_read_b64_tr_b16 v[152:153], v210 offset:4096
    v_mfma_f32_16x16x32_bf16 v[64:67], v[156:159], a[192:195], v[64:67]
    ds_read_b64_tr_b16 v[154:155], v210 offset:4608
    v_mfma_f32_16x16x32_bf16 v[68:71], v[156:159], a[196:199], v[68:71]
    v_mfma_f32_16x16x32_bf16 v[72:75], v[156:159], a[200:203], v[72:75]
    buffer_load_dwordx4 v223, s[40:43], s60 offen offset:3072 lds
    v_mfma_f32_16x16x32_bf16 v[76:79], v[156:159], a[204:207], v[76:79]
    ds_read_b64_tr_b16 v[156:157], v211 offset:4096
    s_waitcnt lgkmcnt(14)
    v_mfma_f32_16x16x32_bf16 v[80:83], v[160:163], a[192:195], v[80:83]
    ds_read_b64_tr_b16 v[158:159], v211 offset:4608
    v_mfma_f32_16x16x32_bf16 v[84:87], v[160:163], a[196:199], v[84:87]
    ds_read_b128 a[216:219], v203 offset:4096
    v_mfma_f32_16x16x32_bf16 v[88:91], v[160:163], a[200:203], v[88:91]
    v_mfma_f32_16x16x32_bf16 v[92:95], v[160:163], a[204:207], v[92:95]
    ds_read_b64_tr_b16 v[160:161], v208 offset:12288
    v_mfma_f32_16x16x32_bf16 v[96:99], v[164:167], a[192:195], v[96:99]
    ds_read_b64_tr_b16 v[162:163], v208 offset:12800
    v_mfma_f32_16x16x32_bf16 v[100:103], v[164:167], a[196:199], v[100:103]
    s_add_u32 m0, s62, 53248
    s_add_u32 s60, s60, 40960
    buffer_load_dwordx4 v220, s[40:43], s60 offen offset:0 lds
    v_mfma_f32_16x16x32_bf16 v[104:107], v[164:167], a[200:203], v[104:107]
    v_mfma_f32_16x16x32_bf16 v[108:111], v[164:167], a[204:207], v[108:111]
    ds_read_b64_tr_b16 v[164:165], v209 offset:12288
    s_waitcnt lgkmcnt(14)
    v_mfma_f32_16x16x32_bf16 v[112:115], v[168:171], a[192:195], v[112:115]
    ds_read_b64_tr_b16 v[166:167], v209 offset:12800
    v_mfma_f32_16x16x32_bf16 v[116:119], v[168:171], a[196:199], v[116:119]
    ds_read_b128 a[220:223], v203 offset:6144
    v_mfma_f32_16x16x32_bf16 v[120:123], v[168:171], a[200:203], v[120:123]
    buffer_load_dwordx4 v221, s[40:43], s60 offen offset:1024 lds
    v_mfma_f32_16x16x32_bf16 v[124:127], v[168:171], a[204:207], v[124:127]
    ds_read_b64_tr_b16 v[168:169], v210 offset:12288
    v_mfma_f32_16x16x32_bf16 v[128:131], v[172:175], a[192:195], v[128:131]
    ds_read_b64_tr_b16 v[170:171], v210 offset:12800
    v_mfma_f32_16x16x32_bf16 v[132:135], v[172:175], a[196:199], v[132:135]
    v_mfma_f32_16x16x32_bf16 v[136:139], v[172:175], a[200:203], v[136:139]
    buffer_load_dwordx4 v222, s[40:43], s60 offen offset:2048 lds
    v_mfma_f32_16x16x32_bf16 v[140:143], v[172:175], a[204:207], v[140:143]
    ds_read_b64_tr_b16 v[172:173], v211 offset:12288
    ds_read_b64_tr_b16 v[174:175], v211 offset:12800
    s_waitcnt lgkmcnt(4)
    v_mfma_f32_16x16x32_bf16 v[16:19], v[144:147], a[208:211], v[16:19]
    v_mfma_f32_16x16x32_bf16 v[20:23], v[144:147], a[212:215], v[20:23]
    v_mfma_f32_16x16x32_bf16 v[24:27], v[144:147], a[216:219], v[24:27]
    v_mfma_f32_16x16x32_bf16 v[28:31], v[144:147], a[220:223], v[28:31]
    v_mfma_f32_16x16x32_bf16 v[32:35], v[148:151], a[208:211], v[32:35]
    buffer_load_dwordx4 v223, s[40:43], s60 offen offset:3072 lds
    v_mfma_f32_16x16x32_bf16 v[36:39], v[148:151], a[212:215], v[36:39]
    s_waitcnt vmcnt(10)
    v_cmp_ne_u64 vcc, s[16:17], v[196:197]
    s_nop 3
    s_cbranch_vccnz re_g
ok_g:
    v_mfma_f32_16x16x32_bf16 v[40:43], v[148:151], a[216:219], v[40:43]
    v_mfma_f32_16x16x32_bf16 v[44:47], v[148:151], a[220:223], v[44:47]
    s_waitcnt vmcnt(13) lgkmcnt(0)
    s_barrier
    ds_read_b64_tr_b16 v[144:145], v204 offset:0
    s_waitcnt lgkmcnt(11)
    v_mfma_f32_16x16x32_bf16 v[48:51], v[152:155], a[208:211], v[48:51]
    ds_read_b64_tr_b16 v[146:147], v204 offset:512
    v_mfma_f32_16x16x32_bf16 v[52:55], v[152:155], a[212:215], v[52:55]
    ds_read_b64_tr_b16 v[148:149], v205 offset:0
    v_mfma_f32_16x16x32_bf16 v[56:59], v[152:155], a[216:219], v[56:59]
    ds_read_b64_tr_b16 v[150:151], v205 offset:512
    buffer_load_dwordx4 v[234:237], v11, s[52:55], s95 offen sc1
    v_mfma_f32_16x16x32_bf16 v[60:63], v[152:155], a[220:223], v[60:63]
    ds_read_b64_tr_b16 v[152:153], v206 offset:0
    v_mfma_f32_16x16x32_bf16 v[64:67], v[156:159], a[208:211], v[64:67]
    ds_read_b64_tr_b16 v[154:155], v206 offset:512
    v_mfma_f32_16x16x32_bf16 v[68:71], v[156:159], a[212:215], v[68:71]
    ds_read_b128 a[192:195], v200 offset:0
    v_mfma_f32_16x16x32_bf16 v[72:75], v[156:159], a[216:219], v[72:75]
    buffer_load_dwordx2 v[232:233], v213, s[52:55], s95 offen sc1
    buffer_load_dwordx4 v[240:243], v11, s[52:55], s95 offen offset:1024 sc1
    v_mfma_f32_16x16x32_bf16 v[76:79], v[156:159], a[220:223], v[76:79]
    ds_read_b64_tr_b16 v[156:157], v207 offset:0
    buffer_load_dwordx4 v[228:231], v212, s[52:55], s11 offen sc1
    s_waitcnt lgkmcnt(13)
    v_mfma_f32_16x16x32_bf16 v[80:83], v[160:163], a[208:211], v[80:83]
    ds_read_b64_tr_b16 v[158:159], v207 offset:512
    buffer_load_dwordx4 v[244:247], v9, s[52:55], s3 offen sc1
    buffer_load_dword v9, v9, s[52:55], s92 offen sc1
    v_mfma_f32_16x16x32_bf16 v[84:87], v[160:163], a[212:215], v[84:87]
    ds_read_b128 a[196:199], v200 offset:2048
    v_mfma_f32_16x16x32_bf16 v[88:91], v[160:163], a[216:219], v[88:91]
    buffer_load_dwordx2 v[238:239], v11, s[52:55], s95 offen offset:1016 sc1
    v_mov_b32 v248, s16
    v_mov_b32 v249, s17
    v_mfma_f32_16x16x32_bf16 v[92:95], v[160:163], a[220:223], v[92:95]
    ds_read_b64_tr_b16 v[160:161], v204 offset:8192
    buffer_store_dwordx2 v[198:199], v254, s[52:55], s23 offen offset:64 sc1
    v_mfma_f32_16x16x32_bf16 v[96:99], v[164:167], a[208:211], v[96:99]
    ds_read_b64_tr_b16 v[162:163], v204 offset:8704
    v_mfma_f32_16x16x32_bf16 v[100:103], v[164:167], a[212:215], v[100:103]
    ds_read_b128 a[200:203], v200 offset:4096
    v_mfma_f32_16x16x32_bf16 v[104:107], v[164:167], a[216:219], v[104:107]
    s_add_u32 m0, s1, 17152
    s_nop 0
    buffer_load_dwordx4 v11, s[84:87], 0 offen lds
    v_mfma_f32_16x16x32_bf16 v[108:111], v[164:167], a[220:223], v[108:111]
    ds_read_b64_tr_b16 v[164:165], v205 offset:8192
    s_waitcnt lgkmcnt(14)
    v_mfma_f32_16x16x32_bf16 v[112:115], v[168:171], a[208:211], v[112:115]
    ds_read_b64_tr_b16 v[166:167], v205 offset:8704
    buffer_load_dwordx4 v11, s[84:87], 0 offen offset:1024 lds
    v_mfma_f32_16x16x32_bf16 v[116:119], v[168:171], a[212:215], v[116:119]
    ds_read_b128 a[204:207], v200 offset:6144
    v_mfma_f32_16x16x32_bf16 v[120:123], v[168:171], a[216:219], v[120:123]
    v_mfma_f32_16x16x32_bf16 v[124:127], v[168:171], a[220:223], v[124:127]
    ds_read_b64_tr_b16 v[168:169], v206 offset:8192
    v_mfma_f32_16x16x32_bf16 v[128:131], v[172:175], a[208:211], v[128:131]
    ds_read_b64_tr_b16 v[170:171], v206 offset:8704
    v_mfma_f32_16x16x32_bf16 v[132:135], v[172:175], a[212:215], v[132:135]
    buffer_load_dwordx4 a[0:3], v5, s[52:55], s89 offen offset:0 sc1
    v_mfma_f32_16x16x32_bf16 v[136:139], v[172:175], a[216:219], v[136:139]
    v_mfma_f32_16x16x32_bf16 v[140:143], v[172:175], a[220:223], v[140:143]
    ds_read_b64_tr_b16 v[172:173], v207 offset:8192
    ds_read_b64_tr_b16 v[174:175], v207 offset:8704
    s_waitcnt lgkmcnt(4)
    v_mfma_f32_16x16x32_bf16 v[16:19], v[144:147], a[192:195], v[16:19]
    buffer_load_dwordx4 a[4:7], v5, s[52:55], s89 offen offset:1024 sc1
    v_mfma_f32_16x16x32_bf16 v[20:23], v[144:147], a[196:199], v[20:23]
    ds_read_b128 a[208:211], v201 offset:0
    v_mfma_f32_16x16x32_bf16 v[24:27], v[144:147], a[200:203], v[24:27]
    v_mfma_f32_16x16x32_bf16 v[28:31], v[144:147], a[204:207], v[28:31]
    ds_read_b64_tr_b16 v[144:145], v204 offset:4096
    v_mfma_f32_16x16x32_bf16 v[32:35], v[148:151], a[192:195], v[32:35]
    ds_read_b64_tr_b16 v[146:147], v204 offset:4608
    v_mfma_f32_16x16x32_bf16 v[36:39], v[148:151], a[196:199], v[36:39]
    v_mfma_f32_16x16x32_bf16 v[40:43], v[148:151], a[200:203], v[40:43]
    buffer_load_dwordx4 a[8:11], v5, s[52:55], s89 offen offset:2048 sc1
    v_mfma_f32_16x16x32_bf16 v[44:47], v[148:151], a[204:207], v[44:47]
    ds_read_b64_tr_b16 v[148:149], v205 offset:4096
    s_waitcnt lgkmcnt(15)
    v_mfma_f32_16x16x32_bf16 v[48:51], v[152:155], a[192:195], v[48:51]
    ds_read_b64_tr_b16 v[150:151], v205 offset:4608
    v_mfma_f32_16x16x32_bf16 v[52:55], v[152:155], a[196:199], v[52:55]
    ds_read_b128 a[212:215], v201 offset:2048
    v_mfma_f32_16x16x32_bf16 v[56:59], v[152:155], a[200:203], v[56:59]
    buffer_load_dwordx4 a[12:15], v5, s[52:55], s89 offen offset:3072 sc1
    s_add_u32 s89, s89, 4096
    v_mfma_f32_16x16x32_bf16 v[60:63], v[152:155], a[204:207], v[60:63]
    ds_read_b64_tr_b16 v[152:153], v206 offset:4096
    v_mfma_f32_16x16x32_bf16 v[64:67], v[156:159], a[192:195], v[64:67]
    ds_read_b64_tr_b16 v[154:155], v206 offset:4608
    v_mfma_f32_16x16x32_bf16 v[68:71], v[156:159], a[196:199], v[68:71]
    v_mfma_f32_16x16x32_bf16 v[72:75], v[156:159], a[200:203], v[72:75]
    buffer_load_dwordx4 a[16:19], v5, s[52:55], s89 offen offset:0 sc1
    v_mfma_f32_16x16x32_bf16 v[76:79], v[156:159], a[204:207], v[76:79]
    ds_read_b64_tr_b16 v[156:157], v207 offset:4096
    s_waitcnt lgkmcnt(14)
    v_mfma_f32_16x16x32_bf16 v[80:83], v[160:163], a[192:195], v[80:83]
    ds_read_b64_tr_b16 v[158:159], v207 offset:4608
    v_mfma_f32_16x16x32_bf16 v[84:87], v[160:163], a[196:199], v[84:87]
    ds_read_b128 a[216:219], v201 offset:4096
    v_mfma_f32_16x16x32_bf16 v[88:91], v[160:163], a[200:203], v[88:91]
    v_mfma_f32_16x16x32_bf16 v[92:95], v[160:163], a[204:207], v[92:95]
    ds_read_b64_tr_b16 v[160:161], v204 offset:12288
    v_mfma_f32_16x16x32_bf16 v[96:99], v[164:167], a[192:195], v[96:99]
    ds_read_b64_tr_b16 v[162:163], v204 offset:12800
    v_mfma_f32_16x16x32_bf16 v[100:103], v[164:167], a[196:199], v[100:103]
    buffer_load_dwordx4 a[20:23], v5, s[52:55], s89 offen offset:1024 sc1
    v_mfma_f32_16x16x32_bf16 v[104:107], v[164:167], a[200:203], v[104:107]
    v_mfma_f32_16x16x32_bf16 v[108:111], v[164:167], a[204:207], v[108:111]
    ds_read_b64_tr_b16 v[164:165], v205 offset:12288
    s_waitcnt lgkmcnt(14)
    v_mfma_f32_16x16x32_bf16 v[112:115], v[168:171], a[192:195], v[112:115]
    ds_read_b64_tr_b16 v[166:167], v205 offset:12800
    v_mfma_f32_16x16x32_bf16 v[116:119], v[168:171], a[196:199], v[116:119]
    ds_read_b128 a[220:223], v201 offset:6144
    v_mfma_f32_16x16x32_bf16 v[120:123], v[168:171], a[200:203], v[120:123]
    buffer_load_dwordx4 a[24:27], v5, s[52:55], s89 offen offset:2048 sc1
    ds_write_b128 v193, a[232:235]
    v_mfma_f32_16x16x32_bf16 v[124:127], v[168:171], a[204:207], v[124:127]
    ds_read_b64_tr_b16 v[168:169], v206 offset:12288
    v_mfma_f32_16x16x32_bf16 v[128:131], v[172:175], a[192:195], v[128:131]
    ds_read_b64_tr_b16 v[170:171], v206 offset:12800
    v_mfma_f32_16x16x32_bf16 v[132:135], v[172:175], a[196:199], v[132:135]
    s_waitcnt vmcnt(10)
    v_mfma_f32_16x16x32_bf16 v[136:139], v[172:175], a[200:203], v[136:139]
    buffer_load_dwordx4 a[28:31], v5, s[52:55], s89 offen offset:3072 sc1
    s_add_u32 s89, s89, 4096
    v_mfma_f32_16x16x32_bf16 v[140:143], v[172:175], a[204:207], v[140:143]
    ds_read_b64_tr_b16 v[172:173], v207 offset:12288
    ds_read_b64_tr_b16 v[174:175], v207 offset:12800
    s_waitcnt lgkmcnt(5)
    v_mfma_f32_16x16x32_bf16 v[16:19], v[144:147], a[208:211], v[16:19]
    ds_write_b128 v192, v[234:237] offset:32
    v_mfma_f32_16x16x32_bf16 v[20:23], v[144:147], a[212:215], v[20:23]
    v_alignbit_b32 v180, v234, v233, 16
    s_waitcnt vmcnt(12)
    v_mfma_f32_16x16x32_bf16 v[24:27], v[144:147], a[216:219], v[24:27]
    v_alignbit_b32 v181, v235, v234, 16
    v_mfma_f32_16x16x32_bf16 v[28:31], v[144:147], a[220:223], v[28:31]
    v_add_f32_dpp v228, v228, v228 row_ror:8 row_mask:0xf bank_mask:0xf
    v_mfma_f32_16x16x32_bf16 v[32:35], v[148:151], a[208:211], v[32:35]
    buffer_load_dwordx4 a[32:35], v5, s[52:55], s89 offen offset:0 sc1
    v_add_f32_dpp v229, v229, v229 row_ror:8 row_mask:0xf bank_mask:0xf
    v_mfma_f32_16x16x32_bf16 v[36:39], v[148:151], a[212:215], v[36:39]
    v_alignbit_b32 v182, v236, v235, 16
    v_mfma_f32_16x16x32_bf16 v[40:43], v[148:151], a[216:219], v[40:43]
    v_alignbit_b32 v183, v237, v236, 16
    v_add_f32_dpp v230, v230, v230 row_ror:8 row_mask:0xf bank_mask:0xf
    v_mfma_f32_16x16x32_bf16 v[44:47], v[148:151], a[220:223], v[44:47]
    s_waitcnt vmcnt(19) lgkmcnt(0)
    s_barrier
    ds_read_b64_tr_b16 v[144:145], v204 offset:49152
    s_waitcnt lgkmcnt(13)
    v_mfma_f32_16x16x32_bf16 v[48:51], v[152:155], a[208:211], v[48:51]
    ds_read_b64_tr_b16 v[146:147], v204 offset:49664
    ds_write_b128 v192, v[180:183] offset:4192
    v_mfma_f32_16x16x32_bf16 v[52:55], v[152:155], a[212:215], v[52:55]
    ds_read_b64_tr_b16 v[148:149], v205 offset:49152
    buffer_load_dwordx4 a[36:39], v5, s[52:55], s89 offen offset:1024 sc1
    v_mfma_f32_16x16x32_bf16 v[56:59], v[152:155], a[216:219], v[56:59]
    ds_read_b64_tr_b16 v[150:151], v205 offset:49664
    v_add_f32_dpp v231, v231, v231 row_ror:8 row_mask:0xf bank_mask:0xf
    v_mfma_f32_16x16x32_bf16 v[60:63], v[152:155], a[220:223], v[60:63]
    ds_read_b64_tr_b16 v[152:153], v206 offset:49152
    v_mov_b32 v184, v233
    v_mfma_f32_16x16x32_bf16 v[64:67], v[156:159], a[208:211], v[64:67]
    ds_read_b64_tr_b16 v[154:155], v206 offset:49664
    v_mov_b32 v216, v228
    v_mfma_f32_16x16x32_bf16 v[68:71], v[156:159], a[212:215], v[68:71]
    ds_read_b128 a[192:195], v200 offset:49152
    v_mov_b32 v185, v234
    v_mfma_f32_16x16x32_bf16 v[72:75], v[156:159], a[216:219], v[72:75]
    buffer_load_dwordx4 a[40:43], v5, s[52:55], s89 offen offset:2048 sc1
    v_mov_b32 v217, v229
    v_mov_b32 v218, v230
    v_mfma_f32_16x16x32_bf16 v[76:79], v[156:159], a[220:223], v[76:79]
    ds_read_b64_tr_b16 v[156:157], v207 offset:49152
    s_waitcnt lgkmcnt(15)
    v_mfma_f32_16x16x32_bf16 v[80:83], v[160:163], a[208:211], v[80:83]
    ds_read_b64_tr_b16 v[158:159], v207 offset:49664
    v_mov_b32 v186, v235
    v_mov_b32 v219, v231
    v_mfma_f32_16x16x32_bf16 v[84:87], v[160:163], a[212:215], v[84:87]
    ds_read_b128 a[196:199], v200 offset:51200
    v_mov_b32 v187, v236
    v_mfma_f32_16x16x32_bf16 v[88:91], v[160:163], a[216:219], v[88:91]
    buffer_load_dwordx4 a[44:47], v5, s[52:55], s89 offen offset:3072 sc1
    s_add_u32 s89, s89, 4096
    v_mfma_f32_16x16x32_bf16 v[92:95], v[160:163], a[220:223], v[92:95]
    ds_read_b64_tr_b16 v[160:161], v204 offset:57344
    s_nop 0
    v_mfma_f32_16x16x32_bf16 v[96:99], v[164:167], a[208:211], v[96:99]
    ds_read_b64_tr_b16 v[162:163], v204 offset:57856
    ds_write_b128 v192, v[184:187] offset:8352
    v_mfma_f32_16x16x32_bf16 v[100:103], v[164:167], a[212:215], v[100:103]
    ds_read_b128 a[200:203], v200 offset:53248
    v_permlane16_swap_b32 v228, v216
    v_mfma_f32_16x16x32_bf16 v[104:107], v[164:167], a[216:219], v[104:107]
    buffer_load_dwordx4 a[48:51], v5, s[52:55], s89 offen offset:0 sc1
    v_alignbit_b32 v188, v233, v232, 16
    v_mfma_f32_16x16x32_bf16 v[108:111], v[164:167], a[220:223], v[108:111]
    ds_read_b64_tr_b16 v[164:165], v205 offset:57344
    s_waitcnt lgkmcnt(15)
    v_mfma_f32_16x16x32_bf16 v[112:115], v[168:171], a[208:211], v[112:115]
    ds_read_b64_tr_b16 v[166:167], v205 offset:57856
    v_permlane16_swap_b32 v229, v217
    v_mfma_f32_16x16x32_bf16 v[116:119], v[168:171], a[212:215], v[116:119]
    ds_read_b128 a[204:207], v200 offset:55296
    v_permlane16_swap_b32 v230, v218
    v_mfma_f32_16x16x32_bf16 v[120:123], v[168:171], a[216:219], v[120:123]
    v_alignbit_b32 v189, v234, v233, 16
    v_permlane16_swap_b32 v231, v219
    v_mfma_f32_16x16x32_bf16 v[124:127], v[168:171], a[220:223], v[124:127]
    ds_read_b64_tr_b16 v[168:169], v206 offset:57344
    v_alignbit_b32 v190, v235, v234, 16
    v_mfma_f32_16x16x32_bf16 v[128:131], v[172:175], a[208:211], v[128:131]
    ds_read_b64_tr_b16 v[170:171], v206 offset:57856
    v_add_f32 v228, v228, v216
    v_mfma_f32_16x16x32_bf16 v[132:135], v[172:175], a[212:215], v[132:135]
    buffer_load_dwordx4 a[52:55], v5, s[52:55], s89 offen offset:1024 sc1
    v_mfma_f32_16x16x32_bf16 v[136:139], v[172:175], a[216:219], v[136:139]
    v_alignbit_b32 v191, v236, v235, 16
    v_add_f32 v229, v229, v217
    v_mfma_f32_16x16x32_bf16 v[140:143], v[172:175], a[220:223], v[140:143]
    ds_read_b64_tr_b16 v[172:173], v207 offset:57344
    ds_read_b64_tr_b16 v[174:175], v207 offset:57856
    s_waitcnt lgkmcnt(4)
    v_mfma_f32_16x16x32_bf16 v[16:19], v[144:147], a[192:195], v[16:19]
    ds_write_b128 v192, v[188:191] offset:12512
    v_mfma_f32_16x16x32_bf16 v[20:23], v[144:147], a[196:199], v[20:23]
    ds_read_b128 a[208:211], v201 offset:49152
    ds_write_b128 v192, v[240:243] offset:1056
    v_mfma_f32_16x16x32_bf16 v[24:27], v[144:147], a[200:203], v[24:27]
    buffer_load_dwordx4 a[56:59], v5, s[52:55], s89 offen offset:2048 sc1
    v_add_f32 v230, v230, v218
    v_mfma_f32_16x16x32_bf16 v[28:31], v[144:147], a[204:207], v[28:31]
    ds_read_b64_tr_b16 v[144:145], v204 offset:53248
    v_add_f32 v231, v231, v219
    v_mfma_f32_16x16x32_bf16 v[32:35], v[148:151], a[192:195], v[32:35]
    ds_read_b64_tr_b16 v[146:147], v204 offset:53760
    v_mov_b32 v216, v228
    v_mfma_f32_16x16x32_bf16 v[36:39], v[148:151], a[196:199], v[36:39]
    v_alignbit_b32 v180, v240, v239, 16
    v_alignbit_b32 v181, v241, v240, 16
    v_mfma_f32_16x16x32_bf16 v[40:43], v[148:151], a[200:203], v[40:43]
    buffer_load_dwordx4 a[60:63], v5, s[52:55], s89 offen offset:3072 sc1
    s_add_u32 s89, s89, 4096
    v_mov_b32 v217, v229
    v_mfma_f32_16x16x32_bf16 v[44:47], v[148:151], a[204:207], v[44:47]
    ds_read_b64_tr_b16 v[148:149], v205 offset:53248
    s_waitcnt lgkmcnt(15)
    v_mfma_f32_16x16x32_bf16 v[48:51], v[152:155], a[192:195], v[48:51]
    ds_read_b64_tr_b16 v[150:151], v205 offset:53760
    v_alignbit_b32 v182, v242, v241, 16
    v_mfma_f32_16x16x32_bf16 v[52:55], v[152:155], a[196:199], v[52:55]
    ds_read_b128 a[212:215], v201 offset:51200
    v_mov_b32 v218, v230
    v_mfma_f32_16x16x32_bf16 v[56:59], v[152:155], a[200:203], v[56:59]
    buffer_load_dwordx4 a[64:67], v5, s[52:55], s89 offen offset:0 sc1
    v_alignbit_b32 v183, v243, v242, 16
    v_mfma_f32_16x16x32_bf16 v[60:63], v[152:155], a[204:207], v[60:63]
    ds_read_b64_tr_b16 v[152:153], v206 offset:53248
    v_mov_b32 v219, v231
    v_mfma_f32_16x16x32_bf16 v[64:67], v[156:159], a[192:195], v[64:67]
    ds_read_b64_tr_b16 v[154:155], v206 offset:53760
    s_nop 0
    v_mfma_f32_16x16x32_bf16 v[68:71], v[156:159], a[196:199], v[68:71]
    ds_write_b128 v192, v[180:183] offset:5216
    v_mfma_f32_16x16x32_bf16 v[72:75], v[156:159], a[200:203], v[72:75]
    buffer_load_dwordx4 a[68:71], v5, s[52:55], s89 offen offset:1024 sc1
    v_mov_b32 v184, v239
    v_mfma_f32_16x16x32_bf16 v[76:79], v[156:159], a[204:207], v[76:79]
    ds_read_b64_tr_b16 v[156:157], v207 offset:53248
    s_waitcnt lgkmcnt(15)
    v_mfma_f32_16x16x32_bf16 v[80:83], v[160:163], a[192:195], v[80:83]
    ds_read_b64_tr_b16 v[158:159], v207 offset:53760
    v_permlane32_swap_b32 v228, v216
    v_mfma_f32_16x16x32_bf16 v[84:87], v[160:163], a[196:199], v[84:87]
    ds_read_b128 a[216:219], v201 offset:53248
    v_permlane32_swap_b32 v229, v217
    v_mfma_f32_16x16x32_bf16 v[88:91], v[160:163], a[200:203], v[88:91]
    v_mov_b32 v185, v240
    v_permlane32_swap_b32 v230, v218
    v_mfma_f32_16x16x32_bf16 v[92:95], v[160:163], a[204:207], v[92:95]
    ds_read_b64_tr_b16 v[160:161], v204 offset:61440
    v_mov_b32 v186, v241
    v_mfma_f32_16x16x32_bf16 v[96:99], v[164:167], a[192:195], v[96:99]
    ds_read_b64_tr_b16 v[162:163], v204 offset:61952
    v_permlane32_swap_b32 v231, v219
    v_mfma_f32_16x16x32_bf16 v[100:103], v[164:167], a[196:199], v[100:103]
    buffer_load_dwordx4 a[72:75], v5, s[52:55], s89 offen offset:2048 sc1
    v_add_f32 v228, v228, v216
    v_mfma_f32_16x16x32_bf16 v[104:107], v[164:167], a[200:203], v[104:107]
    v_mov_b32 v187, v242
    ds_write_b128 v192, v[184:187] offset:9376
    v_mfma_f32_16x16x32_bf16 v[108:111], v[164:167], a[204:207], v[108:111]
    ds_read_b64_tr_b16 v[164:165], v205 offset:61440
    s_waitcnt lgkmcnt(15)
    v_mfma_f32_16x16x32_bf16 v[112:115], v[168:171], a[192:195], v[112:115]
    ds_read_b64_tr_b16 v[166:167], v205 offset:61952
    v_add_f32 v229, v229, v217
    v_mfma_f32_16x16x32_bf16 v[116:119], v[168:171], a[196:199], v[116:119]
    ds_read_b128 a[220:223], v201 offset:55296
    v_alignbit_b32 v188, v239, v238, 16
    v_mfma_f32_16x16x32_bf16 v[120:123], v[168:171], a[200:203], v[120:123]
    buffer_load_dwordx4 a[76:79], v5, s[52:55], s89 offen offset:3072 sc1
    s_add_u32 s89, s89, 4096
    v_mfma_f32_16x16x32_bf16 v[124:127], v[168:171], a[204:207], v[124:127]
    ds_read_b64_tr_b16 v[168:169], v206 offset:61440
    v_add_f32 v230, v230, v218
    v_mfma_f32_16x16x32_bf16 v[128:131], v[172:175], a[192:195], v[128:131]
    ds_read_b64_tr_b16 v[170:171], v206 offset:61952
    v_add_f32 v231, v231, v219
    v_mfma_f32_16x16x32_bf16 v[132:135], v[172:175], a[196:199], v[132:135]
    buffer_load_dwordx4 a[80:83], v5, s[52:55], s89 offen offset:0 sc1
    v_mfma_f32_16x16x32_bf16 v[136:139], v[172:175], a[200:203], v[136:139]
    v_alignbit_b32 v189, v240, v239, 16
    ds_write_b128 v215, v[228:231]
    v_mfma_f32_16x16x32_bf16 v[140:143], v[172:175], a[204:207], v[140:143]
    ds_read_b64_tr_b16 v[172:173], v207 offset:61440
    ds_read_b64_tr_b16 v[174:175], v207 offset:61952
    s_waitcnt lgkmcnt(5)
    v_mfma_f32_16x16x32_bf16 v[16:19], v[144:147], a[208:211], v[16:19]
    v_alignbit_b32 v190, v241, v240, 16
    v_mfma_f32_16x16x32_bf16 v[20:23], v[144:147], a[212:215], v[20:23]
    v_alignbit_b32 v191, v242, v241, 16
    v_mfma_f32_16x16x32_bf16 v[24:27], v[144:147], a[216:219], v[24:27]
    buffer_load_dwordx4 a[84:87], v5, s[52:55], s89 offen offset:1024 sc1
    v_mfma_f32_16x16x32_bf16 v[28:31], v[144:147], a[220:223], v[28:31]
    ds_write_b128 v192, v[188:191] offset:13536
    v_mfma_f32_16x16x32_bf16 v[32:35], v[148:151], a[208:211], v[32:35]
    v_mfma_f32_16x16x32_bf16 v[36:39], v[148:151], a[212:215], v[36:39]
    v_and_b32 v219, 0xffff0000, v244
    v_mfma_f32_16x16x32_bf16 v[40:43], v[148:151], a[216:219], v[40:43]
    buffer_load_dwordx4 a[88:91], v5, s[52:55], s89 offen offset:2048 sc1
    v_mfma_f32_16x16x32_bf16 v[44:47], v[148:151], a[220:223], v[44:47]
    s_waitcnt lgkmcnt(13)
    v_mfma_f32_16x16x32_bf16 v[48:51], v[152:155], a[208:211], v[48:51]
    v_lshlrev_b32 v216, 16, v244
    v_mfma_f32_16x16x32_bf16 v[52:55], v[152:155], a[212:215], v[52:55]
    v_rcp_f32 v217, v219
    v_mfma_f32_16x16x32_bf16 v[56:59], v[152:155], a[216:219], v[56:59]
    v_xor_b32 v216, 0x80000000, v216
    v_mfma_f32_16x16x32_bf16 v[60:63], v[152:155], a[220:223], v[60:63]
    buffer_load_dwordx4 a[92:95], v5, s[52:55], s89 offen offset:3072 sc1
    s_add_u32 s89, s89, 4096
    v_mfma_f32_16x16x32_bf16 v[64:67], v[156:159], a[208:211], v[64:67]
    v_mul_f32 v218, v219, v219
    v_mfma_f32_16x16x32_bf16 v[68:71], v[156:159], a[212:215], v[68:71]
    v_mul_f32 v217, 0xbfb8aa3b, v217
    v_mfma_f32_16x16x32_bf16 v[72:75], v[156:159], a[216:219], v[72:75]
    v_and_b32 v223, 0xffff0000, v245
    v_lshlrev_b32 v220, 16, v245
    v_mfma_f32_16x16x32_bf16 v[76:79], v[156:159], a[220:223], v[76:79]
    v_rcp_f32 v221, v223
    s_waitcnt lgkmcnt(7)
    v_mfma_f32_16x16x32_bf16 v[80:83], v[160:163], a[208:211], v[80:83]
    buffer_load_dwordx4 a[96:99], v5, s[52:55], s89 offen offset:0 sc1
    v_mfma_f32_16x16x32_bf16 v[84:87], v[160:163], a[212:215], v[84:87]
    v_xor_b32 v220, 0x80000000, v220
    v_mfma_f32_16x16x32_bf16 v[88:91], v[160:163], a[216:219], v[88:91]
    v_mul_f32 v222, v223, v223
    v_mfma_f32_16x16x32_bf16 v[92:95], v[160:163], a[220:223], v[92:95]
    v_mul_f32 v221, 0xbfb8aa3b, v221
    v_mfma_f32_16x16x32_bf16 v[96:99], v[164:167], a[208:211], v[96:99]
    buffer_load_dwordx4 a[100:103], v5, s[52:55], s89 offen offset:1024 sc1
    v_mfma_f32_16x16x32_bf16 v[100:103], v[164:167], a[212:215], v[100:103]
    v_and_b32 v227, 0xffff0000, v246
    v_mfma_f32_16x16x32_bf16 v[104:107], v[164:167], a[216:219], v[104:107]
    v_lshlrev_b32 v224, 16, v246
    v_rcp_f32 v225, v227
    v_mfma_f32_16x16x32_bf16 v[108:111], v[164:167], a[220:223], v[108:111]
    s_waitcnt vmcnt(26) lgkmcnt(0)
    s_barrier
    ds_read_b128 v[144:147], v194 offset:0
    s_waitcnt lgkmcnt(2)
    v_mfma_f32_16x16x32_bf16 v[112:115], v[168:171], a[208:211], v[112:115]
    ds_read_b128 v[148:151], v194 offset:64
    v_xor_b32 v224, 0x80000000, v224
    v_mul_f32 v226, v227, v227
    v_mfma_f32_16x16x32_bf16 v[116:119], v[168:171], a[212:215], v[116:119]
    buffer_load_dwordx4 a[104:107], v5, s[52:55], s89 offen offset:2048 sc1
    ds_read_b128 v[160:163], v194 offset:256
    v_mfma_f32_16x16x32_bf16 v[120:123], v[168:171], a[216:219], v[120:123]
    ds_read_b128 v[164:167], v194 offset:320
    v_mul_f32 v225, 0xbfb8aa3b, v225
    v_mfma_f32_16x16x32_bf16 v[124:127], v[168:171], a[220:223], v[124:127]
    ds_read_b128 v[152:155], v194 offset:128
    v_and_b32 v231, 0xffff0000, v247
    v_mfma_f32_16x16x32_bf16 v[128:131], v[172:175], a[208:211], v[128:131]
    ds_read_b128 v[156:159], v194 offset:192
    v_lshlrev_b32 v228, 16, v247
    v_mfma_f32_16x16x32_bf16 v[132:135], v[172:175], a[212:215], v[132:135]
    buffer_load_dwordx4 a[108:111], v5, s[52:55], s89 offen offset:3072 sc1
    s_add_u32 s89, s89, 4096
    v_mfma_f32_16x16x32_bf16 v[136:139], v[172:175], a[216:219], v[136:139]
    v_rcp_f32 v229, v231
    v_mfma_f32_16x16x32_bf16 v[140:143], v[172:175], a[220:223], v[140:143]
    v_xor_b32 v228, 0x80000000, v228
    v_mul_f32 v230, v231, v231
    v_mul_f32 v229, 0xbfb8aa3b, v229
    s_nop 3
    ds_read_b128 v[168:171], v194 offset:384
    ds_read_b128 v[172:175], v194 offset:448
    s_waitcnt lgkmcnt(2)
    v_pk_fma_f32 v[16:17], v[144:145], v[216:217], v[16:17] op_sel_hi:[1,0,1]
    buffer_load_dwordx4 a[112:115], v5, s[52:55], s89 offen offset:0 sc1
    v_pk_fma_f32 v[18:19], v[146:147], v[216:217], v[18:19] op_sel_hi:[1,0,1]
    v_pk_fma_f32 v[32:33], v[148:149], v[216:217], v[32:33] op_sel_hi:[1,0,1]
    v_pk_fma_f32 v[34:35], v[150:151], v[216:217], v[34:35] op_sel_hi:[1,0,1]
    v_pk_mul_f32 v[176:177], v[16:17], v[216:217] op_sel:[0,1] op_sel_hi:[1,1]
    v_pk_mul_f32 v[178:179], v[18:19], v[216:217] op_sel:[0,1] op_sel_hi:[1,1]
    v_pk_mul_f32 v[180:181], v[32:33], v[216:217] op_sel:[0,1] op_sel_hi:[1,1]
    v_pk_mul_f32 v[182:183], v[34:35], v[216:217] op_sel:[0,1] op_sel_hi:[1,1]
    v_exp_f32 v176, v176
    v_exp_f32 v177, v177
    v_exp_f32 v178, v178
    v_exp_f32 v179, v179
    v_exp_f32 v180, v180
    v_exp_f32 v181, v181
    v_exp_f32 v182, v182
    v_exp_f32 v183, v183
    v_pk_fma_f32 v[80:81], v[160:161], v[216:217], v[80:81] op_sel_hi:[1,0,1]
    v_pk_fma_f32 v[82:83], v[162:163], v[216:217], v[82:83] op_sel_hi:[1,0,1]
    buffer_load_dwordx4 a[116:119], v5, s[52:55], s89 offen offset:1024 sc1
    s_mul_i32 s31, s93, -61440
    s_add_u32 s89, s89, s31
    v_pk_fma_f32 v[96:97], v[164:165], v[216:217], v[96:97] op_sel_hi:[1,0,1]
    v_pk_fma_f32 v[98:99], v[166:167], v[216:217], v[98:99] op_sel_hi:[1,0,1]
    v_pk_fma_f32 v[176:177], v[176:177], v[218:219], v[218:219] op_sel_hi:[1,0,0]
    v_pk_fma_f32 v[178:179], v[178:179], v[218:219], v[218:219] op_sel_hi:[1,0,0]
    v_pk_fma_f32 v[180:181], v[180:181], v[218:219], v[218:219] op_sel_hi:[1,0,0]
    v_pk_fma_f32 v[182:183], v[182:183], v[218:219], v[218:219] op_sel_hi:[1,0,0]
    v_rcp_f32 v176, v176
    v_rcp_f32 v177, v177
    v_rcp_f32 v178, v178
    v_rcp_f32 v179, v179
    v_rcp_f32 v180, v180
    v_rcp_f32 v181, v181
    v_rcp_f32 v182, v182
    v_rcp_f32 v183, v183
    v_pk_mul_f32 v[16:17], v[16:17], v[80:81]
    v_pk_mul_f32 v[18:19], v[18:19], v[82:83]
    v_pk_mul_f32 v[32:33], v[32:33], v[96:97]
    v_pk_mul_f32 v[34:35], v[34:35], v[98:99]
    v_pk_mul_f32 v[16:17], v[16:17], v[176:177]
    v_pk_mul_f32 v[18:19], v[18:19], v[178:179]
    v_pk_mul_f32 v[32:33], v[32:33], v[180:181]
    v_pk_mul_f32 v[34:35], v[34:35], v[182:183]
    v_cvt_pk_bf16_f32 v184, v16, v17
    v_cvt_pk_bf16_f32 v185, v18, v19
    v_cvt_pk_bf16_f32 v186, v32, v33
    v_cvt_pk_bf16_f32 v187, v34, v35
    buffer_store_dwordx4 v[184:187], v5, s[52:55], s78 offen offset:0 sc1
    v_pk_fma_f32 v[20:21], v[144:145], v[220:221], v[20:21] op_sel_hi:[1,0,1]
    buffer_load_dwordx4 a[120:123], v5, s[52:55], s89 offen offset:2048 sc1
    v_pk_fma_f32 v[22:23], v[146:147], v[220:221], v[22:23] op_sel_hi:[1,0,1]
    v_pk_fma_f32 v[36:37], v[148:149], v[220:221], v[36:37] op_sel_hi:[1,0,1]
    v_pk_fma_f32 v[38:39], v[150:151], v[220:221], v[38:39] op_sel_hi:[1,0,1]
    v_pk_mul_f32 v[176:177], v[20:21], v[220:221] op_sel:[0,1] op_sel_hi:[1,1]
    v_pk_mul_f32 v[178:179], v[22:23], v[220:221] op_sel:[0,1] op_sel_hi:[1,1]
    v_pk_mul_f32 v[180:181], v[36:37], v[220:221] op_sel:[0,1] op_sel_hi:[1,1]
    v_pk_mul_f32 v[182:183], v[38:39], v[220:221] op_sel:[0,1] op_sel_hi:[1,1]
    v_exp_f32 v176, v176
    v_exp_f32 v177, v177
    v_exp_f32 v178, v178
    v_exp_f32 v179, v179
    v_exp_f32 v180, v180
    v_exp_f32 v181, v181
    v_exp_f32 v182, v182
    v_exp_f32 v183, v183
    v_pk_fma_f32 v[84:85], v[160:161], v[220:221], v[84:85] op_sel_hi:[1,0,1]
    v_pk_fma_f32 v[86:87], v[162:163], v[220:221], v[86:87] op_sel_hi:[1,0,1]
    buffer_load_dwordx4 a[124:127], v5, s[52:55], s89 offen offset:3072 sc1
    s_add_u32 s89, s89, 4096
    v_pk_fma_f32 v[100:101], v[164:165], v[220:221], v[100:101] op_sel_hi:[1,0,1]
    v_pk_fma_f32 v[102:103], v[166:167], v[220:221], v[102:103] op_sel_hi:[1,0,1]
    v_pk_fma_f32 v[176:177], v[176:177], v[222:223], v[222:223] op_sel_hi:[1,0,0]
    v_pk_fma_f32 v[178:179], v[178:179], v[222:223], v[222:223] op_sel_hi:[1,0,0]
    v_pk_fma_f32 v[180:181], v[180:181], v[222:223], v[222:223] op_sel_hi:[1,0,0]
    v_pk_fma_f32 v[182:183], v[182:183], v[222:223], v[222:223] op_sel_hi:[1,0,0]
    v_rcp_f32 v176, v176
    v_rcp_f32 v177, v177
    v_rcp_f32 v178, v178
    v_rcp_f32 v179, v179
    v_rcp_f32 v180, v180
    v_rcp_f32 v181, v181
    v_rcp_f32 v182, v182
    v_rcp_f32 v183, v183
    v_pk_mul_f32 v[20:21], v[20:21], v[84:85]
    v_pk_mul_f32 v[22:23], v[22:23], v[86:87]
    v_pk_mul_f32 v[36:37], v[36:37], v[100:101]
    v_pk_mul_f32 v[38:39], v[38:39], v[102:103]
    v_pk_mul_f32 v[20:21], v[20:21], v[176:177]
    v_pk_mul_f32 v[22:23], v[22:23], v[178:179]
    v_pk_mul_f32 v[36:37], v[36:37], v[180:181]
    v_pk_mul_f32 v[38:39], v[38:39], v[182:183]
    v_cvt_pk_bf16_f32 v188, v20, v21
    v_cvt_pk_bf16_f32 v189, v22, v23
    v_cvt_pk_bf16_f32 v190, v36, v37
    v_cvt_pk_bf16_f32 v191, v38, v39
    buffer_store_dwordx4 v[188:191], v5, s[52:55], s78 offen offset:1024 sc1
    v_pk_fma_f32 v[24:25], v[144:145], v[224:225], v[24:25] op_sel_hi:[1,0,1]
    buffer_load_dwordx4 a[128:131], v5, s[52:55], s89 offen offset:0 sc1
    v_pk_fma_f32 v[26:27], v[146:147], v[224:225], v[26:27] op_sel_hi:[1,0,1]
    v_pk_fma_f32 v[40:41], v[148:149], v[224:225], v[40:41] op_sel_hi:[1,0,1]
    v_pk_fma_f32 v[42:43], v[150:151], v[224:225], v[42:43] op_sel_hi:[1,0,1]
    v_pk_mul_f32 v[176:177], v[24:25], v[224:225] op_sel:[0,1] op_sel_hi:[1,1]
    v_pk_mul_f32 v[178:179], v[26:27], v[224:225] op_sel:[0,1] op_sel_hi:[1,1]
    v_pk_mul_f32 v[180:181], v[40:41], v[224:225] op_sel:[0,1] op_sel_hi:[1,1]
    v_pk_mul_f32 v[182:183], v[42:43], v[224:225] op_sel:[0,1] op_sel_hi:[1,1]
    v_exp_f32 v176, v176
    v_exp_f32 v177, v177
    v_exp_f32 v178, v178
    v_exp_f32 v179, v179
    v_exp_f32 v180, v180
    v_exp_f32 v181, v181
    v_exp_f32 v182, v182
    v_exp_f32 v183, v183
    v_pk_fma_f32 v[88:89], v[160:161], v[224:225], v[88:89] op_sel_hi:[1,0,1]
    v_pk_fma_f32 v[90:91], v[162:163], v[224:225], v[90:91] op_sel_hi:[1,0,1]
    buffer_load_dwordx4 a[132:135], v5, s[52:55], s89 offen offset:1024 sc1
    v_pk_fma_f32 v[104:105], v[164:165], v[224:225], v[104:105] op_sel_hi:[1,0,1]
    v_pk_fma_f32 v[106:107], v[166:167], v[224:225], v[106:107] op_sel_hi:[1,0,1]
    v_pk_fma_f32 v[176:177], v[176:177], v[226:227], v[226:227] op_sel_hi:[1,0,0]
    v_pk_fma_f32 v[178:179], v[178:179], v[226:227], v[226:227] op_sel_hi:[1,0,0]
    v_pk_fma_f32 v[180:181], v[180:181], v[226:227], v[226:227] op_sel_hi:[1,0,0]
    v_pk_fma_f32 v[182:183], v[182:183], v[226:227], v[226:227] op_sel_hi:[1,0,0]
    v_rcp_f32 v176, v176
    v_rcp_f32 v177, v177
    v_rcp_f32 v178, v178
    v_rcp_f32 v179, v179
    v_rcp_f32 v180, v180
    v_rcp_f32 v181, v181
    v_rcp_f32 v182, v182
    v_rcp_f32 v183, v183
    v_pk_mul_f32 v[24:25], v[24:25], v[88:89]
    v_pk_mul_f32 v[26:27], v[26:27], v[90:91]
    v_pk_mul_f32 v[40:41], v[40:41], v[104:105]
    v_pk_mul_f32 v[42:43], v[42:43], v[106:107]
    v_pk_mul_f32 v[24:25], v[24:25], v[176:177]
    v_pk_mul_f32 v[26:27], v[26:27], v[178:179]
    v_pk_mul_f32 v[40:41], v[40:41], v[180:181]
    v_pk_mul_f32 v[42:43], v[42:43], v[182:183]
    v_cvt_pk_bf16_f32 v200, v24, v25
    v_cvt_pk_bf16_f32 v201, v26, v27
    v_cvt_pk_bf16_f32 v202, v40, v41
    v_cvt_pk_bf16_f32 v203, v42, v43
    buffer_store_dwordx4 v[200:203], v5, s[52:55], s78 offen offset:2048 sc1
    v_pk_fma_f32 v[28:29], v[144:145], v[228:229], v[28:29] op_sel_hi:[1,0,1]
    buffer_load_dwordx4 a[136:139], v5, s[52:55], s89 offen offset:2048 sc1
    v_pk_fma_f32 v[30:31], v[146:147], v[228:229], v[30:31] op_sel_hi:[1,0,1]
    v_pk_fma_f32 v[44:45], v[148:149], v[228:229], v[44:45] op_sel_hi:[1,0,1]
    v_pk_fma_f32 v[46:47], v[150:151], v[228:229], v[46:47] op_sel_hi:[1,0,1]
    v_pk_mul_f32 v[176:177], v[28:29], v[228:229] op_sel:[0,1] op_sel_hi:[1,1]
    v_pk_mul_f32 v[178:179], v[30:31], v[228:229] op_sel:[0,1] op_sel_hi:[1,1]
    v_pk_mul_f32 v[180:181], v[44:45], v[228:229] op_sel:[0,1] op_sel_hi:[1,1]
    v_pk_mul_f32 v[182:183], v[46:47], v[228:229] op_sel:[0,1] op_sel_hi:[1,1]
    v_exp_f32 v176, v176
    v_exp_f32 v177, v177
    v_exp_f32 v178, v178
    v_exp_f32 v179, v179
    v_exp_f32 v180, v180
    v_exp_f32 v181, v181
    v_exp_f32 v182, v182
    v_exp_f32 v183, v183
    v_pk_fma_f32 v[92:93], v[160:161], v[228:229], v[92:93] op_sel_hi:[1,0,1]
    v_pk_fma_f32 v[94:95], v[162:163], v[228:229], v[94:95] op_sel_hi:[1,0,1]
    buffer_load_dwordx4 a[140:143], v5, s[52:55], s89 offen offset:3072 sc1
    s_add_u32 s89, s89, 4096
    v_pk_fma_f32 v[108:109], v[164:165], v[228:229], v[108:109] op_sel_hi:[1,0,1]
    v_pk_fma_f32 v[110:111], v[166:167], v[228:229], v[110:111] op_sel_hi:[1,0,1]
    v_pk_fma_f32 v[176:177], v[176:177], v[230:231], v[230:231] op_sel_hi:[1,0,0]
    v_pk_fma_f32 v[178:179], v[178:179], v[230:231], v[230:231] op_sel_hi:[1,0,0]
    v_pk_fma_f32 v[180:181], v[180:181], v[230:231], v[230:231] op_sel_hi:[1,0,0]
    v_pk_fma_f32 v[182:183], v[182:183], v[230:231], v[230:231] op_sel_hi:[1,0,0]
    v_rcp_f32 v176, v176
    v_rcp_f32 v177, v177
    v_rcp_f32 v178, v178
    v_rcp_f32 v179, v179
    v_rcp_f32 v180, v180
    v_rcp_f32 v181, v181
    v_rcp_f32 v182, v182
    v_rcp_f32 v183, v183
    v_pk_mul_f32 v[28:29], v[28:29], v[92:93]
    v_pk_mul_f32 v[30:31], v[30:31], v[94:95]
    v_pk_mul_f32 v[44:45], v[44:45], v[108:109]
    v_pk_mul_f32 v[46:47], v[46:47], v[110:111]
    v_pk_mul_f32 v[28:29], v[28:29], v[176:177]
    v_pk_mul_f32 v[30:31], v[30:31], v[178:179]
    v_pk_mul_f32 v[44:45], v[44:45], v[180:181]
    v_pk_mul_f32 v[46:47], v[46:47], v[182:183]
    v_cvt_pk_bf16_f32 v204, v28, v29
    v_cvt_pk_bf16_f32 v205, v30, v31
    v_cvt_pk_bf16_f32 v206, v44, v45
    v_cvt_pk_bf16_f32 v207, v46, v47
    buffer_store_dwordx4 v[204:207], v5, s[52:55], s78 offen offset:3072 sc1
    s_waitcnt lgkmcnt(0)
    v_pk_fma_f32 v[48:49], v[152:153], v[216:217], v[48:49] op_sel_hi:[1,0,1]
    buffer_load_dwordx4 a[144:147], v5, s[52:55], s89 offen offset:0 sc1
    v_pk_fma_f32 v[50:51], v[154:155], v[216:217], v[50:51] op_sel_hi:[1,0,1]
    v_pk_fma_f32 v[64:65], v[156:157], v[216:217], v[64:65] op_sel_hi:[1,0,1]
    v_pk_fma_f32 v[66:67], v[158:159], v[216:217], v[66:67] op_sel_hi:[1,0,1]
    v_pk_mul_f32 v[176:177], v[48:49], v[216:217] op_sel:[0,1] op_sel_hi:[1,1]
    v_pk_mul_f32 v[178:179], v[50:51], v[216:217] op_sel:[0,1] op_sel_hi:[1,1]
    v_pk_mul_f32 v[180:181], v[64:65], v[216:217] op_sel:[0,1] op_sel_hi:[1,1]
    v_pk_mul_f32 v[182:183], v[66:67], v[216:217] op_sel:[0,1] op_sel_hi:[1,1]
    v_exp_f32 v176, v176
    v_exp_f32 v177, v177
    v_exp_f32 v178, v178
    v_exp_f32 v179, v179
    v_exp_f32 v180, v180
    v_exp_f32 v181, v181
    v_exp_f32 v182, v182
    v_exp_f32 v183, v183
    v_pk_fma_f32 v[112:113], v[168:169], v[216:217], v[112:113] op_sel_hi:[1,0,1]
    v_pk_fma_f32 v[114:115], v[170:171], v[216:217], v[114:115] op_sel_hi:[1,0,1]
    buffer_load_dwordx4 a[148:151], v5, s[52:55], s89 offen offset:1024 sc1
    v_pk_fma_f32 v[128:129], v[172:173], v[216:217], v[128:129] op_sel_hi:[1,0,1]
    v_pk_fma_f32 v[130:131], v[174:175], v[216:217], v[130:131] op_sel_hi:[1,0,1]
    v_pk_fma_f32 v[176:177], v[176:177], v[218:219], v[218:219] op_sel_hi:[1,0,0]
    v_pk_fma_f32 v[178:179], v[178:179], v[218:219], v[218:219] op_sel_hi:[1,0,0]
    v_pk_fma_f32 v[180:181], v[180:181], v[218:219], v[218:219] op_sel_hi:[1,0,0]
    v_pk_fma_f32 v[182:183], v[182:183], v[218:219], v[218:219] op_sel_hi:[1,0,0]
    v_rcp_f32 v176, v176
    v_rcp_f32 v177, v177
    v_rcp_f32 v178, v178
    v_rcp_f32 v179, v179
    v_rcp_f32 v180, v180
    v_rcp_f32 v181, v181
    v_rcp_f32 v182, v182
    v_rcp_f32 v183, v183
    v_pk_mul_f32 v[48:49], v[48:49], v[112:113]
    v_pk_mul_f32 v[50:51], v[50:51], v[114:115]
    v_pk_mul_f32 v[64:65], v[64:65], v[128:129]
    v_pk_mul_f32 v[66:67], v[66:67], v[130:131]
    v_pk_mul_f32 v[48:49], v[48:49], v[176:177]
    v_pk_mul_f32 v[50:51], v[50:51], v[178:179]
    v_pk_mul_f32 v[64:65], v[64:65], v[180:181]
    v_pk_mul_f32 v[66:67], v[66:67], v[182:183]
    v_cvt_pk_bf16_f32 v184, v48, v49
    v_cvt_pk_bf16_f32 v185, v50, v51
    v_cvt_pk_bf16_f32 v186, v64, v65
    v_cvt_pk_bf16_f32 v187, v66, v67
    buffer_store_dwordx4 v[184:187], v5, s[52:55], s79 offen offset:0 sc1
    v_pk_fma_f32 v[52:53], v[152:153], v[220:221], v[52:53] op_sel_hi:[1,0,1]
    ds_read_b128 v[80:83], v253 offset:192
    v_pk_fma_f32 v[54:55], v[154:155], v[220:221], v[54:55] op_sel_hi:[1,0,1]
    v_pk_fma_f32 v[68:69], v[156:157], v[220:221], v[68:69] op_sel_hi:[1,0,1]
    v_pk_fma_f32 v[70:71], v[158:159], v[220:221], v[70:71] op_sel_hi:[1,0,1]
    v_pk_mul_f32 v[176:177], v[52:53], v[220:221] op_sel:[0,1] op_sel_hi:[1,1]
    ds_read_b64_tr_b16 v[16:17], v251 offset:8
    v_pk_mul_f32 v[178:179], v[54:55], v[220:221] op_sel:[0,1] op_sel_hi:[1,1]
    v_pk_mul_f32 v[180:181], v[68:69], v[220:221] op_sel:[0,1] op_sel_hi:[1,1]
    v_pk_mul_f32 v[182:183], v[70:71], v[220:221] op_sel:[0,1] op_sel_hi:[1,1]
    buffer_load_dwordx4 a[152:155], v5, s[52:55], s89 offen offset:2048 sc1
    v_exp_f32 v176, v176
    v_exp_f32 v177, v177
    v_exp_f32 v178, v178
    v_exp_f32 v179, v179
    ds_read_b64_tr_b16 v[18:19], v251 offset:0
    v_exp_f32 v180, v180
    v_exp_f32 v181, v181
    v_exp_f32 v182, v182
    ds_read_b128 v[84:87], v253 offset:704
    v_exp_f32 v183, v183
    v_pk_fma_f32 v[116:117], v[168:169], v[220:221], v[116:117] op_sel_hi:[1,0,1]
    v_pk_fma_f32 v[118:119], v[170:171], v[220:221], v[118:119] op_sel_hi:[1,0,1]
    ds_read_b64_tr_b16 v[20:21], v251 offset:520
    v_pk_fma_f32 v[132:133], v[172:173], v[220:221], v[132:133] op_sel_hi:[1,0,1]
    v_pk_fma_f32 v[134:135], v[174:175], v[220:221], v[134:135] op_sel_hi:[1,0,1]
    v_pk_fma_f32 v[176:177], v[176:177], v[222:223], v[222:223] op_sel_hi:[1,0,0]
    v_pk_fma_f32 v[178:179], v[178:179], v[222:223], v[222:223] op_sel_hi:[1,0,0]
    ds_read_b64_tr_b16 v[22:23], v251 offset:512
    v_pk_fma_f32 v[180:181], v[180:181], v[222:223], v[222:223] op_sel_hi:[1,0,0]
    v_pk_fma_f32 v[182:183], v[182:183], v[222:223], v[222:223] op_sel_hi:[1,0,0]
    v_rcp_f32 v176, v176
    buffer_load_dwordx4 a[156:159], v5, s[52:55], s89 offen offset:3072 sc1
    s_add_u32 s89, s89, 4096
    v_rcp_f32 v177, v177
    v_rcp_f32 v178, v178
    v_rcp_f32 v179, v179
    v_rcp_f32 v180, v180
    ds_read_b128 v[88:91], v253 offset:1216
    v_rcp_f32 v181, v181
    v_rcp_f32 v182, v182
    v_rcp_f32 v183, v183
    ds_read_b64_tr_b16 v[24:25], v251 offset:1032
    v_pk_mul_f32 v[52:53], v[52:53], v[116:117]
    v_pk_mul_f32 v[54:55], v[54:55], v[118:119]
    v_pk_mul_f32 v[68:69], v[68:69], v[132:133]
    v_pk_mul_f32 v[70:71], v[70:71], v[134:135]
    v_pk_mul_f32 v[52:53], v[52:53], v[176:177]
    v_pk_mul_f32 v[54:55], v[54:55], v[178:179]
    v_pk_mul_f32 v[68:69], v[68:69], v[180:181]
    v_pk_mul_f32 v[70:71], v[70:71], v[182:183]
    v_cvt_pk_bf16_f32 v188, v52, v53
    v_cvt_pk_bf16_f32 v189, v54, v55
    v_cvt_pk_bf16_f32 v190, v68, v69
    v_cvt_pk_bf16_f32 v191, v70, v71
    buffer_store_dwordx4 v[188:191], v5, s[52:55], s79 offen offset:1024 sc1
    v_pk_fma_f32 v[56:57], v[152:153], v[224:225], v[56:57] op_sel_hi:[1,0,1]
    ds_read_b64_tr_b16 v[26:27], v251 offset:1024
    v_pk_fma_f32 v[58:59], v[154:155], v[224:225], v[58:59] op_sel_hi:[1,0,1]
    v_pk_fma_f32 v[72:73], v[156:157], v[224:225], v[72:73] op_sel_hi:[1,0,1]
    v_pk_fma_f32 v[74:75], v[158:159], v[224:225], v[74:75] op_sel_hi:[1,0,1]
    v_pk_mul_f32 v[176:177], v[56:57], v[224:225] op_sel:[0,1] op_sel_hi:[1,1]
    ds_read_b128 v[92:95], v253 offset:1728
    v_pk_mul_f32 v[178:179], v[58:59], v[224:225] op_sel:[0,1] op_sel_hi:[1,1]
    v_pk_mul_f32 v[180:181], v[72:73], v[224:225] op_sel:[0,1] op_sel_hi:[1,1]
    v_pk_mul_f32 v[182:183], v[74:75], v[224:225] op_sel:[0,1] op_sel_hi:[1,1]
    buffer_load_dwordx4 a[160:163], v5, s[52:55], s89 offen offset:0 sc1
    v_exp_f32 v176, v176
    v_exp_f32 v177, v177
    v_exp_f32 v178, v178
    v_exp_f32 v179, v179
    ds_read_b64_tr_b16 v[28:29], v251 offset:1544
    v_exp_f32 v180, v180
    v_exp_f32 v181, v181
    v_exp_f32 v182, v182
    ds_read_b64_tr_b16 v[30:31], v251 offset:1536
    v_exp_f32 v183, v183
    v_pk_fma_f32 v[120:121], v[168:169], v[224:225], v[120:121] op_sel_hi:[1,0,1]
    v_pk_fma_f32 v[122:123], v[170:171], v[224:225], v[122:123] op_sel_hi:[1,0,1]
    ds_read_b128 v[96:99], v253 offset:2240
    v_pk_fma_f32 v[136:137], v[172:173], v[224:225], v[136:137] op_sel_hi:[1,0,1]
    v_pk_fma_f32 v[138:139], v[174:175], v[224:225], v[138:139] op_sel_hi:[1,0,1]
    v_pk_fma_f32 v[176:177], v[176:177], v[226:227], v[226:227] op_sel_hi:[1,0,0]
    v_pk_fma_f32 v[178:179], v[178:179], v[226:227], v[226:227] op_sel_hi:[1,0,0]
    ds_read_b64_tr_b16 v[32:33], v251 offset:2056
    v_pk_fma_f32 v[180:181], v[180:181], v[226:227], v[226:227] op_sel_hi:[1,0,0]
    v_pk_fma_f32 v[182:183], v[182:183], v[226:227], v[226:227] op_sel_hi:[1,0,0]
    v_rcp_f32 v176, v176
    buffer_load_dwordx4 a[164:167], v5, s[52:55], s89 offen offset:1024 sc1
    v_rcp_f32 v177, v177
    v_rcp_f32 v178, v178
    v_rcp_f32 v179, v179
    v_rcp_f32 v180, v180
    ds_read_b64_tr_b16 v[34:35], v251 offset:2048
    v_rcp_f32 v181, v181
    v_rcp_f32 v182, v182
    v_rcp_f32 v183, v183
    ds_read_b128 v[100:103], v253 offset:2752
    v_pk_mul_f32 v[56:57], v[56:57], v[120:121]
    v_pk_mul_f32 v[58:59], v[58:59], v[122:123]
    v_pk_mul_f32 v[72:73], v[72:73], v[136:137]
    v_pk_mul_f32 v[74:75], v[74:75], v[138:139]
    v_pk_mul_f32 v[56:57], v[56:57], v[176:177]
    v_pk_mul_f32 v[58:59], v[58:59], v[178:179]
    v_pk_mul_f32 v[72:73], v[72:73], v[180:181]
    v_pk_mul_f32 v[74:75], v[74:75], v[182:183]
    v_cvt_pk_bf16_f32 v200, v56, v57
    v_cvt_pk_bf16_f32 v201, v58, v59
    v_cvt_pk_bf16_f32 v202, v72, v73
    v_cvt_pk_bf16_f32 v203, v74, v75
    buffer_store_dwordx4 v[200:203], v5, s[52:55], s79 offen offset:2048 sc1
    v_pk_fma_f32 v[60:61], v[152:153], v[228:229], v[60:61] op_sel_hi:[1,0,1]
    ds_read_b64_tr_b16 v[36:37], v251 offset:2568
    v_pk_fma_f32 v[62:63], v[154:155], v[228:229], v[62:63] op_sel_hi:[1,0,1]
    v_pk_fma_f32 v[76:77], v[156:157], v[228:229], v[76:77] op_sel_hi:[1,0,1]
    v_pk_fma_f32 v[78:79], v[158:159], v[228:229], v[78:79] op_sel_hi:[1,0,1]
    v_pk_mul_f32 v[176:177], v[60:61], v[228:229] op_sel:[0,1] op_sel_hi:[1,1]
    ds_read_b64_tr_b16 v[38:39], v251 offset:2560
    v_pk_mul_f32 v[178:179], v[62:63], v[228:229] op_sel:[0,1] op_sel_hi:[1,1]
    v_pk_mul_f32 v[180:181], v[76:77], v[228:229] op_sel:[0,1] op_sel_hi:[1,1]
    v_pk_mul_f32 v[182:183], v[78:79], v[228:229] op_sel:[0,1] op_sel_hi:[1,1]
    buffer_load_dwordx4 a[168:171], v5, s[52:55], s89 offen offset:2048 sc1
    v_exp_f32 v176, v176
    v_exp_f32 v177, v177
    v_exp_f32 v178, v178
    v_exp_f32 v179, v179
    ds_read_b128 v[104:107], v253 offset:3264
    v_exp_f32 v180, v180
    v_exp_f32 v181, v181
    v_exp_f32 v182, v182
    ds_read_b64_tr_b16 v[40:41], v251 offset:3080
    v_exp_f32 v183, v183
    v_pk_fma_f32 v[124:125], v[168:169], v[228:229], v[124:125] op_sel_hi:[1,0,1]
    v_pk_fma_f32 v[126:127], v[170:171], v[228:229], v[126:127] op_sel_hi:[1,0,1]
    ds_read_b64_tr_b16 v[42:43], v251 offset:3072
    v_pk_fma_f32 v[140:141], v[172:173], v[228:229], v[140:141] op_sel_hi:[1,0,1]
    v_pk_fma_f32 v[142:143], v[174:175], v[228:229], v[142:143] op_sel_hi:[1,0,1]
    v_pk_fma_f32 v[176:177], v[176:177], v[230:231], v[230:231] op_sel_hi:[1,0,0]
    v_pk_fma_f32 v[178:179], v[178:179], v[230:231], v[230:231] op_sel_hi:[1,0,0]
    ds_read_b128 v[108:111], v253 offset:3776
    v_pk_fma_f32 v[180:181], v[180:181], v[230:231], v[230:231] op_sel_hi:[1,0,0]
    v_pk_fma_f32 v[182:183], v[182:183], v[230:231], v[230:231] op_sel_hi:[1,0,0]
    v_rcp_f32 v176, v176
    buffer_load_dwordx4 a[172:175], v5, s[52:55], s89 offen offset:3072 sc1
    s_add_u32 s89, s89, 4096
    v_rcp_f32 v177, v177
    v_rcp_f32 v178, v178
    v_rcp_f32 v179, v179
    v_rcp_f32 v180, v180
    ds_read_b64_tr_b16 v[44:45], v251 offset:3592
    v_rcp_f32 v181, v181
    v_rcp_f32 v182, v182
    v_rcp_f32 v183, v183
    ds_read_b64_tr_b16 v[46:47], v251 offset:3584
    v_pk_mul_f32 v[60:61], v[60:61], v[124:125]
    v_pk_mul_f32 v[62:63], v[62:63], v[126:127]
    v_pk_mul_f32 v[76:77], v[76:77], v[140:141]
    v_pk_mul_f32 v[78:79], v[78:79], v[142:143]
    v_pk_mul_f32 v[60:61], v[60:61], v[176:177]
    v_pk_mul_f32 v[62:63], v[62:63], v[178:179]
    v_pk_mul_f32 v[76:77], v[76:77], v[180:181]
    v_pk_mul_f32 v[78:79], v[78:79], v[182:183]
    v_cvt_pk_bf16_f32 v204, v60, v61
    v_cvt_pk_bf16_f32 v205, v62, v63
    v_cvt_pk_bf16_f32 v206, v76, v77
    v_cvt_pk_bf16_f32 v207, v78, v79
    buffer_store_dwordx4 v[204:207], v5, s[52:55], s79 offen offset:3072 sc1
    s_waitcnt lgkmcnt(0)
    v_mfma_f32_16x16x32_bf16 v[216:219], v[16:19], v[80:83], 0
    ds_read_b128 v[112:115], v253 offset:128
    v_mfma_f32_16x16x32_bf16 v[220:223], v[16:19], v[84:87], 0
    ds_read_b64_tr_b16 v[48:49], v251 offset:72
    v_mfma_f32_16x16x32_bf16 v[224:227], v[16:19], v[88:91], 0
    buffer_load_dwordx4 a[176:179], v5, s[52:55], s89 offen offset:0 sc1
    v_mfma_f32_16x16x32_bf16 v[228:231], v[16:19], v[92:95], 0
    ds_read_b64_tr_b16 v[50:51], v251 offset:64
    v_mfma_f32_16x16x32_bf16 v[232:235], v[16:19], v[96:99], 0
    ds_read_b128 v[116:119], v253 offset:640
    v_mfma_f32_16x16x32_bf16 v[236:239], v[16:19], v[100:103], 0
    ds_read_b64_tr_b16 v[52:53], v251 offset:584
    v_mfma_f32_16x16x32_bf16 v[240:243], v[16:19], v[104:107], 0
    buffer_load_dwordx4 a[180:183], v5, s[52:55], s89 offen offset:1024 sc1
    v_mfma_f32_16x16x32_bf16 v[244:247], v[16:19], v[108:111], 0
    ds_read_b64_tr_b16 v[54:55], v251 offset:576
    v_mfma_f32_16x16x32_bf16 v[220:223], v[20:23], v[80:83], v[220:223]
    ds_read_b128 v[120:123], v253 offset:1152
    v_mfma_f32_16x16x32_bf16 v[224:227], v[20:23], v[84:87], v[224:227]
    ds_read_b64_tr_b16 v[56:57], v251 offset:1096
    v_mfma_f32_16x16x32_bf16 v[228:231], v[20:23], v[88:91], v[228:231]
    buffer_load_dwordx4 a[184:187], v5, s[52:55], s89 offen offset:2048 sc1
    v_mfma_f32_16x16x32_bf16 v[232:235], v[20:23], v[92:95], v[232:235]
    ds_read_b64_tr_b16 v[58:59], v251 offset:1088
    v_mfma_f32_16x16x32_bf16 v[236:239], v[20:23], v[96:99], v[236:239]
    ds_read_b128 v[124:127], v253 offset:1664
    v_mfma_f32_16x16x32_bf16 v[240:243], v[20:23], v[100:103], v[240:243]
    ds_read_b64_tr_b16 v[60:61], v251 offset:1608
    v_mfma_f32_16x16x32_bf16 v[244:247], v[20:23], v[104:107], v[244:247]
    buffer_load_dwordx4 a[188:191], v5, s[52:55], s89 offen offset:3072 sc1
    s_add_u32 s89, s89, 4096
    v_mfma_f32_16x16x32_bf16 v[224:227], v[24:27], v[80:83], v[224:227]
    ds_read_b64_tr_b16 v[62:63], v251 offset:1600
    v_mfma_f32_16x16x32_bf16 v[228:231], v[24:27], v[84:87], v[228:231]
    ds_read_b128 v[128:131], v253 offset:2176
    v_mfma_f32_16x16x32_bf16 v[232:235], v[24:27], v[88:91], v[232:235]
    ds_read_b64_tr_b16 v[64:65], v251 offset:2120
    v_mfma_f32_16x16x32_bf16 v[236:239], v[24:27], v[92:95], v[236:239]
    buffer_load_dwordx4 a[192:195], v5, s[52:55], s89 offen offset:0 sc1
    v_mfma_f32_16x16x32_bf16 v[240:243], v[24:27], v[96:99], v[240:243]
    ds_read_b64_tr_b16 v[66:67], v251 offset:2112
    v_mfma_f32_16x16x32_bf16 v[244:247], v[24:27], v[100:103], v[244:247]
    ds_read_b128 v[132:135], v253 offset:2688
    v_mfma_f32_16x16x32_bf16 v[228:231], v[28:31], v[80:83], v[228:231]
    ds_read_b64_tr_b16 v[68:69], v251 offset:2632
    v_mfma_f32_16x16x32_bf16 v[232:235], v[28:31], v[84:87], v[232:235]
    buffer_load_dwordx4 a[196:199], v5, s[52:55], s89 offen offset:1024 sc1
    v_mfma_f32_16x16x32_bf16 v[236:239], v[28:31], v[88:91], v[236:239]
    ds_read_b64_tr_b16 v[70:71], v251 offset:2624
    v_mfma_f32_16x16x32_bf16 v[240:243], v[28:31], v[92:95], v[240:243]
    ds_read_b128 v[136:139], v253 offset:3200
    v_mfma_f32_16x16x32_bf16 v[244:247], v[28:31], v[96:99], v[244:247]
    ds_read_b64_tr_b16 v[72:73], v251 offset:3144
    v_mfma_f32_16x16x32_bf16 v[232:235], v[32:35], v[80:83], v[232:235]
    buffer_load_dwordx4 a[200:203], v5, s[52:55], s89 offen offset:2048 sc1
    v_mfma_f32_16x16x32_bf16 v[236:239], v[32:35], v[84:87], v[236:239]
    ds_read_b64_tr_b16 v[74:75], v251 offset:3136
    v_mfma_f32_16x16x32_bf16 v[240:243], v[32:35], v[88:91], v[240:243]
    ds_read_b128 v[140:143], v253 offset:3712
    v_mfma_f32_16x16x32_bf16 v[244:247], v[32:35], v[92:95], v[244:247]
    ds_read_b64_tr_b16 v[76:77], v251 offset:3656
    v_mfma_f32_16x16x32_bf16 v[236:239], v[36:39], v[80:83], v[236:239]
    buffer_load_dwordx4 a[204:207], v5, s[52:55], s89 offen offset:3072 sc1
    s_add_u32 s89, s89, 4096
    v_mfma_f32_16x16x32_bf16 v[240:243], v[36:39], v[84:87], v[240:243]
    ds_read_b64_tr_b16 v[78:79], v251 offset:3648
    v_mfma_f32_16x16x32_bf16 v[244:247], v[36:39], v[88:91], v[244:247]
    v_mfma_f32_16x16x32_bf16 v[240:243], v[40:43], v[80:83], v[240:243]
    v_mfma_f32_16x16x32_bf16 v[244:247], v[40:43], v[84:87], v[244:247]
    v_mfma_f32_16x16x32_bf16 v[244:247], v[44:47], v[80:83], v[244:247]
    s_waitcnt lgkmcnt(0)
    v_mfma_f32_16x16x32_bf16 v[216:219], v[48:51], v[112:115], v[216:219]
    s_waitcnt vmcnt(8)
    buffer_store_dwordx2 v[248:249], v252, s[52:55], s21 offen sc1
    v_mfma_f32_16x16x32_bf16 v[220:223], v[48:51], v[116:119], v[220:223]
    ds_read_b128 v[80:83], v253 offset:64
    v_mfma_f32_16x16x32_bf16 v[224:227], v[48:51], v[120:123], v[224:227]
    ds_read_b64_tr_b16 v[16:17], v251 offset:136
    v_mfma_f32_16x16x32_bf16 v[228:231], v[48:51], v[124:127], v[228:231]
    buffer_load_dwordx4 a[208:211], v5, s[52:55], s89 offen offset:0 sc1
    v_mfma_f32_16x16x32_bf16 v[232:235], v[48:51], v[128:131], v[232:235]
    ds_read_b64_tr_b16 v[18:19], v251 offset:128
    v_mfma_f32_16x16x32_bf16 v[236:239], v[48:51], v[132:135], v[236:239]
    ds_read_b128 v[84:87], v253 offset:576
    v_mfma_f32_16x16x32_bf16 v[240:243], v[48:51], v[136:139], v[240:243]
    ds_read_b64_tr_b16 v[20:21], v251 offset:648
    v_mfma_f32_16x16x32_bf16 v[244:247], v[48:51], v[140:143], v[244:247]
    ds_read_b64_tr_b16 v[22:23], v251 offset:640
    v_mfma_f32_16x16x32_bf16 v[220:223], v[52:55], v[112:115], v[220:223]
    buffer_load_dwordx4 a[212:215], v5, s[52:55], s89 offen offset:1024 sc1
    v_mfma_f32_16x16x32_bf16 v[224:227], v[52:55], v[116:119], v[224:227]
    ds_read_b128 v[88:91], v253 offset:1088
    v_mfma_f32_16x16x32_bf16 v[228:231], v[52:55], v[120:123], v[228:231]
    ds_read_b64_tr_b16 v[24:25], v251 offset:1160
    v_mfma_f32_16x16x32_bf16 v[232:235], v[52:55], v[124:127], v[232:235]
    ds_read_b64_tr_b16 v[26:27], v251 offset:1152
    v_mfma_f32_16x16x32_bf16 v[236:239], v[52:55], v[128:131], v[236:239]
    buffer_load_dwordx4 a[216:219], v5, s[52:55], s89 offen offset:2048 sc1
    v_mfma_f32_16x16x32_bf16 v[240:243], v[52:55], v[132:135], v[240:243]
    ds_read_b128 v[92:95], v253 offset:1600
    v_mfma_f32_16x16x32_bf16 v[244:247], v[52:55], v[136:139], v[244:247]
    ds_read_b64_tr_b16 v[28:29], v251 offset:1672
    v_mfma_f32_16x16x32_bf16 v[224:227], v[56:59], v[112:115], v[224:227]
    ds_read_b64_tr_b16 v[30:31], v251 offset:1664
    v_mfma_f32_16x16x32_bf16 v[228:231], v[56:59], v[116:119], v[228:231]
    buffer_load_dwordx4 a[220:223], v5, s[52:55], s89 offen offset:3072 sc1
    s_add_u32 s89, s89, 4096
    v_mfma_f32_16x16x32_bf16 v[232:235], v[56:59], v[120:123], v[232:235]
    ds_read_b128 v[96:99], v253 offset:2112
    v_mfma_f32_16x16x32_bf16 v[236:239], v[56:59], v[124:127], v[236:239]
    ds_read_b64_tr_b16 v[32:33], v251 offset:2184
    v_mfma_f32_16x16x32_bf16 v[240:243], v[56:59], v[128:131], v[240:243]
    ds_read_b64_tr_b16 v[34:35], v251 offset:2176
    v_mfma_f32_16x16x32_bf16 v[244:247], v[56:59], v[132:135], v[244:247]
    ds_read_b128 v[100:103], v253 offset:2624
    v_mfma_f32_16x16x32_bf16 v[228:231], v[60:63], v[112:115], v[228:231]
    buffer_load_dwordx4 a[224:227], v5, s[52:55], s89 offen offset:0 sc1
    v_mfma_f32_16x16x32_bf16 v[232:235], v[60:63], v[116:119], v[232:235]
    ds_read_b64_tr_b16 v[36:37], v251 offset:2696
    v_mfma_f32_16x16x32_bf16 v[236:239], v[60:63], v[120:123], v[236:239]
    ds_read_b64_tr_b16 v[38:39], v251 offset:2688
    v_mfma_f32_16x16x32_bf16 v[240:243], v[60:63], v[124:127], v[240:243]
    ds_read_b128 v[104:107], v253 offset:3136
    v_mfma_f32_16x16x32_bf16 v[244:247], v[60:63], v[128:131], v[244:247]
    buffer_load_dwordx4 a[228:231], v5, s[52:55], s89 offen offset:1024 sc1
    v_mfma_f32_16x16x32_bf16 v[232:235], v[64:67], v[112:115], v[232:235]
    ds_read_b64_tr_b16 v[40:41], v251 offset:3208
    v_mfma_f32_16x16x32_bf16 v[236:239], v[64:67], v[116:119], v[236:239]
    ds_read_b64_tr_b16 v[42:43], v251 offset:3200
    v_mfma_f32_16x16x32_bf16 v[240:243], v[64:67], v[120:123], v[240:243]
    ds_read_b128 v[108:111], v253 offset:3648
    v_mfma_f32_16x16x32_bf16 v[244:247], v[64:67], v[124:127], v[244:247]
    ds_read_b64_tr_b16 v[44:45], v251 offset:3720
    v_mfma_f32_16x16x32_bf16 v[236:239], v[68:71], v[112:115], v[236:239]
    buffer_load_dwordx4 a[232:235], v5, s[52:55], s89 offen offset:2048 sc1
    v_mfma_f32_16x16x32_bf16 v[240:243], v[68:71], v[116:119], v[240:243]
    ds_read_b64_tr_b16 v[46:47], v251 offset:3712
    v_mfma_f32_16x16x32_bf16 v[244:247], v[68:71], v[120:123], v[244:247]
    v_mfma_f32_16x16x32_bf16 v[240:243], v[72:75], v[112:115], v[240:243]
    v_mfma_f32_16x16x32_bf16 v[244:247], v[72:75], v[116:119], v[244:247]
    v_mfma_f32_16x16x32_bf16 v[244:247], v[76:79], v[112:115], v[244:247]
    s_waitcnt lgkmcnt(0)
    v_mfma_f32_16x16x32_bf16 v[216:219], v[16:19], v[80:83], v[216:219]
    ds_read_b128 v[112:115], v253 offset:0
    v_mfma_f32_16x16x32_bf16 v[220:223], v[16:19], v[84:87], v[220:223]
    v_mfma_f32_16x16x32_bf16 v[224:227], v[16:19], v[88:91], v[224:227]
    ds_read_b64_tr_b16 v[48:49], v251 offset:200
    v_mfma_f32_16x16x32_bf16 v[228:231], v[16:19], v[92:95], v[228:231]
    buffer_load_dwordx4 a[236:239], v5, s[52:55], s89 offen offset:3072 sc1
    s_add_u32 s89, s89, 4096
    s_mul_i32 s31, s93, 30720
    s_add_u32 s89, s89, s31
    v_mfma_f32_16x16x32_bf16 v[232:235], v[16:19], v[96:99], v[232:235]
    ds_read_b64_tr_b16 v[50:51], v251 offset:192
    v_mfma_f32_16x16x32_bf16 v[236:239], v[16:19], v[100:103], v[236:239]
    ds_read_b128 v[116:119], v253 offset:512
    v_mfma_f32_16x16x32_bf16 v[240:243], v[16:19], v[104:107], v[240:243]
    ds_read_b64_tr_b16 v[52:53], v251 offset:712
    v_mfma_f32_16x16x32_bf16 v[244:247], v[16:19], v[108:111], v[244:247]
    ds_read_b64_tr_b16 v[54:55], v251 offset:704
    v_mfma_f32_16x16x32_bf16 v[220:223], v[20:23], v[80:83], v[220:223]
    buffer_load_dwordx4 v[176:179], v5, s[52:55], s89 offen offset:0 sc1
    v_mfma_f32_16x16x32_bf16 v[224:227], v[20:23], v[84:87], v[224:227]
    ds_read_b128 v[120:123], v253 offset:1024
    v_mfma_f32_16x16x32_bf16 v[228:231], v[20:23], v[88:91], v[228:231]
    ds_read_b64_tr_b16 v[56:57], v251 offset:1224
    v_mfma_f32_16x16x32_bf16 v[232:235], v[20:23], v[92:95], v[232:235]
    ds_read_b64_tr_b16 v[58:59], v251 offset:1216
    v_mfma_f32_16x16x32_bf16 v[236:239], v[20:23], v[96:99], v[236:239]
    buffer_load_dwordx4 v[180:183], v5, s[52:55], s89 offen offset:1024 sc1
    v_mfma_f32_16x16x32_bf16 v[240:243], v[20:23], v[100:103], v[240:243]
    ds_read_b128 v[124:127], v253 offset:1536
    v_mfma_f32_16x16x32_bf16 v[244:247], v[20:23], v[104:107], v[244:247]
    ds_read_b64_tr_b16 v[60:61], v251 offset:1736
    v_mfma_f32_16x16x32_bf16 v[224:227], v[24:27], v[80:83], v[224:227]
    ds_read_b64_tr_b16 v[62:63], v251 offset:1728
    v_mfma_f32_16x16x32_bf16 v[228:231], v[24:27], v[84:87], v[228:231]
    buffer_load_dwordx4 v[184:187], v5, s[52:55], s89 offen offset:2048 sc1
    v_mfma_f32_16x16x32_bf16 v[232:235], v[24:27], v[88:91], v[232:235]
    ds_read_b128 v[128:131], v253 offset:2048
    v_mfma_f32_16x16x32_bf16 v[236:239], v[24:27], v[92:95], v[236:239]
    ds_read_b64_tr_b16 v[64:65], v251 offset:2248
    v_mfma_f32_16x16x32_bf16 v[240:243], v[24:27], v[96:99], v[240:243]
    ds_read_b64_tr_b16 v[66:67], v251 offset:2240
    v_mfma_f32_16x16x32_bf16 v[244:247], v[24:27], v[100:103], v[244:247]
    ds_read_b128 v[132:135], v253 offset:2560
    v_mfma_f32_16x16x32_bf16 v[228:231], v[28:31], v[80:83], v[228:231]
    buffer_load_dwordx4 v[188:191], v5, s[52:55], s89 offen offset:3072 sc1
    s_add_u32 s89, s89, 4096
    v_mfma_f32_16x16x32_bf16 v[232:235], v[28:31], v[84:87], v[232:235]
    ds_read_b64_tr_b16 v[68:69], v251 offset:2760
    v_mfma_f32_16x16x32_bf16 v[236:239], v[28:31], v[88:91], v[236:239]
    ds_read_b64_tr_b16 v[70:71], v251 offset:2752
    v_mfma_f32_16x16x32_bf16 v[240:243], v[28:31], v[92:95], v[240:243]
    ds_read_b128 v[136:139], v253 offset:3072
    v_mfma_f32_16x16x32_bf16 v[244:247], v[28:31], v[96:99], v[244:247]
    buffer_load_dwordx4 v[192:195], v5, s[52:55], s89 offen offset:0 sc1
    v_mfma_f32_16x16x32_bf16 v[232:235], v[32:35], v[80:83], v[232:235]
    ds_read_b64_tr_b16 v[72:73], v251 offset:3272
    v_mfma_f32_16x16x32_bf16 v[236:239], v[32:35], v[84:87], v[236:239]
    ds_read_b64_tr_b16 v[74:75], v251 offset:3264
    v_mfma_f32_16x16x32_bf16 v[240:243], v[32:35], v[88:91], v[240:243]
    ds_read_b128 v[140:143], v253 offset:3584
    v_mfma_f32_16x16x32_bf16 v[244:247], v[32:35], v[92:95], v[244:247]
    ds_read_b64_tr_b16 v[76:77], v251 offset:3784
    v_mfma_f32_16x16x32_bf16 v[236:239], v[36:39], v[80:83], v[236:239]
    buffer_load_dwordx4 v[196:199], v5, s[80:83], s89 offen offset:1024 sc1
    v_mfma_f32_16x16x32_bf16 v[240:243], v[36:39], v[84:87], v[240:243]
    ds_read_b64_tr_b16 v[78:79], v251 offset:3776
    v_mfma_f32_16x16x32_bf16 v[244:247], v[36:39], v[88:91], v[244:247]
    v_mfma_f32_16x16x32_bf16 v[240:243], v[40:43], v[80:83], v[240:243]
    v_mfma_f32_16x16x32_bf16 v[244:247], v[40:43], v[84:87], v[244:247]
    v_mfma_f32_16x16x32_bf16 v[244:247], v[44:47], v[80:83], v[244:247]
    s_waitcnt lgkmcnt(0)
    v_mfma_f32_16x16x32_bf16 v[216:219], v[48:51], v[112:115], v[216:219]
    buffer_load_dwordx4 v[200:203], v5, s[80:83], s89 offen offset:2048 sc1
    v_mfma_f32_16x16x32_bf16 v[220:223], v[48:51], v[116:119], v[220:223]
    buffer_load_dwordx4 v[204:207], v5, s[80:83], s89 offen offset:3072 sc1
    s_add_u32 s89, s89, 4096
    v_mfma_f32_16x16x32_bf16 v[224:227], v[48:51], v[120:123], v[224:227]
    buffer_load_dwordx4 v[208:211], v5, s[80:83], s89 offen offset:0 sc1
    v_mfma_f32_16x16x32_bf16 v[228:231], v[48:51], v[124:127], v[228:231]
    buffer_load_dwordx4 v[212:215], v5, s[80:83], s89 offen offset:1024 sc1
    v_mfma_f32_16x16x32_bf16 v[232:235], v[48:51], v[128:131], v[232:235]
    buffer_load_dwordx2 v[174:175], v250, s[52:55], 0 offen sc1
    v_mfma_f32_16x16x32_bf16 v[236:239], v[48:51], v[132:135], v[236:239]
    s_lshl_b32 s31, s30, 12
    s_add_u32 s31, s31, 81920
    v_mfma_f32_16x16x32_bf16 v[240:243], v[48:51], v[136:139], v[240:243]
    v_add_u32 v254, s31, v5
    v_mfma_f32_16x16x32_bf16 v[244:247], v[48:51], v[140:143], v[244:247]
    v_lshrrev_b32 v14, 1, v0
    v_and_b32 v14, 24, v14
    v_mfma_f32_16x16x32_bf16 v[220:223], v[52:55], v[112:115], v[220:223]
    v_and_b32 v15, 15, v0
    v_lshl_add_u32 v14, v15, 5, v14
    v_mfma_f32_16x16x32_bf16 v[224:227], v[52:55], v[116:119], v[224:227]
    v_add_u32 v14, s1, v14
    v_add_u32 v15, s1, v5
    v_mfma_f32_16x16x32_bf16 v[228:231], v[52:55], v[120:123], v[228:231]
    ds_read_b64 v[16:17], v14 offset:32
    v_mfma_f32_16x16x32_bf16 v[232:235], v[52:55], v[124:127], v[232:235]
    ds_read_b64 v[18:19], v14 offset:544
    v_mfma_f32_16x16x32_bf16 v[236:239], v[52:55], v[128:131], v[236:239]
    ds_read_b64 v[20:21], v14 offset:1056
    v_mfma_f32_16x16x32_bf16 v[240:243], v[52:55], v[132:135], v[240:243]
    ds_read_b64 v[22:23], v14 offset:1568
    v_mfma_f32_16x16x32_bf16 v[244:247], v[52:55], v[136:139], v[244:247]
    s_and_b32 s31, s70, 1
    s_lshl_b32 s31, s31, 4
    v_mfma_f32_16x16x32_bf16 v[224:227], v[56:59], v[112:115], v[224:227]
    s_lshr_b32 s34, s50, s31
    s_lshl_b32 s34, s34, 16
    v_mfma_f32_16x16x32_bf16 v[228:231], v[56:59], v[116:119], v[228:231]
    v_mfma_f32_16x16x32_bf16 v[232:235], v[56:59], v[120:123], v[232:235]
    v_mfma_f32_16x16x32_bf16 v[236:239], v[56:59], v[124:127], v[236:239]
    s_waitcnt lgkmcnt(0)
    v_mfma_f32_16x16x32_bf16 v[240:243], v[56:59], v[128:131], v[240:243]
    v_lshlrev_b32 v24, 16, v16
    v_and_b32 v25, 0xffff0000, v16
    v_mfma_f32_16x16x32_bf16 v[244:247], v[56:59], v[132:135], v[244:247]
    v_lshlrev_b32 v26, 16, v17
    v_and_b32 v27, 0xffff0000, v17
    v_mfma_f32_16x16x32_bf16 v[228:231], v[60:63], v[112:115], v[228:231]
    v_lshlrev_b32 v28, 16, v18
    v_and_b32 v29, 0xffff0000, v18
    v_mfma_f32_16x16x32_bf16 v[232:235], v[60:63], v[116:119], v[232:235]
    v_lshlrev_b32 v30, 16, v19
    v_and_b32 v31, 0xffff0000, v19
    v_mfma_f32_16x16x32_bf16 v[236:239], v[60:63], v[120:123], v[236:239]
    v_lshlrev_b32 v32, 16, v20
    v_and_b32 v33, 0xffff0000, v20
    v_mfma_f32_16x16x32_bf16 v[240:243], v[60:63], v[124:127], v[240:243]
    v_lshlrev_b32 v34, 16, v21
    v_and_b32 v35, 0xffff0000, v21
    v_mfma_f32_16x16x32_bf16 v[244:247], v[60:63], v[128:131], v[244:247]
    v_lshlrev_b32 v36, 16, v22
    v_and_b32 v37, 0xffff0000, v22
    v_mfma_f32_16x16x32_bf16 v[232:235], v[64:67], v[112:115], v[232:235]
    v_lshlrev_b32 v38, 16, v23
    v_and_b32 v39, 0xffff0000, v23
    v_mfma_f32_16x16x32_bf16 v[236:239], v[64:67], v[116:119], v[236:239]
    v_mul_f32 v24, s34, v24
    v_mul_f32 v25, s34, v25
    v_mfma_f32_16x16x32_bf16 v[240:243], v[64:67], v[120:123], v[240:243]
    v_mul_f32 v26, s34, v26
    v_mul_f32 v27, s34, v27
    v_mfma_f32_16x16x32_bf16 v[244:247], v[64:67], v[124:127], v[244:247]
    v_mul_f32 v28, s34, v28
    v_mul_f32 v29, s34, v29
    v_mfma_f32_16x16x32_bf16 v[236:239], v[68:71], v[112:115], v[236:239]
    v_mul_f32 v30, s34, v30
    v_mul_f32 v31, s34, v31
    v_mfma_f32_16x16x32_bf16 v[240:243], v[68:71], v[116:119], v[240:243]
    v_mul_f32 v32, s34, v32
    v_mul_f32 v33, s34, v33
    v_mfma_f32_16x16x32_bf16 v[244:247], v[68:71], v[120:123], v[244:247]
    v_mul_f32 v34, s34, v34
    v_mul_f32 v35, s34, v35
    v_mfma_f32_16x16x32_bf16 v[240:243], v[72:75], v[112:115], v[240:243]
    v_mul_f32 v36, s34, v36
    v_mul_f32 v37, s34, v37
    v_mfma_f32_16x16x32_bf16 v[244:247], v[72:75], v[116:119], v[244:247]
    v_mul_f32 v38, s34, v38
    v_mul_f32 v39, s34, v39
    v_mfma_f32_16x16x32_bf16 v[244:247], v[76:79], v[112:115], v[244:247]
C_e:
    s_waitcnt vmcnt(0)
    v_cmp_ne_u64 vcc, s[16:17], v[174:175]
    s_nop 3
    s_cbranch_vccnz re_h
ok_h:
    buffer_load_dwordx4 v[144:147], v1, s[80:83], s90 offen sc1
    buffer_load_dwordx4 v[148:151], v2, s[80:83], s90 offen sc1
    buffer_load_dwordx4 v[152:155], v3, s[80:83], s90 offen sc1
    buffer_load_dwordx4 v[156:159], v4, s[80:83], s90 offen sc1
    s_sub_u32 s90, s90, 4096
    buffer_load_dwordx4 v[160:163], v1, s[52:55], s90 offen sc1
    buffer_load_dwordx4 v[164:167], v2, s[52:55], s90 offen sc1
    buffer_load_dwordx4 v[168:171], v3, s[52:55], s90 offen sc1
    buffer_load_dwordx4 v[172:175], v4, s[52:55], s90 offen sc1
    s_sub_u32 s90, s90, 4096
    s_mul_i32 s35, s93, -24576
    s_add_u32 s90, s90, s35
    s_cmp_eq_u32 s8, 0
    s_cbranch_scc0 C_hi
    ds_write_b128 v254, v[232:235] offset:0
    ds_write_b128 v254, v[236:239] offset:1024
    ds_write_b128 v254, v[240:243] offset:2048
    ds_write_b128 v254, v[244:247] offset:3072
    v_pk_add_f32 v[24:25], v[24:25], v[216:217]
    v_pk_add_f32 v[26:27], v[26:27], v[218:219]
    v_pk_add_f32 v[28:29], v[28:29], v[220:221]
    v_pk_add_f32 v[30:31], v[30:31], v[222:223]
    v_pk_add_f32 v[32:33], v[32:33], v[224:225]
    v_pk_add_f32 v[34:35], v[34:35], v[226:227]
    v_pk_add_f32 v[36:37], v[36:37], v[228:229]
    v_pk_add_f32 v[38:39], v[38:39], v[230:231]
    s_branch C_x
C_hi:
    ds_write_b128 v254, v[216:219] offset:0
    ds_write_b128 v254, v[220:223] offset:1024
    ds_write_b128 v254, v[224:227] offset:2048
    ds_write_b128 v254, v[228:231] offset:3072
    v_pk_add_f32 v[24:25], v[24:25], v[232:233]
    v_pk_add_f32 v[26:27], v[26:27], v[234:235]
    v_pk_add_f32 v[28:29], v[28:29], v[236:237]
    v_pk_add_f32 v[30:31], v[30:31], v[238:239]
    v_pk_add_f32 v[32:33], v[32:33], v[240:241]
    v_pk_add_f32 v[34:35], v[34:35], v[242:243]
    v_pk_add_f32 v[36:37], v[36:37], v[244:245]
    v_pk_add_f32 v[38:39], v[38:39], v[246:247]
C_x:
    v_xor_b32 v254, 4096, v254
    s_waitcnt lgkmcnt(0)
    s_barrier
    ds_read_b128 v[232:235], v254 offset:0
    ds_read_b128 v[236:239], v254 offset:1024
    ds_read_b128 v[240:243], v254 offset:2048
    ds_read_b128 v[244:247], v254 offset:3072
    buffer_load_dwordx4 v[96:99], v1, s[52:55], s90 offen sc1
    buffer_load_dwordx4 v[100:103], v2, s[52:55], s90 offen sc1
    buffer_load_dwordx4 v[104:107], v3, s[52:55], s90 offen sc1
    buffer_load_dwordx4 v[108:111], v4, s[52:55], s90 offen sc1
    s_sub_u32 s90, s90, 4096
    s_waitcnt lgkmcnt(3)
    v_pk_add_f32 v[24:25], v[24:25], v[232:233]
    v_pk_add_f32 v[26:27], v[26:27], v[234:235]
    v_cvt_pk_bf16_f32 v128, v24, v25
    v_cvt_pk_bf16_f32 v129, v26, v27
    ds_write_b64 v14, v[128:129] offset:16640
    s_waitcnt lgkmcnt(3)
    v_pk_add_f32 v[28:29], v[28:29], v[236:237]
    v_pk_add_f32 v[30:31], v[30:31], v[238:239]
    v_cvt_pk_bf16_f32 v130, v28, v29
    v_cvt_pk_bf16_f32 v131, v30, v31
    ds_write_b64 v14, v[130:131] offset:17152
    s_waitcnt lgkmcnt(3)
    v_pk_add_f32 v[32:33], v[32:33], v[240:241]
    v_pk_add_f32 v[34:35], v[34:35], v[242:243]
    v_cvt_pk_bf16_f32 v132, v32, v33
    v_cvt_pk_bf16_f32 v133, v34, v35
    ds_write_b64 v14, v[132:133] offset:17664
    s_waitcnt lgkmcnt(3)
    v_pk_add_f32 v[36:37], v[36:37], v[244:245]
    v_pk_add_f32 v[38:39], v[38:39], v[246:247]
    v_cvt_pk_bf16_f32 v134, v36, v37
    v_cvt_pk_bf16_f32 v135, v38, v39
    ds_write_b64 v14, v[134:135] offset:18176
    ds_read_b128 v[136:139], v15 offset:16640
    ds_read_b128 v[140:143], v15 offset:17664
    s_waitcnt vmcnt(8)
    v_mfma_f32_16x16x32_bf16 v[16:19], v[196:199], v[144:147], 0
    v_mfma_f32_16x16x32_bf16 v[20:23], v[200:203], v[144:147], 0
    v_mfma_f32_16x16x32_bf16 v[24:27], v[204:207], v[144:147], 0
    v_mfma_f32_16x16x32_bf16 v[28:31], v[208:211], v[144:147], 0
    buffer_load_dwordx4 v[112:115], v1, s[52:55], s90 offen sc1
    v_mfma_f32_16x16x32_bf16 v[32:35], v[212:215], v[144:147], 0
    v_mfma_f32_16x16x32_bf16 v[36:39], v[196:199], v[148:151], 0
    v_mfma_f32_16x16x32_bf16 v[40:43], v[200:203], v[148:151], 0
    v_mfma_f32_16x16x32_bf16 v[44:47], v[204:207], v[148:151], 0
    buffer_load_dwordx4 v[116:119], v2, s[52:55], s90 offen sc1
    v_mfma_f32_16x16x32_bf16 v[48:51], v[208:211], v[148:151], 0
    v_mfma_f32_16x16x32_bf16 v[52:55], v[212:215], v[148:151], 0
    s_waitcnt lgkmcnt(0)
    v_min_u32 v136, -2, v136
    v_mfma_f32_16x16x32_bf16 v[56:59], v[196:199], v[152:155], 0
    v_mfma_f32_16x16x32_bf16 v[60:63], v[200:203], v[152:155], 0
    v_mfma_f32_16x16x32_bf16 v[64:67], v[204:207], v[152:155], 0
    v_min_u32 v140, -2, v140
    buffer_store_dwordx4 v[136:139], v5, s[52:55], s6 offen sc1
    v_mfma_f32_16x16x32_bf16 v[68:71], v[208:211], v[152:155], 0
    v_mfma_f32_16x16x32_bf16 v[72:75], v[212:215], v[152:155], 0
    buffer_load_dwordx4 v[120:123], v3, s[52:55], s90 offen sc1
    v_mfma_f32_16x16x32_bf16 v[76:79], v[196:199], v[156:159], 0
    v_mfma_f32_16x16x32_bf16 v[80:83], v[200:203], v[156:159], 0
    buffer_store_dwordx4 v[140:143], v5, s[52:55], s6 offen offset:1024 sc1
    v_mfma_f32_16x16x32_bf16 v[84:87], v[204:207], v[156:159], 0
    v_mfma_f32_16x16x32_bf16 v[88:91], v[208:211], v[156:159], 0
    buffer_load_dwordx4 v[124:127], v4, s[52:55], s90 offen sc1
    s_sub_u32 s90, s90, 4096
    v_mfma_f32_16x16x32_bf16 v[92:95], v[212:215], v[156:159], 0
    s_waitcnt vmcnt(10)
    v_mfma_f32_16x16x32_bf16 v[16:19], v[176:179], v[160:163], v[16:19]
    buffer_load_dwordx4 v[144:147], v1, s[52:55], s90 offen sc1
    v_mfma_f32_16x16x32_bf16 v[20:23], v[180:183], v[160:163], v[20:23]
    v_mfma_f32_16x16x32_bf16 v[24:27], v[184:187], v[160:163], v[24:27]
    v_mfma_f32_16x16x32_bf16 v[28:31], v[188:191], v[160:163], v[28:31]
    v_mfma_f32_16x16x32_bf16 v[32:35], v[192:195], v[160:163], v[32:35]
    v_mfma_f32_16x16x32_bf16 v[36:39], v[176:179], v[164:167], v[36:39]
    buffer_load_dwordx4 v[148:151], v2, s[52:55], s90 offen sc1
    v_mfma_f32_16x16x32_bf16 v[40:43], v[180:183], v[164:167], v[40:43]
    v_mfma_f32_16x16x32_bf16 v[44:47], v[184:187], v[164:167], v[44:47]
    v_mfma_f32_16x16x32_bf16 v[48:51], v[188:191], v[164:167], v[48:51]
    v_mfma_f32_16x16x32_bf16 v[52:55], v[192:195], v[164:167], v[52:55]
    v_mfma_f32_16x16x32_bf16 v[56:59], v[176:179], v[168:171], v[56:59]
    buffer_load_dwordx4 v[152:155], v3, s[52:55], s90 offen sc1
    v_mfma_f32_16x16x32_bf16 v[60:63], v[180:183], v[168:171], v[60:63]
    v_mfma_f32_16x16x32_bf16 v[64:67], v[184:187], v[168:171], v[64:67]
    v_mfma_f32_16x16x32_bf16 v[68:71], v[188:191], v[168:171], v[68:71]
    v_mfma_f32_16x16x32_bf16 v[72:75], v[192:195], v[168:171], v[72:75]
    v_mfma_f32_16x16x32_bf16 v[76:79], v[176:179], v[172:175], v[76:79]
    buffer_load_dwordx4 v[156:159], v4, s[52:55], s90 offen sc1
    s_sub_u32 s90, s90, 4096
    v_mfma_f32_16x16x32_bf16 v[80:83], v[180:183], v[172:175], v[80:83]
    v_mfma_f32_16x16x32_bf16 v[84:87], v[184:187], v[172:175], v[84:87]
    v_mfma_f32_16x16x32_bf16 v[88:91], v[188:191], v[172:175], v[88:91]
    v_mfma_f32_16x16x32_bf16 v[92:95], v[192:195], v[172:175], v[92:95]
    s_waitcnt vmcnt(10)
    v_mfma_f32_16x16x32_bf16 v[16:19], a[220:223], v[96:99], v[16:19]
    v_mul_u32_u24 v242, 160, v10
    v_lshrrev_b32 v243, 4, v0
    v_mfma_f32_16x16x32_bf16 v[20:23], a[224:227], v[96:99], v[20:23]
    v_mfma_f32_16x16x32_bf16 v[24:27], a[228:231], v[96:99], v[24:27]
    v_lshl_add_u32 v242, v243, 3, v242
    v_add_u32 v242, s88, v242
    v_mfma_f32_16x16x32_bf16 v[28:31], a[232:235], v[96:99], v[28:31]
    v_mfma_f32_16x16x32_bf16 v[32:35], a[236:239], v[96:99], v[32:35]
    buffer_load_dwordx4 v[160:163], v1, s[52:55], s90 offen sc1
    v_mfma_f32_16x16x32_bf16 v[36:39], a[220:223], v[100:103], v[36:39]
    ds_read_b64 v[176:177], v242 offset:0
    v_mfma_f32_16x16x32_bf16 v[40:43], a[224:227], v[100:103], v[40:43]
    v_mfma_f32_16x16x32_bf16 v[44:47], a[228:231], v[100:103], v[44:47]
    ds_read_b64 v[178:179], v242 offset:32
    v_mfma_f32_16x16x32_bf16 v[48:51], a[232:235], v[100:103], v[48:51]
    buffer_load_dwordx4 v[164:167], v2, s[52:55], s90 offen sc1
    v_mfma_f32_16x16x32_bf16 v[52:55], a[236:239], v[100:103], v[52:55]
    v_mfma_f32_16x16x32_bf16 v[56:59], a[220:223], v[104:107], v[56:59]
    ds_read_b64 v[180:181], v242 offset:64
    v_mfma_f32_16x16x32_bf16 v[60:63], a[224:227], v[104:107], v[60:63]
    ds_read_b64 v[182:183], v242 offset:96
    v_mfma_f32_16x16x32_bf16 v[64:67], a[228:231], v[104:107], v[64:67]
    v_mfma_f32_16x16x32_bf16 v[68:71], a[232:235], v[104:107], v[68:71]
    buffer_load_dwordx4 v[168:171], v3, s[52:55], s90 offen sc1
    v_mfma_f32_16x16x32_bf16 v[72:75], a[236:239], v[104:107], v[72:75]
    ds_read_b64 v[184:185], v242 offset:128
    v_mfma_f32_16x16x32_bf16 v[76:79], a[220:223], v[108:111], v[76:79]
    v_mfma_f32_16x16x32_bf16 v[80:83], a[224:227], v[108:111], v[80:83]
    v_and_b32 v240, 0xffff0000, v9
    v_lshlrev_b32 v241, 16, v9
    v_mfma_f32_16x16x32_bf16 v[84:87], a[228:231], v[108:111], v[84:87]
    buffer_load_dwordx4 v[172:175], v4, s[52:55], s90 offen sc1
    s_sub_u32 s90, s90, 4096
    v_mfma_f32_16x16x32_bf16 v[88:91], a[232:235], v[108:111], v[88:91]
    v_mfma_f32_16x16x32_bf16 v[92:95], a[236:239], v[108:111], v[92:95]
    v_rcp_f32 v240, v240
    s_waitcnt vmcnt(8)
    v_mfma_f32_16x16x32_bf16 v[16:19], a[200:203], v[112:115], v[16:19]
    s_waitcnt lgkmcnt(0)
    v_mul_f32 v241, v241, v240
    v_mfma_f32_16x16x32_bf16 v[20:23], a[204:207], v[112:115], v[20:23]
    v_mfma_f32_16x16x32_bf16 v[24:27], a[208:211], v[112:115], v[24:27]
    v_lshlrev_b32 v188, 16, v176
    v_and_b32 v189, 0xffff0000, v176
    v_mfma_f32_16x16x32_bf16 v[28:31], a[212:215], v[112:115], v[28:31]
    buffer_load_dwordx4 v[96:99], v1, s[52:55], s90 offen sc1
    v_mfma_f32_16x16x32_bf16 v[32:35], a[216:219], v[112:115], v[32:35]
    v_lshlrev_b32 v190, 16, v177
    v_and_b32 v191, 0xffff0000, v177
    v_mfma_f32_16x16x32_bf16 v[36:39], a[200:203], v[116:119], v[36:39]
    v_mfma_f32_16x16x32_bf16 v[40:43], a[204:207], v[116:119], v[40:43]
    v_lshlrev_b32 v192, 16, v178
    v_and_b32 v193, 0xffff0000, v178
    v_mfma_f32_16x16x32_bf16 v[44:47], a[208:211], v[116:119], v[44:47]
    v_lshlrev_b32 v194, 16, v179
    v_and_b32 v195, 0xffff0000, v179
    v_mfma_f32_16x16x32_bf16 v[48:51], a[212:215], v[116:119], v[48:51]
    buffer_load_dwordx4 v[100:103], v2, s[52:55], s90 offen sc1
    v_mfma_f32_16x16x32_bf16 v[52:55], a[216:219], v[116:119], v[52:55]
    v_mfma_f32_16x16x32_bf16 v[56:59], a[200:203], v[120:123], v[56:59]
    v_lshlrev_b32 v196, 16, v180
    v_and_b32 v197, 0xffff0000, v180
    v_mfma_f32_16x16x32_bf16 v[60:63], a[204:207], v[120:123], v[60:63]
    v_lshlrev_b32 v198, 16, v181
    v_and_b32 v199, 0xffff0000, v181
    v_mfma_f32_16x16x32_bf16 v[64:67], a[208:211], v[120:123], v[64:67]
    buffer_load_dwordx4 v[104:107], v3, s[52:55], s90 offen sc1
    v_mfma_f32_16x16x32_bf16 v[68:71], a[212:215], v[120:123], v[68:71]
    v_mfma_f32_16x16x32_bf16 v[72:75], a[216:219], v[120:123], v[72:75]
    v_lshlrev_b32 v200, 16, v182
    v_and_b32 v201, 0xffff0000, v182
    v_mfma_f32_16x16x32_bf16 v[76:79], a[200:203], v[124:127], v[76:79]
    v_lshlrev_b32 v202, 16, v183
    v_and_b32 v203, 0xffff0000, v183
    v_mfma_f32_16x16x32_bf16 v[80:83], a[204:207], v[124:127], v[80:83]
    v_lshlrev_b32 v204, 16, v184
    v_and_b32 v205, 0xffff0000, v184
    v_mfma_f32_16x16x32_bf16 v[84:87], a[208:211], v[124:127], v[84:87]
    v_mfma_f32_16x16x32_bf16 v[88:91], a[212:215], v[124:127], v[88:91]
    buffer_load_dwordx4 v[108:111], v4, s[52:55], s90 offen sc1
    s_sub_u32 s90, s90, 4096
    v_mfma_f32_16x16x32_bf16 v[92:95], a[216:219], v[124:127], v[92:95]
    v_lshlrev_b32 v206, 16, v185
    v_and_b32 v207, 0xffff0000, v185
    s_waitcnt vmcnt(8)
    v_mfma_f32_16x16x32_bf16 v[16:19], a[180:183], v[144:147], v[16:19]
    v_fma_f32 v208, v188, v240, -v241
    v_fma_f32 v209, v189, v240, -v241
    v_mfma_f32_16x16x32_bf16 v[20:23], a[184:187], v[144:147], v[20:23]
    v_mfma_f32_16x16x32_bf16 v[24:27], a[188:191], v[144:147], v[24:27]
    v_fma_f32 v210, v190, v240, -v241
    v_fma_f32 v211, v191, v240, -v241
    v_mfma_f32_16x16x32_bf16 v[28:31], a[192:195], v[144:147], v[28:31]
    buffer_load_dwordx4 v[112:115], v1, s[52:55], s90 offen sc1
    v_mfma_f32_16x16x32_bf16 v[32:35], a[196:199], v[144:147], v[32:35]
    v_mfma_f32_16x16x32_bf16 v[36:39], a[180:183], v[148:151], v[36:39]
    v_fma_f32 v212, v192, v240, -v241
    v_fma_f32 v213, v193, v240, -v241
    v_mfma_f32_16x16x32_bf16 v[40:43], a[184:187], v[148:151], v[40:43]
    v_fma_f32 v214, v194, v240, -v241
    v_fma_f32 v215, v195, v240, -v241
    v_mfma_f32_16x16x32_bf16 v[44:47], a[188:191], v[148:151], v[44:47]
    v_mfma_f32_16x16x32_bf16 v[48:51], a[192:195], v[148:151], v[48:51]
    buffer_load_dwordx4 v[116:119], v2, s[52:55], s90 offen sc1
    v_mfma_f32_16x16x32_bf16 v[52:55], a[196:199], v[148:151], v[52:55]
    v_fma_f32 v216, v196, v240, -v241
    v_fma_f32 v217, v197, v240, -v241
    v_mfma_f32_16x16x32_bf16 v[56:59], a[180:183], v[152:155], v[56:59]
    v_fma_f32 v218, v198, v240, -v241
    v_fma_f32 v219, v199, v240, -v241
    v_mfma_f32_16x16x32_bf16 v[60:63], a[184:187], v[152:155], v[60:63]
    v_mfma_f32_16x16x32_bf16 v[64:67], a[188:191], v[152:155], v[64:67]
    v_fma_f32 v220, v200, v240, -v241
    v_fma_f32 v221, v201, v240, -v241
    v_mfma_f32_16x16x32_bf16 v[68:71], a[192:195], v[152:155], v[68:71]
    buffer_load_dwordx4 v[120:123], v3, s[52:55], s90 offen sc1
    v_mfma_f32_16x16x32_bf16 v[72:75], a[196:199], v[152:155], v[72:75]
    v_mfma_f32_16x16x32_bf16 v[76:79], a[180:183], v[156:159], v[76:79]
    v_fma_f32 v222, v202, v240, -v241
    v_fma_f32 v223, v203, v240, -v241
    v_mfma_f32_16x16x32_bf16 v[80:83], a[184:187], v[156:159], v[80:83]
    v_fma_f32 v224, v204, v240, -v241
    v_fma_f32 v225, v205, v240, -v241
    v_mfma_f32_16x16x32_bf16 v[84:87], a[188:191], v[156:159], v[84:87]
    v_mfma_f32_16x16x32_bf16 v[88:91], a[192:195], v[156:159], v[88:91]
    buffer_load_dwordx4 v[124:127], v4, s[52:55], s90 offen sc1
    s_sub_u32 s90, s90, 4096
    s_mul_i32 s35, s93, 49152
    s_add_u32 s90, s90, s35
    v_mfma_f32_16x16x32_bf16 v[92:95], a[196:199], v[156:159], v[92:95]
    v_fma_f32 v226, v206, v240, -v241
    v_fma_f32 v227, v207, v240, -v241
    s_waitcnt vmcnt(8)
    v_mfma_f32_16x16x32_bf16 v[16:19], a[160:163], v[160:163], v[16:19]
    s_xor_b32 s31, s30, 1
    s_mul_i32 s31, s31, 15360
    v_mfma_f32_16x16x32_bf16 v[20:23], a[164:167], v[160:163], v[20:23]
    v_mfma_f32_16x16x32_bf16 v[24:27], a[168:171], v[160:163], v[24:27]
    buffer_load_dwordx4 v[144:147], v1, s[52:55], s90 offen sc1
    v_mfma_f32_16x16x32_bf16 v[28:31], a[172:175], v[160:163], v[28:31]
    v_mfma_f32_16x16x32_bf16 v[32:35], a[176:179], v[160:163], v[32:35]
    s_add_u32 s31, s31, 0
    v_add_u32 v244, s31, v5
    v_mfma_f32_16x16x32_bf16 v[36:39], a[160:163], v[164:167], v[36:39]
    s_xor_b32 s31, s30, 2
    s_mul_i32 s31, s31, 15360
    v_mfma_f32_16x16x32_bf16 v[40:43], a[164:167], v[164:167], v[40:43]
    v_mfma_f32_16x16x32_bf16 v[44:47], a[168:171], v[164:167], v[44:47]
    buffer_load_dwordx4 v[148:151], v2, s[52:55], s90 offen sc1
    v_mfma_f32_16x16x32_bf16 v[48:51], a[172:175], v[164:167], v[48:51]
    v_mfma_f32_16x16x32_bf16 v[52:55], a[176:179], v[164:167], v[52:55]
    s_add_u32 s31, s31, 5120
    v_add_u32 v245, s31, v5
    v_mfma_f32_16x16x32_bf16 v[56:59], a[160:163], v[168:171], v[56:59]
    s_xor_b32 s31, s30, 3
    s_mul_i32 s31, s31, 15360
    v_mfma_f32_16x16x32_bf16 v[60:63], a[164:167], v[168:171], v[60:63]
    v_mfma_f32_16x16x32_bf16 v[64:67], a[168:171], v[168:171], v[64:67]
    buffer_load_dwordx4 v[152:155], v3, s[52:55], s90 offen sc1
    v_mfma_f32_16x16x32_bf16 v[68:71], a[172:175], v[168:171], v[68:71]
    v_mfma_f32_16x16x32_bf16 v[72:75], a[176:179], v[168:171], v[72:75]
    s_add_u32 s31, s31, 10240
    v_add_u32 v250, s31, v5
    v_mfma_f32_16x16x32_bf16 v[76:79], a[160:163], v[172:175], v[76:79]
    v_lshrrev_b32 v243, 3, v0
    v_mul_u32_u24 v243, 160, v243
    v_mfma_f32_16x16x32_bf16 v[80:83], a[164:167], v[172:175], v[80:83]
    v_mfma_f32_16x16x32_bf16 v[84:87], a[168:171], v[172:175], v[84:87]
    buffer_load_dwordx4 v[156:159], v4, s[52:55], s90 offen sc1
    s_sub_u32 s90, s90, 4096
    v_mfma_f32_16x16x32_bf16 v[88:91], a[172:175], v[172:175], v[88:91]
    v_mfma_f32_16x16x32_bf16 v[92:95], a[176:179], v[172:175], v[92:95]
    v_and_b32 v14, 7, v0
    v_lshl_add_u32 v243, v14, 4, v243
    s_waitcnt vmcnt(8)
    v_mfma_f32_16x16x32_bf16 v[16:19], a[140:143], v[96:99], v[16:19]
    s_mul_i32 s31, s30, 3200
    s_add_u32 s31, s31, 61440
    v_mfma_f32_16x16x32_bf16 v[20:23], a[144:147], v[96:99], v[20:23]
    v_mfma_f32_16x16x32_bf16 v[24:27], a[148:151], v[96:99], v[24:27]
    v_add_u32 v243, s31, v243
    s_mul_i32 s31, s30, 15360
    v_mfma_f32_16x16x32_bf16 v[28:31], a[152:155], v[96:99], v[28:31]
    buffer_load_dwordx4 v[160:163], v1, s[52:55], s90 offen sc1
    v_mfma_f32_16x16x32_bf16 v[32:35], a[156:159], v[96:99], v[32:35]
    v_mfma_f32_16x16x32_bf16 v[36:39], a[140:143], v[100:103], v[36:39]
    v_add_u32 v14, s31, v5
    v_lshrrev_b32 v15, 2, v0
    v_mfma_f32_16x16x32_bf16 v[40:43], a[144:147], v[100:103], v[40:43]
    v_mul_u32_u24 v15, 160, v15
    v_and_b32 v251, 3, v0
    v_mfma_f32_16x16x32_bf16 v[44:47], a[148:151], v[100:103], v[44:47]
    v_mfma_f32_16x16x32_bf16 v[48:51], a[152:155], v[100:103], v[48:51]
    buffer_load_dwordx4 v[164:167], v2, s[52:55], s90 offen sc1
    v_mfma_f32_16x16x32_bf16 v[52:55], a[156:159], v[100:103], v[52:55]
    v_lshl_add_u32 v15, v251, 3, v15
    s_lshl_b32 s31, s30, 5
    v_mfma_f32_16x16x32_bf16 v[56:59], a[140:143], v[104:107], v[56:59]
    s_add_u32 s31, s31, 61440
    v_add_u32 v15, s31, v15
    v_mfma_f32_16x16x32_bf16 v[60:63], a[144:147], v[104:107], v[60:63]
    v_mfma_f32_16x16x32_bf16 v[64:67], a[148:151], v[104:107], v[64:67]
    s_mov_b32 s60, s24
    s_mov_b32 s61, s25
    v_mfma_f32_16x16x32_bf16 v[68:71], a[152:155], v[104:107], v[68:71]
    buffer_load_dwordx4 v[168:171], v3, s[52:55], s90 offen sc1
    v_mfma_f32_16x16x32_bf16 v[72:75], a[156:159], v[104:107], v[72:75]
    v_mfma_f32_16x16x32_bf16 v[76:79], a[140:143], v[108:111], v[76:79]
    s_mov_b32 s62, 0x280000
    s_mov_b32 s63, 0x20000
    v_mfma_f32_16x16x32_bf16 v[80:83], a[144:147], v[108:111], v[80:83]
    v_lshrrev_b32 v247, 5, v0
    v_mul_u32_u24 v247, 36864, v247
    v_mfma_f32_16x16x32_bf16 v[84:87], a[148:151], v[108:111], v[84:87]
    v_mfma_f32_16x16x32_bf16 v[88:91], a[152:155], v[108:111], v[88:91]
    buffer_load_dwordx4 v[172:175], v4, s[52:55], s90 offen sc1
    s_sub_u32 s90, s90, 4096
    v_mfma_f32_16x16x32_bf16 v[92:95], a[156:159], v[108:111], v[92:95]
    v_add_u32 v247, v247, v243
    s_waitcnt vmcnt(8)
    v_mfma_f32_16x16x32_bf16 v[16:19], a[120:123], v[112:115], v[16:19]
    buffer_load_dwordx4 v[228:231], v12, s[52:55], s96 offen sc1
    v_mfma_f32_16x16x32_bf16 v[20:23], a[124:127], v[112:115], v[20:23]
    v_mfma_f32_16x16x32_bf16 v[24:27], a[128:131], v[112:115], v[24:27]
    v_mfma_f32_16x16x32_bf16 v[28:31], a[132:135], v[112:115], v[28:31]
    buffer_load_dwordx4 v[232:235], v12, s[52:55], s97 offen sc1
    v_mfma_f32_16x16x32_bf16 v[32:35], a[136:139], v[112:115], v[32:35]
    v_mfma_f32_16x16x32_bf16 v[36:39], a[120:123], v[116:119], v[36:39]
    v_mfma_f32_16x16x32_bf16 v[40:43], a[124:127], v[116:119], v[40:43]
    buffer_load_dwordx4 v[236:239], v13, s[52:55], s0 offen sc1
    v_mfma_f32_16x16x32_bf16 v[44:47], a[128:131], v[116:119], v[44:47]
    v_mfma_f32_16x16x32_bf16 v[48:51], a[132:135], v[116:119], v[48:51]
    v_mfma_f32_16x16x32_bf16 v[52:55], a[136:139], v[116:119], v[52:55]
    buffer_load_dwordx4 v[96:99], v1, s[52:55], s90 offen sc1
    v_mfma_f32_16x16x32_bf16 v[56:59], a[120:123], v[120:123], v[56:59]
    v_mfma_f32_16x16x32_bf16 v[60:63], a[124:127], v[120:123], v[60:63]
    v_mfma_f32_16x16x32_bf16 v[64:67], a[128:131], v[120:123], v[64:67]
    buffer_load_dwordx4 v[100:103], v2, s[52:55], s90 offen sc1
    v_mfma_f32_16x16x32_bf16 v[68:71], a[132:135], v[120:123], v[68:71]
    v_mfma_f32_16x16x32_bf16 v[72:75], a[136:139], v[120:123], v[72:75]
    v_mfma_f32_16x16x32_bf16 v[76:79], a[120:123], v[124:127], v[76:79]
    buffer_load_dwordx4 v[104:107], v3, s[52:55], s90 offen sc1
    v_mfma_f32_16x16x32_bf16 v[80:83], a[124:127], v[124:127], v[80:83]
    v_mfma_f32_16x16x32_bf16 v[84:87], a[128:131], v[124:127], v[84:87]
    v_mfma_f32_16x16x32_bf16 v[88:91], a[132:135], v[124:127], v[88:91]
    buffer_load_dwordx4 v[108:111], v4, s[52:55], s90 offen sc1
    s_sub_u32 s90, s90, 4096
    v_mfma_f32_16x16x32_bf16 v[92:95], a[136:139], v[124:127], v[92:95]
    s_waitcnt vmcnt(11)
    v_mfma_f32_16x16x32_bf16 v[16:19], a[100:103], v[144:147], v[16:19]
    buffer_load_dwordx4 v[112:115], v1, s[52:55], s90 offen sc1
    v_mfma_f32_16x16x32_bf16 v[20:23], a[104:107], v[144:147], v[20:23]
    v_mfma_f32_16x16x32_bf16 v[24:27], a[108:111], v[144:147], v[24:27]
    v_mfma_f32_16x16x32_bf16 v[28:31], a[112:115], v[144:147], v[28:31]
    v_mfma_f32_16x16x32_bf16 v[32:35], a[116:119], v[144:147], v[32:35]
    v_mfma_f32_16x16x32_bf16 v[36:39], a[100:103], v[148:151], v[36:39]
    buffer_load_dwordx4 v[116:119], v2, s[52:55], s90 offen sc1
    v_mfma_f32_16x16x32_bf16 v[40:43], a[104:107], v[148:151], v[40:43]
    v_mfma_f32_16x16x32_bf16 v[44:47], a[108:111], v[148:151], v[44:47]
    v_mfma_f32_16x16x32_bf16 v[48:51], a[112:115], v[148:151], v[48:51]
    v_mfma_f32_16x16x32_bf16 v[52:55], a[116:119], v[148:151], v[52:55]
    v_mfma_f32_16x16x32_bf16 v[56:59], a[100:103], v[152:155], v[56:59]
    buffer_load_dwordx4 v[120:123], v3, s[52:55], s90 offen sc1
    v_mfma_f32_16x16x32_bf16 v[60:63], a[104:107], v[152:155], v[60:63]
    v_mfma_f32_16x16x32_bf16 v[64:67], a[108:111], v[152:155], v[64:67]
    v_mfma_f32_16x16x32_bf16 v[68:71], a[112:115], v[152:155], v[68:71]
    v_mfma_f32_16x16x32_bf16 v[72:75], a[116:119], v[152:155], v[72:75]
    v_mfma_f32_16x16x32_bf16 v[76:79], a[100:103], v[156:159], v[76:79]
    buffer_load_dwordx4 v[124:127], v4, s[52:55], s90 offen sc1
    s_sub_u32 s90, s90, 4096
    v_mfma_f32_16x16x32_bf16 v[80:83], a[104:107], v[156:159], v[80:83]
    v_mfma_f32_16x16x32_bf16 v[84:87], a[108:111], v[156:159], v[84:87]
    v_mfma_f32_16x16x32_bf16 v[88:91], a[112:115], v[156:159], v[88:91]
    v_mfma_f32_16x16x32_bf16 v[92:95], a[116:119], v[156:159], v[92:95]
    s_waitcnt vmcnt(11)
    v_mfma_f32_16x16x32_bf16 v[16:19], a[80:83], v[160:163], v[16:19]
    buffer_load_dwordx4 v[144:147], v1, s[52:55], s90 offen sc1
    v_mfma_f32_16x16x32_bf16 v[20:23], a[84:87], v[160:163], v[20:23]
    v_mfma_f32_16x16x32_bf16 v[24:27], a[88:91], v[160:163], v[24:27]
    v_mfma_f32_16x16x32_bf16 v[28:31], a[92:95], v[160:163], v[28:31]
    v_mfma_f32_16x16x32_bf16 v[32:35], a[96:99], v[160:163], v[32:35]
    v_mfma_f32_16x16x32_bf16 v[36:39], a[80:83], v[164:167], v[36:39]
    buffer_load_dwordx4 v[148:151], v2, s[52:55], s90 offen sc1
    v_mfma_f32_16x16x32_bf16 v[40:43], a[84:87], v[164:167], v[40:43]
    v_mfma_f32_16x16x32_bf16 v[44:47], a[88:91], v[164:167], v[44:47]
    v_mfma_f32_16x16x32_bf16 v[48:51], a[92:95], v[164:167], v[48:51]
    v_mfma_f32_16x16x32_bf16 v[52:55], a[96:99], v[164:167], v[52:55]
    v_mfma_f32_16x16x32_bf16 v[56:59], a[80:83], v[168:171], v[56:59]
    buffer_load_dwordx4 v[152:155], v3, s[52:55], s90 offen sc1
    v_mfma_f32_16x16x32_bf16 v[60:63], a[84:87], v[168:171], v[60:63]
    v_mfma_f32_16x16x32_bf16 v[64:67], a[88:91], v[168:171], v[64:67]
    v_mfma_f32_16x16x32_bf16 v[68:71], a[92:95], v[168:171], v[68:71]
    v_mfma_f32_16x16x32_bf16 v[72:75], a[96:99], v[168:171], v[72:75]
    v_mfma_f32_16x16x32_bf16 v[76:79], a[80:83], v[172:175], v[76:79]
    buffer_load_dwordx4 v[156:159], v4, s[52:55], s90 offen sc1
    s_sub_u32 s90, s90, 4096
    v_mfma_f32_16x16x32_bf16 v[80:83], a[84:87], v[172:175], v[80:83]
    v_mfma_f32_16x16x32_bf16 v[84:87], a[88:91], v[172:175], v[84:87]
    v_mfma_f32_16x16x32_bf16 v[88:91], a[92:95], v[172:175], v[88:91]
    v_mfma_f32_16x16x32_bf16 v[92:95], a[96:99], v[172:175], v[92:95]
    s_waitcnt vmcnt(8)
    v_mfma_f32_16x16x32_bf16 v[16:19], a[60:63], v[96:99], v[16:19]
    buffer_load_dwordx4 v[160:163], v1, s[52:55], s90 offen sc1
    v_mfma_f32_16x16x32_bf16 v[20:23], a[64:67], v[96:99], v[20:23]
    buffer_load_dwordx4 v[164:167], v2, s[52:55], s90 offen sc1
    v_mfma_f32_16x16x32_bf16 v[24:27], a[68:71], v[96:99], v[24:27]
    buffer_load_dwordx4 v[168:171], v3, s[52:55], s90 offen sc1
    v_mfma_f32_16x16x32_bf16 v[28:31], a[72:75], v[96:99], v[28:31]
    buffer_load_dwordx4 v[172:175], v4, s[52:55], s90 offen sc1
    s_sub_u32 s90, s90, 4096
    v_mfma_f32_16x16x32_bf16 v[32:35], a[76:79], v[96:99], v[32:35]
    s_waitcnt vmcnt(16)
    v_max3_u32 v246, v228, v232, v236
    v_mfma_f32_16x16x32_bf16 v[36:39], a[60:63], v[100:103], v[36:39]
    v_cmp_eq_u32 vcc, -1, v246
    v_mfma_f32_16x16x32_bf16 v[40:43], a[64:67], v[100:103], v[40:43]
    v_mfma_f32_16x16x32_bf16 v[44:47], a[68:71], v[100:103], v[44:47]
    s_cbranch_vccnz re_y
ok_y:
    v_mfma_f32_16x16x32_bf16 v[48:51], a[72:75], v[100:103], v[48:51]
    ds_write_b128 v243, v[228:231]
    v_mfma_f32_16x16x32_bf16 v[52:55], a[76:79], v[100:103], v[52:55]
    v_mfma_f32_16x16x32_bf16 v[56:59], a[60:63], v[104:107], v[56:59]
    ds_write_b128 v243, v[232:235] offset:1280
    v_mfma_f32_16x16x32_bf16 v[60:63], a[64:67], v[104:107], v[60:63]
    v_mfma_f32_16x16x32_bf16 v[64:67], a[68:71], v[104:107], v[64:67]
    ds_write_b128 v247, v[236:239] offset:2560
    v_mfma_f32_16x16x32_bf16 v[68:71], a[72:75], v[104:107], v[68:71]
    v_mfma_f32_16x16x32_bf16 v[72:75], a[76:79], v[104:107], v[72:75]
    v_mfma_f32_16x16x32_bf16 v[76:79], a[60:63], v[108:111], v[76:79]
    s_waitcnt lgkmcnt(0)
    s_barrier
    v_mfma_f32_16x16x32_bf16 v[80:83], a[64:67], v[108:111], v[80:83]
    ds_read_b64_tr_b16 v[228:229], v15 offset:0
    v_mfma_f32_16x16x32_bf16 v[84:87], a[68:71], v[108:111], v[84:87]
    ds_read_b64_tr_b16 v[230:231], v15 offset:2560
    v_mfma_f32_16x16x32_bf16 v[88:91], a[72:75], v[108:111], v[88:91]
    ds_read_b64_tr_b16 v[232:233], v15 offset:5120
    v_mfma_f32_16x16x32_bf16 v[92:95], a[76:79], v[108:111], v[92:95]
    ds_read_b64_tr_b16 v[234:235], v15 offset:7680
    ds_read_b64_tr_b16 v[236:237], v15 offset:10240
    s_waitcnt vmcnt(8)
    v_mfma_f32_16x16x32_bf16 v[16:19], a[40:43], v[112:115], v[16:19]
    v_mfma_f32_16x16x32_bf16 v[20:23], a[44:47], v[112:115], v[20:23]
    v_mfma_f32_16x16x32_bf16 v[24:27], a[48:51], v[112:115], v[24:27]
    v_mfma_f32_16x16x32_bf16 v[28:31], a[52:55], v[112:115], v[28:31]
    v_mfma_f32_16x16x32_bf16 v[32:35], a[56:59], v[112:115], v[32:35]
    s_waitcnt lgkmcnt(0)
    v_mfma_f32_16x16x32_bf16 v[36:39], a[40:43], v[116:119], v[36:39]
    v_lshlrev_b32 v128, 16, v228
    v_and_b32 v129, 0xffff0000, v228
    v_mfma_f32_16x16x32_bf16 v[40:43], a[44:47], v[116:119], v[40:43]
    v_mfma_f32_16x16x32_bf16 v[44:47], a[48:51], v[116:119], v[44:47]
    v_fmac_f32 v188, v208, v128
    v_fmac_f32 v189, v209, v129
    v_mfma_f32_16x16x32_bf16 v[48:51], a[52:55], v[116:119], v[48:51]
    v_lshlrev_b32 v130, 16, v229
    v_and_b32 v131, 0xffff0000, v229
    v_mfma_f32_16x16x32_bf16 v[52:55], a[56:59], v[116:119], v[52:55]
    v_mfma_f32_16x16x32_bf16 v[56:59], a[40:43], v[120:123], v[56:59]
    v_fmac_f32 v190, v210, v130
    v_fmac_f32 v191, v211, v131
    v_mfma_f32_16x16x32_bf16 v[60:63], a[44:47], v[120:123], v[60:63]
    v_lshlrev_b32 v132, 16, v230
    v_and_b32 v133, 0xffff0000, v230
    v_mfma_f32_16x16x32_bf16 v[64:67], a[48:51], v[120:123], v[64:67]
    v_mfma_f32_16x16x32_bf16 v[68:71], a[52:55], v[120:123], v[68:71]
    v_fmac_f32 v192, v212, v132
    v_fmac_f32 v193, v213, v133
    v_mfma_f32_16x16x32_bf16 v[72:75], a[56:59], v[120:123], v[72:75]
    v_lshlrev_b32 v134, 16, v231
    v_and_b32 v135, 0xffff0000, v231
    v_mfma_f32_16x16x32_bf16 v[76:79], a[40:43], v[124:127], v[76:79]
    v_mfma_f32_16x16x32_bf16 v[80:83], a[44:47], v[124:127], v[80:83]
    v_fmac_f32 v194, v214, v134
    v_fmac_f32 v195, v215, v135
    v_mfma_f32_16x16x32_bf16 v[84:87], a[48:51], v[124:127], v[84:87]
    v_lshlrev_b32 v128, 16, v232
    v_and_b32 v129, 0xffff0000, v232
    v_mfma_f32_16x16x32_bf16 v[88:91], a[52:55], v[124:127], v[88:91]
    v_mfma_f32_16x16x32_bf16 v[92:95], a[56:59], v[124:127], v[92:95]
    v_fmac_f32 v196, v216, v128
    v_fmac_f32 v197, v217, v129
    s_waitcnt vmcnt(4)
    v_mfma_f32_16x16x32_bf16 v[36:39], a[20:23], v[148:151], v[36:39]
    v_lshlrev_b32 v130, 16, v233
    v_and_b32 v131, 0xffff0000, v233
    v_mfma_f32_16x16x32_bf16 v[40:43], a[24:27], v[148:151], v[40:43]
    v_fmac_f32 v198, v218, v130
    v_fmac_f32 v199, v219, v131
    v_mfma_f32_16x16x32_bf16 v[44:47], a[28:31], v[148:151], v[44:47]
    v_lshlrev_b32 v132, 16, v234
    v_and_b32 v133, 0xffff0000, v234
    v_mfma_f32_16x16x32_bf16 v[48:51], a[32:35], v[148:151], v[48:51]
    v_fmac_f32 v200, v220, v132
    v_fmac_f32 v201, v221, v133
    v_mfma_f32_16x16x32_bf16 v[52:55], a[36:39], v[148:151], v[52:55]
    v_lshlrev_b32 v134, 16, v235
    v_and_b32 v135, 0xffff0000, v235
    s_waitcnt vmcnt(0)
    v_mfma_f32_16x16x32_bf16 v[36:39], a[0:3], v[164:167], v[36:39]
    v_fmac_f32 v202, v222, v134
    v_fmac_f32 v203, v223, v135
    v_mfma_f32_16x16x32_bf16 v[40:43], a[4:7], v[164:167], v[40:43]
    v_mfma_f32_16x16x32_bf16 v[44:47], a[8:11], v[164:167], v[44:47]
    v_lshlrev_b32 v128, 16, v236
    v_and_b32 v129, 0xffff0000, v236
    v_mfma_f32_16x16x32_bf16 v[48:51], a[12:15], v[164:167], v[48:51]
    v_mfma_f32_16x16x32_bf16 v[52:55], a[16:19], v[164:167], v[52:55]
    v_fmac_f32 v204, v224, v128
    v_fmac_f32 v205, v225, v129
    v_mfma_f32_16x16x32_bf16 v[56:59], a[20:23], v[152:155], v[56:59]
    v_lshlrev_b32 v130, 16, v237
    v_and_b32 v131, 0xffff0000, v237
    v_mfma_f32_16x16x32_bf16 v[60:63], a[24:27], v[152:155], v[60:63]
    v_mfma_f32_16x16x32_bf16 v[64:67], a[28:31], v[152:155], v[64:67]
    v_fmac_f32 v206, v226, v130
    v_fmac_f32 v207, v227, v131
    v_mfma_f32_16x16x32_bf16 v[68:71], a[32:35], v[152:155], v[68:71]
    ds_write_b128 v244, v[36:39] offset:0
    v_mfma_f32_16x16x32_bf16 v[72:75], a[36:39], v[152:155], v[72:75]
    v_mfma_f32_16x16x32_bf16 v[56:59], a[0:3], v[168:171], v[56:59]
    ds_write_b128 v244, v[40:43] offset:1024
    v_mfma_f32_16x16x32_bf16 v[60:63], a[4:7], v[168:171], v[60:63]
    v_mfma_f32_16x16x32_bf16 v[64:67], a[8:11], v[168:171], v[64:67]
    ds_write_b128 v244, v[44:47] offset:2048
    v_mfma_f32_16x16x32_bf16 v[68:71], a[12:15], v[168:171], v[68:71]
    v_mfma_f32_16x16x32_bf16 v[72:75], a[16:19], v[168:171], v[72:75]
    ds_write_b128 v244, v[48:51] offset:3072
    v_mfma_f32_16x16x32_bf16 v[76:79], a[20:23], v[156:159], v[76:79]
    v_mfma_f32_16x16x32_bf16 v[80:83], a[24:27], v[156:159], v[80:83]
    ds_write_b128 v244, v[52:55] offset:4096
    v_mfma_f32_16x16x32_bf16 v[84:87], a[28:31], v[156:159], v[84:87]
    v_mfma_f32_16x16x32_bf16 v[88:91], a[32:35], v[156:159], v[88:91]
    ds_write_b128 v245, v[56:59] offset:0
    v_mfma_f32_16x16x32_bf16 v[92:95], a[36:39], v[156:159], v[92:95]
    v_mfma_f32_16x16x32_bf16 v[76:79], a[0:3], v[172:175], v[76:79]
    ds_write_b128 v245, v[60:63] offset:1024
    v_mfma_f32_16x16x32_bf16 v[80:83], a[4:7], v[172:175], v[80:83]
    v_mfma_f32_16x16x32_bf16 v[84:87], a[8:11], v[172:175], v[84:87]
    ds_write_b128 v245, v[64:67] offset:2048
    v_mfma_f32_16x16x32_bf16 v[88:91], a[12:15], v[172:175], v[88:91]
    v_mfma_f32_16x16x32_bf16 v[92:95], a[16:19], v[172:175], v[92:95]
    ds_write_b128 v245, v[68:71] offset:3072
    v_mfma_f32_16x16x32_bf16 v[16:19], a[20:23], v[144:147], v[16:19]
    v_mfma_f32_16x16x32_bf16 v[20:23], a[24:27], v[144:147], v[20:23]
    ds_write_b128 v245, v[72:75] offset:4096
    v_mfma_f32_16x16x32_bf16 v[24:27], a[28:31], v[144:147], v[24:27]
    v_mfma_f32_16x16x32_bf16 v[28:31], a[32:35], v[144:147], v[28:31]
    ds_write_b128 v250, v[76:79] offset:0
    v_mfma_f32_16x16x32_bf16 v[32:35], a[36:39], v[144:147], v[32:35]
    v_mfma_f32_16x16x32_bf16 v[16:19], a[0:3], v[160:163], v[16:19]
    ds_write_b128 v250, v[80:83] offset:1024
    v_mfma_f32_16x16x32_bf16 v[20:23], a[4:7], v[160:163], v[20:23]
    v_mfma_f32_16x16x32_bf16 v[24:27], a[8:11], v[160:163], v[24:27]
    ds_write_b128 v250, v[84:87] offset:2048
    v_mfma_f32_16x16x32_bf16 v[28:31], a[12:15], v[160:163], v[28:31]
    v_mfma_f32_16x16x32_bf16 v[32:35], a[16:19], v[160:163], v[32:35]
    ds_write_b128 v250, v[88:91] offset:3072
    ds_write_b128 v250, v[92:95] offset:4096
    s_nop 4
    v_pk_add_f32 v[188:189], v[188:189], v[16:17]
    v_pk_add_f32 v[190:191], v[190:191], v[18:19]
    v_pk_add_f32 v[192:193], v[192:193], v[20:21]
    v_pk_add_f32 v[194:195], v[194:195], v[22:23]
    v_pk_add_f32 v[196:197], v[196:197], v[24:25]
    v_pk_add_f32 v[198:199], v[198:199], v[26:27]
    v_pk_add_f32 v[200:201], v[200:201], v[28:29]
    v_pk_add_f32 v[202:203], v[202:203], v[30:31]
    v_pk_add_f32 v[204:205], v[204:205], v[32:33]
    v_pk_add_f32 v[206:207], v[206:207], v[34:35]
    s_waitcnt lgkmcnt(0)
    s_barrier
    ds_read_b128 v[96:99], v14 offset:0
    ds_read_b128 v[100:103], v14 offset:5120
    ds_read_b128 v[104:107], v14 offset:10240
    ds_read_b128 v[108:111], v14 offset:1024
    ds_read_b128 v[112:115], v14 offset:6144
    ds_read_b128 v[116:119], v14 offset:11264
    ds_read_b128 v[120:123], v14 offset:2048
    ds_read_b128 v[124:127], v14 offset:7168
    ds_read_b128 v[128:131], v14 offset:12288
    ds_read_b128 v[132:135], v14 offset:3072
    ds_read_b128 v[136:139], v14 offset:8192
    ds_read_b128 v[140:143], v14 offset:13312
    ds_read_b128 v[144:147], v14 offset:4096
    ds_read_b128 v[148:151], v14 offset:9216
    ds_read_b128 v[152:155], v14 offset:14336
    v_add_u32 v14, s88, v5
    s_waitcnt lgkmcnt(12)
    v_pk_add_f32 v[96:97], v[96:97], v[100:101]
    v_pk_add_f32 v[98:99], v[98:99], v[102:103]
    v_pk_add_f32 v[188:189], v[188:189], v[104:105]
    v_pk_add_f32 v[190:191], v[190:191], v[106:107]
    v_pk_add_f32 v[188:189], v[188:189], v[96:97]
    v_pk_add_f32 v[190:191], v[190:191], v[98:99]
    v_cvt_pk_bf16_f32 v176, v188, v189
    v_cvt_pk_bf16_f32 v177, v190, v191
    ds_write_b64 v242, v[176:177] offset:0
    s_waitcnt lgkmcnt(10)
    v_pk_add_f32 v[108:109], v[108:109], v[112:113]
    v_pk_add_f32 v[110:111], v[110:111], v[114:115]
    v_pk_add_f32 v[192:193], v[192:193], v[116:117]
    v_pk_add_f32 v[194:195], v[194:195], v[118:119]
    v_pk_add_f32 v[192:193], v[192:193], v[108:109]
    v_pk_add_f32 v[194:195], v[194:195], v[110:111]
    v_cvt_pk_bf16_f32 v178, v192, v193
    v_cvt_pk_bf16_f32 v179, v194, v195
    ds_write_b64 v242, v[178:179] offset:32
    s_waitcnt lgkmcnt(8)
    v_pk_add_f32 v[120:121], v[120:121], v[124:125]
    v_pk_add_f32 v[122:123], v[122:123], v[126:127]
    v_pk_add_f32 v[196:197], v[196:197], v[128:129]
    v_pk_add_f32 v[198:199], v[198:199], v[130:131]
    v_pk_add_f32 v[196:197], v[196:197], v[120:121]
    v_pk_add_f32 v[198:199], v[198:199], v[122:123]
    v_cvt_pk_bf16_f32 v180, v196, v197
    v_cvt_pk_bf16_f32 v181, v198, v199
    ds_write_b64 v242, v[180:181] offset:64
    s_waitcnt lgkmcnt(6)
    v_pk_add_f32 v[132:133], v[132:133], v[136:137]
    v_pk_add_f32 v[134:135], v[134:135], v[138:139]
    v_pk_add_f32 v[200:201], v[200:201], v[140:141]
    v_pk_add_f32 v[202:203], v[202:203], v[142:143]
    v_pk_add_f32 v[200:201], v[200:201], v[132:133]
    v_pk_add_f32 v[202:203], v[202:203], v[134:135]
    v_cvt_pk_bf16_f32 v182, v200, v201
    v_cvt_pk_bf16_f32 v183, v202, v203
    ds_write_b64 v242, v[182:183] offset:96
    s_waitcnt lgkmcnt(4)
    v_pk_add_f32 v[144:145], v[144:145], v[148:149]
    v_pk_add_f32 v[146:147], v[146:147], v[150:151]
    v_pk_add_f32 v[204:205], v[204:205], v[152:153]
    v_pk_add_f32 v[206:207], v[206:207], v[154:155]
    v_pk_add_f32 v[204:205], v[204:205], v[144:145]
    v_pk_add_f32 v[206:207], v[206:207], v[146:147]
    v_cvt_pk_bf16_f32 v184, v204, v205
    v_cvt_pk_bf16_f32 v185, v206, v207
    ds_write_b64 v242, v[184:185] offset:128
    ds_read_b128 v[96:99], v14 offset:0
    ds_read_b128 v[100:103], v14 offset:1024
    ds_read_b128 v[104:107], v14 offset:2048
    s_waitcnt lgkmcnt(2)
    buffer_store_dwordx4 v[96:99], v6, s[60:63], s94 offen
    s_waitcnt lgkmcnt(1)
    buffer_store_dwordx4 v[100:103], v7, s[60:63], s94 offen
    s_waitcnt lgkmcnt(0)
    buffer_store_dwordx4 v[104:107], v8, s[60:63], s94 offen
    s_endpgm
L_helper:
    s_mul_i32 s35, s35, 20
    s_lshl_b32 s36, s36, 2
    s_add_u32 s32, s35, s36
    s_add_u32 s32, s32, s34
    s_lshl_b32 s33, s32, 2
    s_add_u32 s33, s33, s30
    v_lshrrev_b32 v1, 4, v0
    v_and_b32 v2, 15, v0
    s_mul_i32 s39, s32, 52
    s_lshr_b32 s39, s39, 8
    s_mul_i32 s31, s39, 5
    s_sub_u32 s78, s32, s31
    s_lshl_b32 s77, s32, 7
    s_lshl_b32 s39, s39, 8
    s_lshl_b32 s31, s30, 6
    s_add_u32 s39, s39, s31
    v_lshlrev_b32 v3, 4, v1
    v_add_u32 v3, s39, v3
    v_mul_u32_u24 v6, 1280, v3
    v_lshl_add_u32 v6, v2, 4, v6
    s_lshl_b32 s31, s78, 8
    v_add_u32 v6, s31, v6
    v_lshlrev_b32 v7, 6, v2
    s_waitcnt lgkmcnt(0)
    s_mov_b32 s44, s6
    s_mov_b32 s45, s7
    s_mov_b32 s46, 0x280000
    s_mov_b32 s47, 0x20000
    s_mov_b32 s60, s8
    s_mov_b32 s61, s9
    s_mov_b32 s62, 0x280000
    s_mov_b32 s63, 0x20000
    v_add_u32 v12, -3840, v6
    buffer_load_dwordx4 v[16:19], v12, s[44:47], 0 offen
    v_add_u32 v12, -2560, v6
    buffer_load_dwordx4 v[20:23], v12, s[44:47], 0 offen
    v_add_u32 v12, -1280, v6
    buffer_load_dwordx4 v[24:27], v12, s[44:47], 0 offen
    s_mov_b32 s64, s10
    s_mov_b32 s65, s11
    s_mov_b32 s66, 0x1400
    s_mov_b32 s67, 0x20000
    s_mov_b32 s56, s26
    s_mov_b32 s57, s27
    s_mov_b32 s58, 0x100
    s_mov_b32 s59, 0x20000
    s_cmp_lg_u32 s33, 0
    s_cbranch_scc1 H_nonon
    s_memrealtime s[34:35]
    v_lshlrev_b32 v8, 20, v0
    s_waitcnt lgkmcnt(0)
    s_or_b32 s34, s34, 1
    v_mov_b32 v252, s34
    v_mov_b32 v253, s35
    buffer_store_dwordx2 v[252:253], v8, s[56:59], 0 offen sc1
H_nonon:
    s_lshl_b32 s31, s78, 10
    buffer_load_dwordx4 v[178:181], v7, s[64:67], s31 offen offset:0
    buffer_load_dwordx4 v[182:185], v7, s[64:67], s31 offen offset:16
    buffer_load_dwordx4 v[186:189], v7, s[64:67], s31 offen offset:32
    buffer_load_dwordx4 v[190:193], v7, s[64:67], s31 offen offset:48
    s_mov_b32 s40, s4
    s_mov_b32 s41, s5
    s_mov_b32 s42, 0x280000
    s_mov_b32 s43, 0x20000
    s_mov_b32 s52, s28
    s_mov_b32 s53, s29
    s_mov_b32 s54, 0x1053000
    s_mov_b32 s55, 0x20000
    s_and_b32 s8, s30, 1
    s_lshr_b32 s37, s30, 1
    s_lshl_b32 s34, s32, 1
    s_add_u32 s34, s34, s37
    s_add_u32 s70, s34, 432
    s_add_u32 s9, s33, 512
    s_min_u32 s9, s9, 639
    s_mul_i32 s31, s37, 21248
    s_add_u32 s71, s31, 98304
    s_mul_i32 s10, s30, 21248
    s_lshl_b32 s31, s70, 1
    s_add_u32 s31, s31, s8
    s_lshl_b32 s31, s31, 11
    s_add_u32 s6, s31, 0xd00000
    v_accvgpr_write_b32 a236, -1
    v_accvgpr_write_b32 a237, -1
    v_accvgpr_write_b32 a238, -1
    v_accvgpr_write_b32 a239, -1
    s_lshl_b32 s33, s9, 12
    s_add_u32 s33, s33, 0xd00000
    s_cmp_lt_u32 s32, 32
    s_cselect_b32 s31, 0, 0x40000000
    v_add_u32 v13, s31, v5
    s_lshr_b32 s31, s70, 1
    s_lshl_b32 s31, s31, 2
    s_load_dword s50, s[14:15], s31
    s_lshr_b32 s31, s9, 1
    s_lshl_b32 s31, s31, 2
    s_load_dword s7, s[14:15], s31
    v_lshlrev_b32 v3, 1, v1
    v_and_b32 v4, 7, v2
    v_xor_b32 v3, v3, v4
    v_lshlrev_b32 v9, 7, v2
    v_lshl_add_u32 v9, v3, 4, v9
    v_add_u32 v9, s10, v9
    v_lshrrev_b32 v3, 3, v0
    v_and_b32 v4, 7, v0
    v_xor_b32 v10, v3, v4
    v_lshlrev_b32 v10, 4, v10
    v_lshl_add_u32 v10, v3, 7, v10
    v_add_u32 v10, s10, v10
    v_lshlrev_b32 v7, 15, v3
    v_lshl_add_u32 v7, v4, 4, v7
    s_lshl_b32 s36, s78, 19
    s_lshl_b32 s39, s39, 1
    s_add_u32 s36, s36, s39
    s_add_u32 s36, s36, 0xa00000
    v_mov_b32 v15, 0
    v_add_u32 v12, 0, v6
    buffer_load_dwordx4 v[28:31], v12, s[44:47], 0 offen
    v_add_u32 v12, 1280, v6
    buffer_load_dwordx4 v[32:35], v12, s[44:47], 0 offen
    v_add_u32 v12, 2560, v6
    buffer_load_dwordx4 v[36:39], v12, s[44:47], 0 offen
    v_add_u32 v12, 3840, v6
    buffer_load_dwordx4 v[40:43], v12, s[44:47], 0 offen
    v_add_u32 v12, 5120, v6
    buffer_load_dwordx4 v[44:47], v12, s[44:47], 0 offen
    v_add_u32 v12, 6400, v6
    buffer_load_dwordx4 v[48:51], v12, s[44:47], 0 offen
    v_add_u32 v12, 7680, v6
    buffer_load_dwordx4 v[52:55], v12, s[44:47], 0 offen
    s_waitcnt vmcnt(7)
    v_lshlrev_b32 v124, 16, v178
    v_and_b32 v126, 0xffff0000, v178
    v_lshlrev_b32 v128, 16, v179
    v_and_b32 v130, 0xffff0000, v179
    v_lshlrev_b32 v125, 16, v180
    v_and_b32 v127, 0xffff0000, v180
    v_lshlrev_b32 v129, 16, v181
    v_and_b32 v131, 0xffff0000, v181
    v_lshlrev_b32 v132, 16, v182
    v_and_b32 v134, 0xffff0000, v182
    v_lshlrev_b32 v136, 16, v183
    v_and_b32 v138, 0xffff0000, v183
    v_lshlrev_b32 v133, 16, v184
    v_and_b32 v135, 0xffff0000, v184
    v_lshlrev_b32 v137, 16, v185
    v_and_b32 v139, 0xffff0000, v185
    v_lshlrev_b32 v140, 16, v186
    v_and_b32 v142, 0xffff0000, v186
    v_lshlrev_b32 v144, 16, v187
    v_and_b32 v146, 0xffff0000, v187
    v_lshlrev_b32 v141, 16, v188
    v_and_b32 v143, 0xffff0000, v188
    v_lshlrev_b32 v145, 16, v189
    v_and_b32 v147, 0xffff0000, v189
    v_lshlrev_b32 v148, 16, v190
    v_and_b32 v150, 0xffff0000, v190
    v_lshlrev_b32 v152, 16, v191
    v_and_b32 v154, 0xffff0000, v191
    v_lshlrev_b32 v149, 16, v192
    v_and_b32 v151, 0xffff0000, v192
    v_lshlrev_b32 v153, 16, v193
    v_and_b32 v155, 0xffff0000, v193
    v_add_u32 v12, 8960, v6
    buffer_load_dwordx4 v[56:59], v12, s[44:47], 0 offen
    v_add_u32 v12, 0, v6
    buffer_load_dwordx4 v[92:95], v12, s[60:63], 0 offen
    v_add_u32 v12, 1280, v6
    buffer_load_dwordx4 v[96:99], v12, s[60:63], 0 offen
    v_add_u32 v12, 2560, v6
    buffer_load_dwordx4 v[100:103], v12, s[60:63], 0 offen
    v_add_u32 v12, 3840, v6
    buffer_load_dwordx4 v[104:107], v12, s[60:63], 0 offen
    v_add_u32 v12, 5120, v6
    buffer_load_dwordx4 v[108:111], v12, s[60:63], 0 offen
    v_add_u32 v12, 6400, v6
    buffer_load_dwordx4 v[112:115], v12, s[60:63], 0 offen
    s_waitcnt vmcnt(6)
    v_lshlrev_b32 v156, 16, v16
    v_add_u32 v12, 7680, v6
    buffer_load_dwordx4 v[116:119], v12, s[60:63], 0 offen
    v_and_b32 v157, 0xffff0000, v16
    v_lshlrev_b32 v158, 16, v20
    v_and_b32 v159, 0xffff0000, v20
    v_lshlrev_b32 v160, 16, v24
    v_and_b32 v161, 0xffff0000, v24
    v_lshlrev_b32 v162, 16, v28
    v_and_b32 v163, 0xffff0000, v28
    v_lshlrev_b32 v164, 16, v32
    v_and_b32 v165, 0xffff0000, v32
    v_lshlrev_b32 v166, 16, v36
    v_and_b32 v167, 0xffff0000, v36
    v_lshlrev_b32 v168, 16, v40
    v_and_b32 v169, 0xffff0000, v40
    v_lshlrev_b32 v170, 16, v44
    v_and_b32 v171, 0xffff0000, v44
    v_lshlrev_b32 v172, 16, v48
    v_and_b32 v173, 0xffff0000, v48
    v_lshlrev_b32 v174, 16, v52
    v_and_b32 v175, 0xffff0000, v52
    v_lshlrev_b32 v176, 16, v56
    v_and_b32 v177, 0xffff0000, v56
    v_pk_mul_f32 v[178:179], v[130:131], v[156:157]
    v_pk_mul_f32 v[180:181], v[130:131], v[158:159]
    v_pk_mul_f32 v[182:183], v[130:131], v[160:161]
    v_pk_mul_f32 v[184:185], v[130:131], v[162:163]
    v_pk_mul_f32 v[186:187], v[130:131], v[164:165]
    v_pk_mul_f32 v[188:189], v[130:131], v[166:167]
    v_add_u32 v12, 8960, v6
    buffer_load_dwordx4 v[120:123], v12, s[60:63], 0 offen
    v_pk_mul_f32 v[190:191], v[130:131], v[168:169]
    v_pk_mul_f32 v[192:193], v[130:131], v[170:171]
    v_pk_fma_f32 v[178:179], v[128:129], v[158:159], v[178:179]
    v_pk_fma_f32 v[180:181], v[128:129], v[160:161], v[180:181]
    v_pk_fma_f32 v[182:183], v[128:129], v[162:163], v[182:183]
    v_pk_fma_f32 v[184:185], v[128:129], v[164:165], v[184:185]
    v_pk_fma_f32 v[186:187], v[128:129], v[166:167], v[186:187]
    v_pk_fma_f32 v[188:189], v[128:129], v[168:169], v[188:189]
    v_pk_fma_f32 v[190:191], v[128:129], v[170:171], v[190:191]
    v_pk_fma_f32 v[192:193], v[128:129], v[172:173], v[192:193]
    v_pk_fma_f32 v[178:179], v[126:127], v[160:161], v[178:179]
    v_pk_fma_f32 v[180:181], v[126:127], v[162:163], v[180:181]
    v_pk_fma_f32 v[182:183], v[126:127], v[164:165], v[182:183]
    v_pk_fma_f32 v[184:185], v[126:127], v[166:167], v[184:185]
    v_pk_fma_f32 v[186:187], v[126:127], v[168:169], v[186:187]
    v_pk_fma_f32 v[188:189], v[126:127], v[170:171], v[188:189]
    v_pk_fma_f32 v[190:191], v[126:127], v[172:173], v[190:191]
    v_pk_fma_f32 v[192:193], v[126:127], v[174:175], v[192:193]
    v_pk_fma_f32 v[178:179], v[124:125], v[162:163], v[178:179]
    v_pk_fma_f32 v[180:181], v[124:125], v[164:165], v[180:181]
    v_pk_fma_f32 v[182:183], v[124:125], v[166:167], v[182:183]
    v_pk_fma_f32 v[184:185], v[124:125], v[168:169], v[184:185]
    v_pk_fma_f32 v[186:187], v[124:125], v[170:171], v[186:187]
    v_pk_fma_f32 v[188:189], v[124:125], v[172:173], v[188:189]
    v_pk_fma_f32 v[190:191], v[124:125], v[174:175], v[190:191]
    v_pk_fma_f32 v[192:193], v[124:125], v[176:177], v[192:193]
    v_lshlrev_b32 v156, 16, v17
    v_add_u32 v12, 10240, v6
    buffer_load_dwordx4 v[60:63], v12, s[44:47], 0 offen
    v_and_b32 v157, 0xffff0000, v17
    v_lshlrev_b32 v158, 16, v21
    v_and_b32 v159, 0xffff0000, v21
    v_lshlrev_b32 v160, 16, v25
    v_and_b32 v161, 0xffff0000, v25
    v_lshlrev_b32 v162, 16, v29
    v_and_b32 v163, 0xffff0000, v29
    v_lshlrev_b32 v164, 16, v33
    v_and_b32 v165, 0xffff0000, v33
    v_lshlrev_b32 v166, 16, v37
    v_and_b32 v167, 0xffff0000, v37
    v_lshlrev_b32 v168, 16, v41
    v_and_b32 v169, 0xffff0000, v41
    v_lshlrev_b32 v170, 16, v45
    v_and_b32 v171, 0xffff0000, v45
    v_lshlrev_b32 v172, 16, v49
    v_and_b32 v173, 0xffff0000, v49
    v_lshlrev_b32 v174, 16, v53
    v_and_b32 v175, 0xffff0000, v53
    v_lshlrev_b32 v176, 16, v57
    v_and_b32 v177, 0xffff0000, v57
    v_pk_mul_f32 v[194:195], v[138:139], v[156:157]
    v_pk_mul_f32 v[196:197], v[138:139], v[158:159]
    v_pk_mul_f32 v[198:199], v[138:139], v[160:161]
    v_pk_mul_f32 v[200:201], v[138:139], v[162:163]
    v_pk_mul_f32 v[202:203], v[138:139], v[164:165]
    v_pk_mul_f32 v[204:205], v[138:139], v[166:167]
    v_add_u32 v12, 11520, v6
    buffer_load_dwordx4 v[64:67], v12, s[44:47], 0 offen
    v_pk_mul_f32 v[206:207], v[138:139], v[168:169]
    v_pk_mul_f32 v[208:209], v[138:139], v[170:171]
    v_pk_fma_f32 v[194:195], v[136:137], v[158:159], v[194:195]
    v_pk_fma_f32 v[196:197], v[136:137], v[160:161], v[196:197]
    v_pk_fma_f32 v[198:199], v[136:137], v[162:163], v[198:199]
    v_pk_fma_f32 v[200:201], v[136:137], v[164:165], v[200:201]
    v_pk_fma_f32 v[202:203], v[136:137], v[166:167], v[202:203]
    v_pk_fma_f32 v[204:205], v[136:137], v[168:169], v[204:205]
    v_pk_fma_f32 v[206:207], v[136:137], v[170:171], v[206:207]
    v_pk_fma_f32 v[208:209], v[136:137], v[172:173], v[208:209]
    v_pk_fma_f32 v[194:195], v[134:135], v[160:161], v[194:195]
    v_pk_fma_f32 v[196:197], v[134:135], v[162:163], v[196:197]
    v_pk_fma_f32 v[198:199], v[134:135], v[164:165], v[198:199]
    v_pk_fma_f32 v[200:201], v[134:135], v[166:167], v[200:201]
    v_pk_fma_f32 v[202:203], v[134:135], v[168:169], v[202:203]
    v_pk_fma_f32 v[204:205], v[134:135], v[170:171], v[204:205]
    v_pk_fma_f32 v[206:207], v[134:135], v[172:173], v[206:207]
    v_pk_fma_f32 v[208:209], v[134:135], v[174:175], v[208:209]
    v_pk_fma_f32 v[194:195], v[132:133], v[162:163], v[194:195]
    v_pk_fma_f32 v[196:197], v[132:133], v[164:165], v[196:197]
    v_pk_fma_f32 v[198:199], v[132:133], v[166:167], v[198:199]
    v_pk_fma_f32 v[200:201], v[132:133], v[168:169], v[200:201]
    v_pk_fma_f32 v[202:203], v[132:133], v[170:171], v[202:203]
    v_pk_fma_f32 v[204:205], v[132:133], v[172:173], v[204:205]
    v_pk_fma_f32 v[206:207], v[132:133], v[174:175], v[206:207]
    v_pk_fma_f32 v[208:209], v[132:133], v[176:177], v[208:209]
    v_lshlrev_b32 v156, 16, v18
    v_add_u32 v12, 12800, v6
    buffer_load_dwordx4 v[68:71], v12, s[44:47], 0 offen
    v_and_b32 v157, 0xffff0000, v18
    v_lshlrev_b32 v158, 16, v22
    v_and_b32 v159, 0xffff0000, v22
    v_lshlrev_b32 v160, 16, v26
    v_and_b32 v161, 0xffff0000, v26
    v_lshlrev_b32 v162, 16, v30
    v_and_b32 v163, 0xffff0000, v30
    v_lshlrev_b32 v164, 16, v34
    v_and_b32 v165, 0xffff0000, v34
    v_lshlrev_b32 v166, 16, v38
    v_and_b32 v167, 0xffff0000, v38
    v_lshlrev_b32 v168, 16, v42
    v_and_b32 v169, 0xffff0000, v42
    v_lshlrev_b32 v170, 16, v46
    v_and_b32 v171, 0xffff0000, v46
    v_lshlrev_b32 v172, 16, v50
    v_and_b32 v173, 0xffff0000, v50
    v_lshlrev_b32 v174, 16, v54
    v_and_b32 v175, 0xffff0000, v54
    v_lshlrev_b32 v176, 16, v58
    v_and_b32 v177, 0xffff0000, v58
    v_pk_mul_f32 v[210:211], v[146:147], v[156:157]
    v_pk_mul_f32 v[212:213], v[146:147], v[158:159]
    v_pk_mul_f32 v[214:215], v[146:147], v[160:161]
    v_pk_mul_f32 v[216:217], v[146:147], v[162:163]
    v_pk_mul_f32 v[218:219], v[146:147], v[164:165]
    v_pk_mul_f32 v[220:221], v[146:147], v[166:167]
    v_add_u32 v12, 14080, v6
    buffer_load_dwordx4 v[72:75], v12, s[44:47], 0 offen
    v_pk_mul_f32 v[222:223], v[146:147], v[168:169]
    v_pk_mul_f32 v[224:225], v[146:147], v[170:171]
    v_pk_fma_f32 v[210:211], v[144:145], v[158:159], v[210:211]
    v_pk_fma_f32 v[212:213], v[144:145], v[160:161], v[212:213]
    v_pk_fma_f32 v[214:215], v[144:145], v[162:163], v[214:215]
    v_pk_fma_f32 v[216:217], v[144:145], v[164:165], v[216:217]
    v_pk_fma_f32 v[218:219], v[144:145], v[166:167], v[218:219]
    v_pk_fma_f32 v[220:221], v[144:145], v[168:169], v[220:221]
    v_pk_fma_f32 v[222:223], v[144:145], v[170:171], v[222:223]
    v_pk_fma_f32 v[224:225], v[144:145], v[172:173], v[224:225]
    v_pk_fma_f32 v[210:211], v[142:143], v[160:161], v[210:211]
    v_pk_fma_f32 v[212:213], v[142:143], v[162:163], v[212:213]
    v_pk_fma_f32 v[214:215], v[142:143], v[164:165], v[214:215]
    v_pk_fma_f32 v[216:217], v[142:143], v[166:167], v[216:217]
    v_pk_fma_f32 v[218:219], v[142:143], v[168:169], v[218:219]
    v_pk_fma_f32 v[220:221], v[142:143], v[170:171], v[220:221]
    v_pk_fma_f32 v[222:223], v[142:143], v[172:173], v[222:223]
    v_pk_fma_f32 v[224:225], v[142:143], v[174:175], v[224:225]
    v_pk_fma_f32 v[210:211], v[140:141], v[162:163], v[210:211]
    v_pk_fma_f32 v[212:213], v[140:141], v[164:165], v[212:213]
    v_pk_fma_f32 v[214:215], v[140:141], v[166:167], v[214:215]
    v_pk_fma_f32 v[216:217], v[140:141], v[168:169], v[216:217]
    v_pk_fma_f32 v[218:219], v[140:141], v[170:171], v[218:219]
    v_pk_fma_f32 v[220:221], v[140:141], v[172:173], v[220:221]
    v_pk_fma_f32 v[222:223], v[140:141], v[174:175], v[222:223]
    v_pk_fma_f32 v[224:225], v[140:141], v[176:177], v[224:225]
    v_lshlrev_b32 v156, 16, v19
    v_add_u32 v12, 15360, v6
    buffer_load_dwordx4 v[76:79], v12, s[44:47], 0 offen
    v_and_b32 v157, 0xffff0000, v19
    v_lshlrev_b32 v158, 16, v23
    v_and_b32 v159, 0xffff0000, v23
    v_lshlrev_b32 v160, 16, v27
    v_and_b32 v161, 0xffff0000, v27
    v_lshlrev_b32 v162, 16, v31
    v_and_b32 v163, 0xffff0000, v31
    v_lshlrev_b32 v164, 16, v35
    v_and_b32 v165, 0xffff0000, v35
    v_lshlrev_b32 v166, 16, v39
    v_and_b32 v167, 0xffff0000, v39
    v_lshlrev_b32 v168, 16, v43
    v_and_b32 v169, 0xffff0000, v43
    v_lshlrev_b32 v170, 16, v47
    v_and_b32 v171, 0xffff0000, v47
    v_lshlrev_b32 v172, 16, v51
    v_and_b32 v173, 0xffff0000, v51
    v_lshlrev_b32 v174, 16, v55
    v_and_b32 v175, 0xffff0000, v55
    v_lshlrev_b32 v176, 16, v59
    v_and_b32 v177, 0xffff0000, v59
    v_pk_mul_f32 v[226:227], v[154:155], v[156:157]
    v_pk_mul_f32 v[228:229], v[154:155], v[158:159]
    v_pk_mul_f32 v[230:231], v[154:155], v[160:161]
    v_pk_mul_f32 v[232:233], v[154:155], v[162:163]
    v_pk_mul_f32 v[234:235], v[154:155], v[164:165]
    v_pk_mul_f32 v[236:237], v[154:155], v[166:167]
    v_add_u32 v12, 16640, v6
    buffer_load_dwordx4 v[80:83], v12, s[44:47], 0 offen
    v_pk_mul_f32 v[238:239], v[154:155], v[168:169]
    v_pk_mul_f32 v[240:241], v[154:155], v[170:171]
    v_pk_fma_f32 v[226:227], v[152:153], v[158:159], v[226:227]
    v_pk_fma_f32 v[228:229], v[152:153], v[160:161], v[228:229]
    v_pk_fma_f32 v[230:231], v[152:153], v[162:163], v[230:231]
    v_pk_fma_f32 v[232:233], v[152:153], v[164:165], v[232:233]
    v_pk_fma_f32 v[234:235], v[152:153], v[166:167], v[234:235]
    v_pk_fma_f32 v[236:237], v[152:153], v[168:169], v[236:237]
    v_pk_fma_f32 v[238:239], v[152:153], v[170:171], v[238:239]
    v_pk_fma_f32 v[240:241], v[152:153], v[172:173], v[240:241]
    v_pk_fma_f32 v[226:227], v[150:151], v[160:161], v[226:227]
    v_pk_fma_f32 v[228:229], v[150:151], v[162:163], v[228:229]
    v_pk_fma_f32 v[230:231], v[150:151], v[164:165], v[230:231]
    v_pk_fma_f32 v[232:233], v[150:151], v[166:167], v[232:233]
    v_pk_fma_f32 v[234:235], v[150:151], v[168:169], v[234:235]
    v_pk_fma_f32 v[236:237], v[150:151], v[170:171], v[236:237]
    v_pk_fma_f32 v[238:239], v[150:151], v[172:173], v[238:239]
    v_pk_fma_f32 v[240:241], v[150:151], v[174:175], v[240:241]
    v_pk_fma_f32 v[226:227], v[148:149], v[162:163], v[226:227]
    v_pk_fma_f32 v[228:229], v[148:149], v[164:165], v[228:229]
    v_pk_fma_f32 v[230:231], v[148:149], v[166:167], v[230:231]
    v_pk_fma_f32 v[232:233], v[148:149], v[168:169], v[232:233]
    v_pk_fma_f32 v[234:235], v[148:149], v[170:171], v[234:235]
    v_pk_fma_f32 v[236:237], v[148:149], v[172:173], v[236:237]
    v_pk_fma_f32 v[238:239], v[148:149], v[174:175], v[238:239]
    v_pk_fma_f32 v[240:241], v[148:149], v[176:177], v[240:241]
    s_waitcnt vmcnt(6)
    v_lshlrev_b32 v156, 16, v92
    v_add_u32 v12, 17920, v6
    buffer_load_dwordx4 v[84:87], v12, s[44:47], 0 offen
    v_and_b32 v157, 0xffff0000, v92
    v_lshlrev_b32 v158, 16, v96
    v_and_b32 v159, 0xffff0000, v96
    v_lshlrev_b32 v160, 16, v100
    v_and_b32 v161, 0xffff0000, v100
    v_lshlrev_b32 v162, 16, v104
    v_and_b32 v163, 0xffff0000, v104
    v_lshlrev_b32 v164, 16, v108
    v_and_b32 v165, 0xffff0000, v108
    v_lshlrev_b32 v166, 16, v112
    v_and_b32 v167, 0xffff0000, v112
    v_lshlrev_b32 v168, 16, v116
    v_and_b32 v169, 0xffff0000, v116
    v_lshlrev_b32 v170, 16, v120
    v_and_b32 v171, 0xffff0000, v120
    v_pk_mul_f32 v[178:179], v[178:179], v[156:157]
    v_pk_mul_f32 v[180:181], v[180:181], v[158:159]
    v_pk_mul_f32 v[182:183], v[182:183], v[160:161]
    v_add_u32 v12, 19200, v6
    buffer_load_dwordx4 v[88:91], v12, s[44:47], 0 offen
    v_pk_mul_f32 v[184:185], v[184:185], v[162:163]
    v_pk_mul_f32 v[186:187], v[186:187], v[164:165]
    v_pk_mul_f32 v[188:189], v[188:189], v[166:167]
    v_pk_mul_f32 v[190:191], v[190:191], v[168:169]
    v_pk_mul_f32 v[192:193], v[192:193], v[170:171]
    s_waitcnt lgkmcnt(0)
    v_cvt_pk_bf16_f32 v242, v178, v180
    v_cvt_pk_bf16_f32 v243, v182, v184
    v_cvt_pk_bf16_f32 v244, v186, v188
    v_cvt_pk_bf16_f32 v245, v190, v192
    v_cvt_pk_bf16_f32 v246, v179, v181
    v_cvt_pk_bf16_f32 v247, v183, v185
    v_cvt_pk_bf16_f32 v248, v187, v189
    v_cvt_pk_bf16_f32 v249, v191, v193
    ds_write_b128 v9, v[242:245] offset:0
    ds_write_b128 v9, v[246:249] offset:2048
    v_lshlrev_b32 v156, 16, v93
    v_add_u32 v12, 10240, v6
    buffer_load_dwordx4 v[16:19], v12, s[60:63], 0 offen
    v_and_b32 v157, 0xffff0000, v93
    v_lshlrev_b32 v158, 16, v97
    v_and_b32 v159, 0xffff0000, v97
    v_lshlrev_b32 v160, 16, v101
    v_and_b32 v161, 0xffff0000, v101
    v_lshlrev_b32 v162, 16, v105
    v_and_b32 v163, 0xffff0000, v105
    v_lshlrev_b32 v164, 16, v109
    v_and_b32 v165, 0xffff0000, v109
    v_lshlrev_b32 v166, 16, v113
    v_and_b32 v167, 0xffff0000, v113
    v_lshlrev_b32 v168, 16, v117
    v_and_b32 v169, 0xffff0000, v117
    v_lshlrev_b32 v170, 16, v121
    v_and_b32 v171, 0xffff0000, v121
    v_pk_mul_f32 v[194:195], v[194:195], v[156:157]
    v_pk_mul_f32 v[196:197], v[196:197], v[158:159]
    v_pk_mul_f32 v[198:199], v[198:199], v[160:161]
    v_add_u32 v12, 11520, v6
    buffer_load_dwordx4 v[20:23], v12, s[60:63], 0 offen
    v_pk_mul_f32 v[200:201], v[200:201], v[162:163]
    v_pk_mul_f32 v[202:203], v[202:203], v[164:165]
    v_pk_mul_f32 v[204:205], v[204:205], v[166:167]
    v_pk_mul_f32 v[206:207], v[206:207], v[168:169]
    v_pk_mul_f32 v[208:209], v[208:209], v[170:171]
    s_waitcnt lgkmcnt(0)
    v_cvt_pk_bf16_f32 v242, v194, v196
    v_cvt_pk_bf16_f32 v243, v198, v200
    v_cvt_pk_bf16_f32 v244, v202, v204
    v_cvt_pk_bf16_f32 v245, v206, v208
    v_cvt_pk_bf16_f32 v246, v195, v197
    v_cvt_pk_bf16_f32 v247, v199, v201
    v_cvt_pk_bf16_f32 v248, v203, v205
    v_cvt_pk_bf16_f32 v249, v207, v209
    ds_write_b128 v9, v[242:245] offset:4096
    ds_write_b128 v9, v[246:249] offset:6144
    v_lshlrev_b32 v156, 16, v94
    v_add_u32 v12, 12800, v6
    buffer_load_dwordx4 v[24:27], v12, s[60:63], 0 offen
    v_and_b32 v157, 0xffff0000, v94
    v_lshlrev_b32 v158, 16, v98
    v_and_b32 v159, 0xffff0000, v98
    v_lshlrev_b32 v160, 16, v102
    v_and_b32 v161, 0xffff0000, v102
    v_lshlrev_b32 v162, 16, v106
    v_and_b32 v163, 0xffff0000, v106
    v_lshlrev_b32 v164, 16, v110
    v_and_b32 v165, 0xffff0000, v110
    v_lshlrev_b32 v166, 16, v114
    v_and_b32 v167, 0xffff0000, v114
    v_lshlrev_b32 v168, 16, v118
    v_and_b32 v169, 0xffff0000, v118
    v_lshlrev_b32 v170, 16, v122
    v_and_b32 v171, 0xffff0000, v122
    v_pk_mul_f32 v[210:211], v[210:211], v[156:157]
    v_pk_mul_f32 v[212:213], v[212:213], v[158:159]
    v_pk_mul_f32 v[214:215], v[214:215], v[160:161]
    v_add_u32 v12, 14080, v6
    buffer_load_dwordx4 v[28:31], v12, s[60:63], 0 offen
    v_pk_mul_f32 v[216:217], v[216:217], v[162:163]
    v_pk_mul_f32 v[218:219], v[218:219], v[164:165]
    v_pk_mul_f32 v[220:221], v[220:221], v[166:167]
    v_pk_mul_f32 v[222:223], v[222:223], v[168:169]
    v_pk_mul_f32 v[224:225], v[224:225], v[170:171]
    s_waitcnt lgkmcnt(0)
    v_cvt_pk_bf16_f32 v242, v210, v212
    v_cvt_pk_bf16_f32 v243, v214, v216
    v_cvt_pk_bf16_f32 v244, v218, v220
    v_cvt_pk_bf16_f32 v245, v222, v224
    v_cvt_pk_bf16_f32 v246, v211, v213
    v_cvt_pk_bf16_f32 v247, v215, v217
    v_cvt_pk_bf16_f32 v248, v219, v221
    v_cvt_pk_bf16_f32 v249, v223, v225
    ds_write_b128 v9, v[242:245] offset:8192
    ds_write_b128 v9, v[246:249] offset:10240
    v_lshlrev_b32 v156, 16, v95
    v_add_u32 v12, 15360, v6
    buffer_load_dwordx4 v[32:35], v12, s[60:63], 0 offen
    v_and_b32 v157, 0xffff0000, v95
    v_lshlrev_b32 v158, 16, v99
    v_and_b32 v159, 0xffff0000, v99
    v_lshlrev_b32 v160, 16, v103
    v_and_b32 v161, 0xffff0000, v103
    v_lshlrev_b32 v162, 16, v107
    v_and_b32 v163, 0xffff0000, v107
    v_lshlrev_b32 v164, 16, v111
    v_and_b32 v165, 0xffff0000, v111
    v_lshlrev_b32 v166, 16, v115
    v_and_b32 v167, 0xffff0000, v115
    v_lshlrev_b32 v168, 16, v119
    v_and_b32 v169, 0xffff0000, v119
    v_lshlrev_b32 v170, 16, v123
    v_and_b32 v171, 0xffff0000, v123
    v_pk_mul_f32 v[226:227], v[226:227], v[156:157]
    v_pk_mul_f32 v[228:229], v[228:229], v[158:159]
    v_pk_mul_f32 v[230:231], v[230:231], v[160:161]
    v_add_u32 v12, 16640, v6
    buffer_load_dwordx4 v[36:39], v12, s[60:63], 0 offen
    v_pk_mul_f32 v[232:233], v[232:233], v[162:163]
    v_pk_mul_f32 v[234:235], v[234:235], v[164:165]
    v_pk_mul_f32 v[236:237], v[236:237], v[166:167]
    v_pk_mul_f32 v[238:239], v[238:239], v[168:169]
    v_pk_mul_f32 v[240:241], v[240:241], v[170:171]
    s_waitcnt lgkmcnt(0)
    v_cvt_pk_bf16_f32 v242, v226, v228
    v_cvt_pk_bf16_f32 v243, v230, v232
    v_cvt_pk_bf16_f32 v244, v234, v236
    v_cvt_pk_bf16_f32 v245, v238, v240
    v_cvt_pk_bf16_f32 v246, v227, v229
    v_cvt_pk_bf16_f32 v247, v231, v233
    v_cvt_pk_bf16_f32 v248, v235, v237
    v_cvt_pk_bf16_f32 v249, v239, v241
    ds_write_b128 v9, v[242:245] offset:12288
    ds_write_b128 v9, v[246:249] offset:14336
    s_waitcnt vmcnt(6)
    v_lshlrev_b32 v156, 16, v48
    v_add_u32 v12, 17920, v6
    buffer_load_dwordx4 v[40:43], v12, s[60:63], 0 offen
    v_and_b32 v157, 0xffff0000, v48
    v_lshlrev_b32 v158, 16, v52
    v_and_b32 v159, 0xffff0000, v52
    v_lshlrev_b32 v160, 16, v56
    v_and_b32 v161, 0xffff0000, v56
    v_lshlrev_b32 v162, 16, v60
    v_and_b32 v163, 0xffff0000, v60
    v_lshlrev_b32 v164, 16, v64
    v_and_b32 v165, 0xffff0000, v64
    v_lshlrev_b32 v166, 16, v68
    v_and_b32 v167, 0xffff0000, v68
    v_lshlrev_b32 v168, 16, v72
    v_and_b32 v169, 0xffff0000, v72
    v_lshlrev_b32 v170, 16, v76
    v_and_b32 v171, 0xffff0000, v76
    v_lshlrev_b32 v172, 16, v80
    v_and_b32 v173, 0xffff0000, v80
    v_lshlrev_b32 v174, 16, v84
    v_and_b32 v175, 0xffff0000, v84
    v_lshlrev_b32 v176, 16, v88
    v_and_b32 v177, 0xffff0000, v88
    v_pk_mul_f32 v[178:179], v[130:131], v[156:157]
    v_pk_mul_f32 v[180:181], v[130:131], v[158:159]
    v_pk_mul_f32 v[182:183], v[130:131], v[160:161]
    v_pk_mul_f32 v[184:185], v[130:131], v[162:163]
    v_pk_mul_f32 v[186:187], v[130:131], v[164:165]
    v_pk_mul_f32 v[188:189], v[130:131], v[166:167]
    v_add_u32 v12, 19200, v6
    buffer_load_dwordx4 v[44:47], v12, s[60:63], 0 offen
    v_pk_mul_f32 v[190:191], v[130:131], v[168:169]
    v_pk_mul_f32 v[192:193], v[130:131], v[170:171]
    v_pk_fma_f32 v[178:179], v[128:129], v[158:159], v[178:179]
    v_pk_fma_f32 v[180:181], v[128:129], v[160:161], v[180:181]
    v_pk_fma_f32 v[182:183], v[128:129], v[162:163], v[182:183]
    v_pk_fma_f32 v[184:185], v[128:129], v[164:165], v[184:185]
    v_pk_fma_f32 v[186:187], v[128:129], v[166:167], v[186:187]
    v_pk_fma_f32 v[188:189], v[128:129], v[168:169], v[188:189]
    v_pk_fma_f32 v[190:191], v[128:129], v[170:171], v[190:191]
    v_pk_fma_f32 v[192:193], v[128:129], v[172:173], v[192:193]
    v_pk_fma_f32 v[178:179], v[126:127], v[160:161], v[178:179]
    v_pk_fma_f32 v[180:181], v[126:127], v[162:163], v[180:181]
    v_pk_fma_f32 v[182:183], v[126:127], v[164:165], v[182:183]
    v_pk_fma_f32 v[184:185], v[126:127], v[166:167], v[184:185]
    v_pk_fma_f32 v[186:187], v[126:127], v[168:169], v[186:187]
    v_pk_fma_f32 v[188:189], v[126:127], v[170:171], v[188:189]
    v_pk_fma_f32 v[190:191], v[126:127], v[172:173], v[190:191]
    v_pk_fma_f32 v[192:193], v[126:127], v[174:175], v[192:193]
    v_pk_fma_f32 v[178:179], v[124:125], v[162:163], v[178:179]
    v_pk_fma_f32 v[180:181], v[124:125], v[164:165], v[180:181]
    v_pk_fma_f32 v[182:183], v[124:125], v[166:167], v[182:183]
    v_pk_fma_f32 v[184:185], v[124:125], v[168:169], v[184:185]
    v_pk_fma_f32 v[186:187], v[124:125], v[170:171], v[186:187]
    v_pk_fma_f32 v[188:189], v[124:125], v[172:173], v[188:189]
    v_pk_fma_f32 v[190:191], v[124:125], v[174:175], v[190:191]
    v_pk_fma_f32 v[192:193], v[124:125], v[176:177], v[192:193]
    v_lshlrev_b32 v156, 16, v49
    buffer_load_dwordx2 v[250:251], v15, s[56:59], 0 offen sc1
    v_and_b32 v157, 0xffff0000, v49
    v_lshlrev_b32 v158, 16, v53
    v_and_b32 v159, 0xffff0000, v53
    v_lshlrev_b32 v160, 16, v57
    v_and_b32 v161, 0xffff0000, v57
    v_lshlrev_b32 v162, 16, v61
    v_and_b32 v163, 0xffff0000, v61
    v_lshlrev_b32 v164, 16, v65
    v_and_b32 v165, 0xffff0000, v65
    v_lshlrev_b32 v166, 16, v69
    v_and_b32 v167, 0xffff0000, v69
    v_lshlrev_b32 v168, 16, v73
    v_and_b32 v169, 0xffff0000, v73
    v_lshlrev_b32 v170, 16, v77
    v_and_b32 v171, 0xffff0000, v77
    v_lshlrev_b32 v172, 16, v81
    v_and_b32 v173, 0xffff0000, v81
    v_lshlrev_b32 v174, 16, v85
    v_and_b32 v175, 0xffff0000, v85
    v_lshlrev_b32 v176, 16, v89
    v_and_b32 v177, 0xffff0000, v89
    v_pk_mul_f32 v[194:195], v[138:139], v[156:157]
    v_pk_mul_f32 v[196:197], v[138:139], v[158:159]
    v_pk_mul_f32 v[198:199], v[138:139], v[160:161]
    v_pk_mul_f32 v[200:201], v[138:139], v[162:163]
    v_pk_mul_f32 v[202:203], v[138:139], v[164:165]
    v_pk_mul_f32 v[204:205], v[138:139], v[166:167]
    v_xor_b32 v9, 16, v9
    v_pk_mul_f32 v[206:207], v[138:139], v[168:169]
    v_pk_mul_f32 v[208:209], v[138:139], v[170:171]
    v_pk_fma_f32 v[194:195], v[136:137], v[158:159], v[194:195]
    v_pk_fma_f32 v[196:197], v[136:137], v[160:161], v[196:197]
    v_pk_fma_f32 v[198:199], v[136:137], v[162:163], v[198:199]
    v_pk_fma_f32 v[200:201], v[136:137], v[164:165], v[200:201]
    v_pk_fma_f32 v[202:203], v[136:137], v[166:167], v[202:203]
    v_pk_fma_f32 v[204:205], v[136:137], v[168:169], v[204:205]
    v_pk_fma_f32 v[206:207], v[136:137], v[170:171], v[206:207]
    v_pk_fma_f32 v[208:209], v[136:137], v[172:173], v[208:209]
    v_pk_fma_f32 v[194:195], v[134:135], v[160:161], v[194:195]
    v_pk_fma_f32 v[196:197], v[134:135], v[162:163], v[196:197]
    v_pk_fma_f32 v[198:199], v[134:135], v[164:165], v[198:199]
    v_pk_fma_f32 v[200:201], v[134:135], v[166:167], v[200:201]
    v_pk_fma_f32 v[202:203], v[134:135], v[168:169], v[202:203]
    v_pk_fma_f32 v[204:205], v[134:135], v[170:171], v[204:205]
    v_pk_fma_f32 v[206:207], v[134:135], v[172:173], v[206:207]
    v_pk_fma_f32 v[208:209], v[134:135], v[174:175], v[208:209]
    v_pk_fma_f32 v[194:195], v[132:133], v[162:163], v[194:195]
    v_pk_fma_f32 v[196:197], v[132:133], v[164:165], v[196:197]
    v_pk_fma_f32 v[198:199], v[132:133], v[166:167], v[198:199]
    v_pk_fma_f32 v[200:201], v[132:133], v[168:169], v[200:201]
    v_pk_fma_f32 v[202:203], v[132:133], v[170:171], v[202:203]
    v_pk_fma_f32 v[204:205], v[132:133], v[172:173], v[204:205]
    v_pk_fma_f32 v[206:207], v[132:133], v[174:175], v[206:207]
    v_pk_fma_f32 v[208:209], v[132:133], v[176:177], v[208:209]
    v_lshlrev_b32 v156, 16, v50
    v_and_b32 v157, 0xffff0000, v50
    v_lshlrev_b32 v158, 16, v54
    v_and_b32 v159, 0xffff0000, v54
    v_lshlrev_b32 v160, 16, v58
    v_and_b32 v161, 0xffff0000, v58
    v_lshlrev_b32 v162, 16, v62
    v_and_b32 v163, 0xffff0000, v62
    v_lshlrev_b32 v164, 16, v66
    v_and_b32 v165, 0xffff0000, v66
    v_lshlrev_b32 v166, 16, v70
    v_and_b32 v167, 0xffff0000, v70
    v_lshlrev_b32 v168, 16, v74
    v_and_b32 v169, 0xffff0000, v74
    v_lshlrev_b32 v170, 16, v78
    v_and_b32 v171, 0xffff0000, v78
    v_lshlrev_b32 v172, 16, v82
    v_and_b32 v173, 0xffff0000, v82
    v_lshlrev_b32 v174, 16, v86
    v_and_b32 v175, 0xffff0000, v86
    v_lshlrev_b32 v176, 16, v90
    v_and_b32 v177, 0xffff0000, v90
    v_pk_mul_f32 v[210:211], v[146:147], v[156:157]
    v_pk_mul_f32 v[212:213], v[146:147], v[158:159]
    v_pk_mul_f32 v[214:215], v[146:147], v[160:161]
    v_pk_mul_f32 v[216:217], v[146:147], v[162:163]
    v_pk_mul_f32 v[218:219], v[146:147], v[164:165]
    v_pk_mul_f32 v[220:221], v[146:147], v[166:167]
    v_pk_mul_f32 v[222:223], v[146:147], v[168:169]
    v_pk_mul_f32 v[224:225], v[146:147], v[170:171]
    v_pk_fma_f32 v[210:211], v[144:145], v[158:159], v[210:211]
    v_pk_fma_f32 v[212:213], v[144:145], v[160:161], v[212:213]
    v_pk_fma_f32 v[214:215], v[144:145], v[162:163], v[214:215]
    v_pk_fma_f32 v[216:217], v[144:145], v[164:165], v[216:217]
    v_pk_fma_f32 v[218:219], v[144:145], v[166:167], v[218:219]
    v_pk_fma_f32 v[220:221], v[144:145], v[168:169], v[220:221]
    v_pk_fma_f32 v[222:223], v[144:145], v[170:171], v[222:223]
    v_pk_fma_f32 v[224:225], v[144:145], v[172:173], v[224:225]
    v_pk_fma_f32 v[210:211], v[142:143], v[160:161], v[210:211]
    v_pk_fma_f32 v[212:213], v[142:143], v[162:163], v[212:213]
    v_pk_fma_f32 v[214:215], v[142:143], v[164:165], v[214:215]
    v_pk_fma_f32 v[216:217], v[142:143], v[166:167], v[216:217]
    v_pk_fma_f32 v[218:219], v[142:143], v[168:169], v[218:219]
    v_pk_fma_f32 v[220:221], v[142:143], v[170:171], v[220:221]
    v_pk_fma_f32 v[222:223], v[142:143], v[172:173], v[222:223]
    v_pk_fma_f32 v[224:225], v[142:143], v[174:175], v[224:225]
    v_pk_fma_f32 v[210:211], v[140:141], v[162:163], v[210:211]
    v_pk_fma_f32 v[212:213], v[140:141], v[164:165], v[212:213]
    v_pk_fma_f32 v[214:215], v[140:141], v[166:167], v[214:215]
    v_pk_fma_f32 v[216:217], v[140:141], v[168:169], v[216:217]
    v_pk_fma_f32 v[218:219], v[140:141], v[170:171], v[218:219]
    v_pk_fma_f32 v[220:221], v[140:141], v[172:173], v[220:221]
    v_pk_fma_f32 v[222:223], v[140:141], v[174:175], v[222:223]
    v_pk_fma_f32 v[224:225], v[140:141], v[176:177], v[224:225]
    v_lshlrev_b32 v156, 16, v51
    v_and_b32 v157, 0xffff0000, v51
    v_lshlrev_b32 v158, 16, v55
    v_and_b32 v159, 0xffff0000, v55
    v_lshlrev_b32 v160, 16, v59
    v_and_b32 v161, 0xffff0000, v59
    v_lshlrev_b32 v162, 16, v63
    v_and_b32 v163, 0xffff0000, v63
    v_lshlrev_b32 v164, 16, v67
    v_and_b32 v165, 0xffff0000, v67
    v_lshlrev_b32 v166, 16, v71
    v_and_b32 v167, 0xffff0000, v71
    v_lshlrev_b32 v168, 16, v75
    v_and_b32 v169, 0xffff0000, v75
    v_lshlrev_b32 v170, 16, v79
    v_and_b32 v171, 0xffff0000, v79
    v_lshlrev_b32 v172, 16, v83
    v_and_b32 v173, 0xffff0000, v83
    v_lshlrev_b32 v174, 16, v87
    v_and_b32 v175, 0xffff0000, v87
    v_lshlrev_b32 v176, 16, v91
    v_and_b32 v177, 0xffff0000, v91
    v_pk_mul_f32 v[226:227], v[154:155], v[156:157]
    v_pk_mul_f32 v[228:229], v[154:155], v[158:159]
    v_pk_mul_f32 v[230:231], v[154:155], v[160:161]
    v_pk_mul_f32 v[232:233], v[154:155], v[162:163]
    v_pk_mul_f32 v[234:235], v[154:155], v[164:165]
    v_pk_mul_f32 v[236:237], v[154:155], v[166:167]
    v_pk_mul_f32 v[238:239], v[154:155], v[168:169]
    v_pk_mul_f32 v[240:241], v[154:155], v[170:171]
    v_pk_fma_f32 v[226:227], v[152:153], v[158:159], v[226:227]
    v_pk_fma_f32 v[228:229], v[152:153], v[160:161], v[228:229]
    v_pk_fma_f32 v[230:231], v[152:153], v[162:163], v[230:231]
    v_pk_fma_f32 v[232:233], v[152:153], v[164:165], v[232:233]
    v_pk_fma_f32 v[234:235], v[152:153], v[166:167], v[234:235]
    v_pk_fma_f32 v[236:237], v[152:153], v[168:169], v[236:237]
    v_pk_fma_f32 v[238:239], v[152:153], v[170:171], v[238:239]
    v_pk_fma_f32 v[240:241], v[152:153], v[172:173], v[240:241]
    v_pk_fma_f32 v[226:227], v[150:151], v[160:161], v[226:227]
    v_pk_fma_f32 v[228:229], v[150:151], v[162:163], v[228:229]
    v_pk_fma_f32 v[230:231], v[150:151], v[164:165], v[230:231]
    v_pk_fma_f32 v[232:233], v[150:151], v[166:167], v[232:233]
    v_pk_fma_f32 v[234:235], v[150:151], v[168:169], v[234:235]
    v_pk_fma_f32 v[236:237], v[150:151], v[170:171], v[236:237]
    v_pk_fma_f32 v[238:239], v[150:151], v[172:173], v[238:239]
    v_pk_fma_f32 v[240:241], v[150:151], v[174:175], v[240:241]
    v_pk_fma_f32 v[226:227], v[148:149], v[162:163], v[226:227]
    v_pk_fma_f32 v[228:229], v[148:149], v[164:165], v[228:229]
    v_pk_fma_f32 v[230:231], v[148:149], v[166:167], v[230:231]
    v_pk_fma_f32 v[232:233], v[148:149], v[168:169], v[232:233]
    v_pk_fma_f32 v[234:235], v[148:149], v[170:171], v[234:235]
    v_pk_fma_f32 v[236:237], v[148:149], v[172:173], v[236:237]
    v_pk_fma_f32 v[238:239], v[148:149], v[174:175], v[238:239]
    v_pk_fma_f32 v[240:241], v[148:149], v[176:177], v[240:241]
    s_waitcnt vmcnt(1)
    v_lshlrev_b32 v156, 16, v16
    v_and_b32 v157, 0xffff0000, v16
    v_lshlrev_b32 v158, 16, v20
    v_and_b32 v159, 0xffff0000, v20
    v_lshlrev_b32 v160, 16, v24
    v_and_b32 v161, 0xffff0000, v24
    v_lshlrev_b32 v162, 16, v28
    v_and_b32 v163, 0xffff0000, v28
    v_lshlrev_b32 v164, 16, v32
    v_and_b32 v165, 0xffff0000, v32
    v_lshlrev_b32 v166, 16, v36
    v_and_b32 v167, 0xffff0000, v36
    v_lshlrev_b32 v168, 16, v40
    v_and_b32 v169, 0xffff0000, v40
    v_lshlrev_b32 v170, 16, v44
    v_and_b32 v171, 0xffff0000, v44
    v_pk_mul_f32 v[178:179], v[178:179], v[156:157]
    v_pk_mul_f32 v[180:181], v[180:181], v[158:159]
    v_pk_mul_f32 v[182:183], v[182:183], v[160:161]
    v_pk_mul_f32 v[184:185], v[184:185], v[162:163]
    v_pk_mul_f32 v[186:187], v[186:187], v[164:165]
    v_pk_mul_f32 v[188:189], v[188:189], v[166:167]
    v_pk_mul_f32 v[190:191], v[190:191], v[168:169]
    v_pk_mul_f32 v[192:193], v[192:193], v[170:171]
    s_waitcnt lgkmcnt(0)
    v_cvt_pk_bf16_f32 v242, v178, v180
    v_cvt_pk_bf16_f32 v243, v182, v184
    v_cvt_pk_bf16_f32 v244, v186, v188
    v_cvt_pk_bf16_f32 v245, v190, v192
    v_cvt_pk_bf16_f32 v246, v179, v181
    v_cvt_pk_bf16_f32 v247, v183, v185
    v_cvt_pk_bf16_f32 v248, v187, v189
    v_cvt_pk_bf16_f32 v249, v191, v193
    ds_write_b128 v9, v[242:245] offset:0
    ds_write_b128 v9, v[246:249] offset:2048
    ds_read_b128 a[80:83], v10 offset:0
    ds_read_b128 a[84:87], v10 offset:1024
    ds_read_b128 a[88:91], v10 offset:2048
    ds_read_b128 a[92:95], v10 offset:3072
    v_lshlrev_b32 v156, 16, v17
    v_and_b32 v157, 0xffff0000, v17
    v_lshlrev_b32 v158, 16, v21
    v_and_b32 v159, 0xffff0000, v21
    v_lshlrev_b32 v160, 16, v25
    v_and_b32 v161, 0xffff0000, v25
    v_lshlrev_b32 v162, 16, v29
    v_and_b32 v163, 0xffff0000, v29
    v_lshlrev_b32 v164, 16, v33
    v_and_b32 v165, 0xffff0000, v33
    v_lshlrev_b32 v166, 16, v37
    v_and_b32 v167, 0xffff0000, v37
    v_lshlrev_b32 v168, 16, v41
    v_and_b32 v169, 0xffff0000, v41
    v_lshlrev_b32 v170, 16, v45
    v_and_b32 v171, 0xffff0000, v45
    v_pk_mul_f32 v[194:195], v[194:195], v[156:157]
    v_pk_mul_f32 v[196:197], v[196:197], v[158:159]
    v_pk_mul_f32 v[198:199], v[198:199], v[160:161]
    v_pk_mul_f32 v[200:201], v[200:201], v[162:163]
    v_pk_mul_f32 v[202:203], v[202:203], v[164:165]
    v_pk_mul_f32 v[204:205], v[204:205], v[166:167]
    v_pk_mul_f32 v[206:207], v[206:207], v[168:169]
    v_pk_mul_f32 v[208:209], v[208:209], v[170:171]
    s_waitcnt lgkmcnt(0)
    v_cvt_pk_bf16_f32 v242, v194, v196
    s_add_u32 s31, s36, 0
    buffer_store_dwordx4 a[80:83], v7, s[52:55], s31 offen sc1
    v_cvt_pk_bf16_f32 v243, v198, v200
    v_cvt_pk_bf16_f32 v244, v202, v204
    s_add_u32 s31, s36, 262144
    buffer_store_dwordx4 a[84:87], v7, s[52:55], s31 offen sc1
    v_cvt_pk_bf16_f32 v245, v206, v208
    v_cvt_pk_bf16_f32 v246, v195, v197
    s_add_u32 s31, s36, 4096
    buffer_store_dwordx4 a[88:91], v7, s[52:55], s31 offen sc1
    v_cvt_pk_bf16_f32 v247, v199, v201
    v_cvt_pk_bf16_f32 v248, v203, v205
    s_add_u32 s31, s36, 266240
    buffer_store_dwordx4 a[92:95], v7, s[52:55], s31 offen sc1
    v_cvt_pk_bf16_f32 v249, v207, v209
    ds_write_b128 v9, v[242:245] offset:4096
    ds_write_b128 v9, v[246:249] offset:6144
    ds_read_b128 a[96:99], v10 offset:4096
    ds_read_b128 a[100:103], v10 offset:5120
    ds_read_b128 a[104:107], v10 offset:6144
    ds_read_b128 a[108:111], v10 offset:7168
    v_lshlrev_b32 v156, 16, v18
    v_and_b32 v157, 0xffff0000, v18
    v_lshlrev_b32 v158, 16, v22
    v_and_b32 v159, 0xffff0000, v22
    v_lshlrev_b32 v160, 16, v26
    v_and_b32 v161, 0xffff0000, v26
    v_lshlrev_b32 v162, 16, v30
    v_and_b32 v163, 0xffff0000, v30
    v_lshlrev_b32 v164, 16, v34
    v_and_b32 v165, 0xffff0000, v34
    v_lshlrev_b32 v166, 16, v38
    v_and_b32 v167, 0xffff0000, v38
    v_lshlrev_b32 v168, 16, v42
    v_and_b32 v169, 0xffff0000, v42
    v_lshlrev_b32 v170, 16, v46
    v_and_b32 v171, 0xffff0000, v46
    v_pk_mul_f32 v[210:211], v[210:211], v[156:157]
    v_pk_mul_f32 v[212:213], v[212:213], v[158:159]
    v_pk_mul_f32 v[214:215], v[214:215], v[160:161]
    v_pk_mul_f32 v[216:217], v[216:217], v[162:163]
    v_pk_mul_f32 v[218:219], v[218:219], v[164:165]
    v_pk_mul_f32 v[220:221], v[220:221], v[166:167]
    v_pk_mul_f32 v[222:223], v[222:223], v[168:169]
    v_pk_mul_f32 v[224:225], v[224:225], v[170:171]
    s_waitcnt lgkmcnt(0)
    v_cvt_pk_bf16_f32 v242, v210, v212
    s_add_u32 s31, s36, 8192
    buffer_store_dwordx4 a[96:99], v7, s[52:55], s31 offen sc1
    v_cvt_pk_bf16_f32 v243, v214, v216
    v_cvt_pk_bf16_f32 v244, v218, v220
    s_add_u32 s31, s36, 270336
    buffer_store_dwordx4 a[100:103], v7, s[52:55], s31 offen sc1
    v_cvt_pk_bf16_f32 v245, v222, v224
    v_cvt_pk_bf16_f32 v246, v211, v213
    s_add_u32 s31, s36, 12288
    buffer_store_dwordx4 a[104:107], v7, s[52:55], s31 offen sc1
    v_cvt_pk_bf16_f32 v247, v215, v217
    v_cvt_pk_bf16_f32 v248, v219, v221
    s_add_u32 s31, s36, 274432
    buffer_store_dwordx4 a[108:111], v7, s[52:55], s31 offen sc1
    v_cvt_pk_bf16_f32 v249, v223, v225
    ds_write_b128 v9, v[242:245] offset:8192
    ds_write_b128 v9, v[246:249] offset:10240
    ds_read_b128 a[112:115], v10 offset:8192
    ds_read_b128 a[116:119], v10 offset:9216
    ds_read_b128 a[120:123], v10 offset:10240
    ds_read_b128 a[124:127], v10 offset:11264
    v_lshlrev_b32 v156, 16, v19
    v_and_b32 v157, 0xffff0000, v19
    v_lshlrev_b32 v158, 16, v23
    v_and_b32 v159, 0xffff0000, v23
    v_lshlrev_b32 v160, 16, v27
    v_and_b32 v161, 0xffff0000, v27
    v_lshlrev_b32 v162, 16, v31
    v_and_b32 v163, 0xffff0000, v31
    v_lshlrev_b32 v164, 16, v35
    v_and_b32 v165, 0xffff0000, v35
    v_lshlrev_b32 v166, 16, v39
    v_and_b32 v167, 0xffff0000, v39
    v_lshlrev_b32 v168, 16, v43
    v_and_b32 v169, 0xffff0000, v43
    v_lshlrev_b32 v170, 16, v47
    v_and_b32 v171, 0xffff0000, v47
    v_pk_mul_f32 v[226:227], v[226:227], v[156:157]
    v_pk_mul_f32 v[228:229], v[228:229], v[158:159]
    v_pk_mul_f32 v[230:231], v[230:231], v[160:161]
    v_pk_mul_f32 v[232:233], v[232:233], v[162:163]
    v_pk_mul_f32 v[234:235], v[234:235], v[164:165]
    v_pk_mul_f32 v[236:237], v[236:237], v[166:167]
    v_pk_mul_f32 v[238:239], v[238:239], v[168:169]
    v_pk_mul_f32 v[240:241], v[240:241], v[170:171]
    s_waitcnt lgkmcnt(0)
    v_cvt_pk_bf16_f32 v242, v226, v228
    s_add_u32 s31, s36, 16384
    buffer_store_dwordx4 a[112:115], v7, s[52:55], s31 offen sc1
    v_cvt_pk_bf16_f32 v243, v230, v232
    v_cvt_pk_bf16_f32 v244, v234, v236
    s_add_u32 s31, s36, 278528
    buffer_store_dwordx4 a[116:119], v7, s[52:55], s31 offen sc1
    v_cvt_pk_bf16_f32 v245, v238, v240
    v_cvt_pk_bf16_f32 v246, v227, v229
    s_add_u32 s31, s36, 20480
    buffer_store_dwordx4 a[120:123], v7, s[52:55], s31 offen sc1
    v_cvt_pk_bf16_f32 v247, v231, v233
    v_cvt_pk_bf16_f32 v248, v235, v237
    s_add_u32 s31, s36, 282624
    buffer_store_dwordx4 a[124:127], v7, s[52:55], s31 offen sc1
    v_cvt_pk_bf16_f32 v249, v239, v241
    ds_write_b128 v9, v[242:245] offset:12288
    ds_write_b128 v9, v[246:249] offset:14336
    ds_read_b128 a[128:131], v10 offset:12288
    ds_read_b128 a[132:135], v10 offset:13312
    ds_read_b128 a[136:139], v10 offset:14336
    ds_read_b128 a[140:143], v10 offset:15360
    s_waitcnt lgkmcnt(0)
    s_add_u32 s31, s36, 24576
    buffer_store_dwordx4 a[128:131], v7, s[52:55], s31 offen sc1
    s_add_u32 s31, s36, 286720
    buffer_store_dwordx4 a[132:135], v7, s[52:55], s31 offen sc1
    s_add_u32 s31, s36, 28672
    buffer_store_dwordx4 a[136:139], v7, s[52:55], s31 offen sc1
    s_add_u32 s31, s36, 290816
    buffer_store_dwordx4 a[140:143], v7, s[52:55], s31 offen sc1
    s_lshr_b32 s31, s70, 7
    v_mov_b32 v214, s31
    s_lshr_b32 s31, s9, 7
    v_mov_b32 v14, s31
    v_cmp_gt_u32 vcc, 32, v0
    s_nop 1
    v_cndmask_b32 v214, v14, v214, vcc
    v_bfe_u32 v14, v0, 2, 3
    v_mad_u32_u24 v214, v14, 5, v214
    v_add_u32 v214, 216, v214
    v_lshlrev_b32 v214, 7, v214
    v_add_u32 v214, 0x1010000, v214
    v_and_b32 v195, 15, v0
    v_min_u32 v195, 13, v195
    v_add_u32 v195, s49, v195
    v_min_u32 v195, 53, v195
    s_mul_i32 s31, s69, 5
    s_lshr_b32 s31, s31, 2
    v_bfe_u32 v14, v0, 4, 1
    v_add_u32 v14, s31, v14
    v_mad_u32_u24 v195, v14, 54, v195
    v_mul_u32_u24 v195, 13108, v195
    v_lshrrev_b32 v195, 15, v195
    s_lshr_b32 s31, s68, 4
    s_mul_i32 s31, s31, 44
    s_lshl_b32 s35, s68, 2
    s_add_u32 s31, s31, s35
    v_bfe_u32 v14, v0, 1, 2
    v_add_u32 v14, s31, v14
    v_cmp_gt_u32 vcc, 32, v0
    s_nop 1
    v_cndmask_b32 v195, v14, v195, vcc
    v_lshlrev_b32 v195, 7, v195
    v_add_u32 v195, 0x1010000, v195
    v_lshlrev_b32 v252, 25, v0
    s_add_u32 s37, s77, 0x1016c00
    s_mov_b32 s31, 0
    s_and_b32 s93, s31, 1
    s_mul_i32 s31, s93, 6
    s_add_u32 s31, s31, s49
    s_mul_i32 s89, s69, 54
    s_add_u32 s89, s89, s31
    s_mul_i32 s89, s89, 5120
    s_add_u32 s89, s89, 0x700000
    v_mov_b32 v190, v13
    s_waitcnt vmcnt(16)
    v_mov_b32 v198, v250
    v_mov_b32 v199, v251
    v_min_u32 v250, 6, v0
    s_lshr_b32 s31, s49, 1
    v_add_lshl_u32 v250, v250, s31, 7
    s_lshl_b32 s31, s68, 12
    s_add_u32 s31, s31, 0x1033000
    v_add_u32 v250, s31, v250
    s_mul_i32 s31, s69, 80
    s_mul_i32 s35, s30, 20
    s_add_u32 s31, s31, s35
    s_sub_u32 s31, s31, 32
    v_min_u32 v14, 51, v0
    v_add_u32 v14, s31, v14
    v_lshrrev_b32 v15, 2, v14
    v_add_u32 v15, 88, v15
    v_cmp_gt_u32 vcc, 512, v14
    v_lshrrev_b32 v14, 1, v14
    s_nop 0
    v_cndmask_b32 v14, v15, v14, vcc
    v_lshlrev_b32 v14, 7, v14
    v_add_u32 v14, 0x1010040, v14
    v_cmp_gt_u32 vcc, 32, v0
    s_nop 1
    v_cndmask_b32 v250, v14, v250, vcc
    s_lshl_b32 s31, s30, 10
    v_add_u32 v1, s31, v5
    v_xor_b32 v2, 1024, v1
    v_xor_b32 v3, 2048, v1
    v_xor_b32 v4, 3072, v1
    v_add_u32 v14, 0, v0
    v_mul_u32_u24 v15, 205, v14
    v_lshrrev_b32 v15, 11, v15
    v_mul_u32_u24 v6, 1120, v15
    v_lshl_add_u32 v6, v14, 4, v6
    v_add_u32 v14, 64, v0
    v_mul_u32_u24 v15, 205, v14
    v_lshrrev_b32 v15, 11, v15
    v_mul_u32_u24 v7, 1120, v15
    v_lshl_add_u32 v7, v14, 4, v7
    v_add_u32 v14, 128, v0
    v_mul_u32_u24 v15, 205, v14
    v_lshrrev_b32 v15, 11, v15
    v_mul_u32_u24 v8, 1120, v15
    v_lshl_add_u32 v8, v14, 4, v8
    v_lshrrev_b32 v15, 3, v0
    v_lshlrev_b32 v12, 12, v15
    v_and_b32 v15, 7, v0
    v_lshl_add_u32 v12, v15, 4, v12
    v_lshrrev_b32 v14, 5, v0
    v_lshl_add_u32 v8, v14, 30, v8
    v_lshl_add_u32 v13, v14, 30, v12
    v_and_b32 v10, 15, v0
    v_lshlrev_b32 v9, 4, v10
    s_lshl_b32 s31, s68, 2
    s_add_u32 s31, s31, s30
    s_mul_i32 s94, s31, 20480
    s_lshl_b32 s92, s68, 8
    s_lshl_b32 s31, s30, 2
    s_add_u32 s92, s92, s31
    s_add_u32 s92, s92, 0x1000000
    s_mul_i32 s31, s69, 160
    s_add_u32 s94, s94, s31
    s_mul_i32 s88, s30, 3072
    s_add_u32 s88, s88, 147456
    s_mul_i32 s96, s69, 80
    s_mul_i32 s31, s30, 20
    s_add_u32 s96, s96, s31
    s_lshl_b32 s96, s96, 12
    s_lshl_b32 s31, s68, 7
    s_add_u32 s96, s96, s31
    s_add_u32 s96, s96, 0xd00000
    s_add_u32 s97, s96, 0x8000
    s_add_u32 s0, s96, 0x10000
    s_mul_i32 s31, s68, 54
    s_add_u32 s31, s31, s49
    s_add_u32 s31, s31, 13
    s_lshl_b32 s91, s31, 12
    s_mov_b32 s90, s91
    s_mov_b32 s80, s28
    s_mov_b32 s81, s29
    s_mov_b32 s83, 0x20000
    s_cmp_lt_u32 s30, 2
    s_cselect_b32 s82, 0x1053000, 0
    s_lshl_b32 s31, s70, 12
    s_add_u32 s84, s12, s31
    s_addc_u32 s85, s13, 0
    s_mov_b32 s86, 4096
    s_mov_b32 s87, 0x20000
    s_add_u32 s95, s31, 0xa00000
    s_lshl_b32 s31, s8, 11
    v_add_u32 v11, s31, v5
    s_add_u32 s1, s31, s71
    v_add_u32 v213, -8, v11
    v_cmp_gt_i32 vcc, 0, v213
    v_bfrev_b32 v14, 1
    v_add_u32 v192, s1, v5
    v_cndmask_b32 v213, v213, v14, vcc
    s_waitcnt vmcnt(0)
    s_nop 0
nc_h:
    v_readfirstlane_b32 s16, v198
    v_readfirstlane_b32 s17, v199
    s_nop 0
    s_cmp_eq_u32 s16, 0
    s_cbranch_scc1 nr_h
nk_h:
    s_lshl_b32 s31, s30, 25
    v_or_b32 v252, s31, v252
    s_barrier
    buffer_store_dwordx2 v[198:199], v252, s[52:55], s37 offen sc1
    s_mov_b32 s78, s37
    s_lshl_b32 s31, s9, 12
    s_add_u32 s44, s12, s31
    s_addc_u32 s45, s13, 0
    s_mov_b32 s46, 4096
    s_add_u32 m0, s10, 17152
    s_nop 0
    buffer_load_dwordx4 v5, s[44:47], 0 offen offset:0 lds
    buffer_load_dwordx4 v5, s[44:47], 0 offen offset:1024 lds
    buffer_load_dwordx4 v5, s[44:47], 0 offen offset:2048 lds
    buffer_load_dwordx4 v5, s[44:47], 0 offen offset:3072 lds
    s_add_u32 m0, s1, 17152
    s_nop 0
    buffer_load_dwordx4 v11, s[84:87], 0 offen lds
    buffer_load_dwordx4 v11, s[84:87], 0 offen offset:1024 lds
    buffer_store_dwordx4 a[236:239], v5, s[52:55], s6 offen offset:0 sc1
    buffer_store_dwordx4 a[236:239], v5, s[52:55], s6 offen offset:1024 sc1
    buffer_store_dwordx4 a[236:239], v190, s[52:55], s33 offen offset:0 sc1
    buffer_store_dwordx4 a[236:239], v190, s[52:55], s33 offen offset:1024 sc1
    buffer_store_dwordx4 a[236:239], v190, s[52:55], s33 offen offset:2048 sc1
    buffer_store_dwordx4 a[236:239], v190, s[52:55], s33 offen offset:3072 sc1
    s_add_u32 m0, s88, 0
    s_nop 0
    buffer_load_dwordx4 v6, s[40:43], s94 offen lds
    s_add_u32 m0, s88, 1024
    s_nop 0
    buffer_load_dwordx4 v7, s[40:43], s94 offen lds
    s_add_u32 m0, s88, 2048
    s_nop 0
    buffer_load_dwordx4 v8, s[40:43], s94 offen lds
    buffer_load_dwordx2 v[248:249], v214, s[52:55], 0 offen sc1
    s_waitcnt vmcnt(0)
    v_cmp_ne_u64 vcc, s[16:17], v[248:249]
    s_nop 3
    s_cbranch_vccnz re_hu
ok_hu:
    buffer_load_dwordx4 v[162:165], v11, s[52:55], s95 offen sc1
    buffer_load_dwordx2 v[160:161], v213, s[52:55], s95 offen sc1
    buffer_load_dwordx4 v[168:171], v11, s[52:55], s95 offen offset:1024 sc1
    buffer_load_dwordx2 v[166:167], v11, s[52:55], s95 offen offset:1016 sc1
    s_lshl_b32 s37, s9, 12
    s_add_u32 s37, s37, 0xa00000
    v_cmp_eq_u32 vcc, 0, v0
    v_add_u32 v14, -8, v5
    v_bfrev_b32 v15, 1
    v_cndmask_b32 v14, v14, v15, vcc
    buffer_load_dwordx4 v[202:205], v5, s[52:55], s37 offen offset:0 sc1
    buffer_load_dwordx2 v[200:201], v14, s[52:55], s37 offen sc1
    buffer_load_dwordx4 v[208:211], v5, s[52:55], s37 offen offset:1024 sc1
    buffer_load_dwordx2 v[206:207], v5, s[52:55], s37 offen offset:1016 sc1
    buffer_load_dwordx4 v[214:217], v5, s[52:55], s37 offen offset:2048 sc1
    buffer_load_dwordx2 v[212:213], v5, s[52:55], s37 offen offset:2040 sc1
    buffer_load_dwordx4 v[220:223], v5, s[52:55], s37 offen offset:3072 sc1
    buffer_load_dwordx2 v[218:219], v5, s[52:55], s37 offen offset:3064 sc1
    s_waitcnt vmcnt(0)
    s_cmp_lt_u32 s32, 32
    s_cbranch_scc1 H_solo
    buffer_load_dwordx2 v[196:197], v195, s[52:55], 0 offen sc1
    ds_write_b128 v192, v[162:165] offset:32
    v_alignbit_b32 v144, v162, v161, 16
    v_alignbit_b32 v145, v163, v162, 16
    v_alignbit_b32 v146, v164, v163, 16
    v_alignbit_b32 v147, v165, v164, 16
    ds_write_b128 v192, v[144:147] offset:4192
    v_mov_b32 v148, v161
    v_mov_b32 v149, v162
    v_mov_b32 v150, v163
    v_mov_b32 v151, v164
    ds_write_b128 v192, v[148:151] offset:8352
    v_alignbit_b32 v152, v161, v160, 16
    v_alignbit_b32 v153, v162, v161, 16
    v_alignbit_b32 v154, v163, v162, 16
    v_alignbit_b32 v155, v164, v163, 16
    ds_write_b128 v192, v[152:155] offset:12512
    ds_write_b128 v192, v[168:171] offset:1056
    v_alignbit_b32 v144, v168, v167, 16
    v_alignbit_b32 v145, v169, v168, 16
    v_alignbit_b32 v146, v170, v169, 16
    v_alignbit_b32 v147, v171, v170, 16
    ds_write_b128 v192, v[144:147] offset:5216
    v_mov_b32 v148, v167
    v_mov_b32 v149, v168
    v_mov_b32 v150, v169
    v_mov_b32 v151, v170
    ds_write_b128 v192, v[148:151] offset:9376
    v_alignbit_b32 v152, v167, v166, 16
    v_alignbit_b32 v153, v168, v167, 16
    v_alignbit_b32 v154, v169, v168, 16
    v_alignbit_b32 v155, v170, v169, 16
    ds_write_b128 v192, v[152:155] offset:13536
    v_mov_b32 v156, 0
    v_mov_b32 v157, 0
    v_mov_b32 v158, 0
    v_mov_b32 v159, 0
    v_bfe_u32 v172, v0, 1, 2
    v_mul_u32_u24 v172, 4160, v172
    v_and_b32 v14, 1, v0
    v_lshl_add_u32 v172, v14, 4, v172
    v_add_u32 v14, 16640, v5
    v_cmp_gt_u32 vcc, 32, v0
    s_nop 1
    v_cndmask_b32 v172, v172, v14, vcc
    v_add_u32 v172, s71, v172
    ds_write_b128 v172, v[156:159]
    s_waitcnt vmcnt(0)
    v_cmp_ne_u64 vcc, s[16:17], v[196:197]
    s_nop 3
    s_cbranch_vccnz re_hw2
ok_hw2:
    buffer_load_dword v9, v9, s[52:55], s92 offen sc1
    buffer_load_dwordx4 a[0:3], v5, s[52:55], s89 offen offset:0 sc1
    buffer_load_dwordx4 a[4:7], v5, s[52:55], s89 offen offset:1024 sc1
    buffer_load_dwordx4 a[8:11], v5, s[52:55], s89 offen offset:2048 sc1
    buffer_load_dwordx4 a[12:15], v5, s[52:55], s89 offen offset:3072 sc1
    s_add_u32 s89, s89, 4096
    buffer_load_dwordx4 a[16:19], v5, s[52:55], s89 offen offset:0 sc1
    buffer_load_dwordx4 a[20:23], v5, s[52:55], s89 offen offset:1024 sc1
    buffer_load_dwordx4 a[24:27], v5, s[52:55], s89 offen offset:2048 sc1
    buffer_load_dwordx4 a[28:31], v5, s[52:55], s89 offen offset:3072 sc1
    s_add_u32 s89, s89, 4096
    buffer_load_dwordx4 a[32:35], v5, s[52:55], s89 offen offset:0 sc1
    buffer_load_dwordx4 a[36:39], v5, s[52:55], s89 offen offset:1024 sc1
    buffer_load_dwordx4 a[40:43], v5, s[52:55], s89 offen offset:2048 sc1
    buffer_load_dwordx4 a[44:47], v5, s[52:55], s89 offen offset:3072 sc1
    s_add_u32 s89, s89, 4096
    buffer_load_dwordx4 a[48:51], v5, s[52:55], s89 offen offset:0 sc1
    buffer_load_dwordx4 a[52:55], v5, s[52:55], s89 offen offset:1024 sc1
    buffer_load_dwordx4 a[56:59], v5, s[52:55], s89 offen offset:2048 sc1
    buffer_load_dwordx4 a[60:63], v5, s[52:55], s89 offen offset:3072 sc1
    s_add_u32 s89, s89, 4096
    buffer_load_dwordx4 a[64:67], v5, s[52:55], s89 offen offset:0 sc1
    buffer_load_dwordx4 a[68:71], v5, s[52:55], s89 offen offset:1024 sc1
    buffer_load_dwordx4 a[72:75], v5, s[52:55], s89 offen offset:2048 sc1
    buffer_load_dwordx4 a[76:79], v5, s[52:55], s89 offen offset:3072 sc1
    s_add_u32 s89, s89, 4096
    buffer_load_dwordx4 a[80:83], v5, s[52:55], s89 offen offset:0 sc1
    buffer_load_dwordx4 a[84:87], v5, s[52:55], s89 offen offset:1024 sc1
    buffer_load_dwordx4 a[88:91], v5, s[52:55], s89 offen offset:2048 sc1
    buffer_load_dwordx4 a[92:95], v5, s[52:55], s89 offen offset:3072 sc1
    s_add_u32 s89, s89, 4096
    buffer_load_dwordx4 a[96:99], v5, s[52:55], s89 offen offset:0 sc1
    buffer_load_dwordx4 a[100:103], v5, s[52:55], s89 offen offset:1024 sc1
    buffer_load_dwordx4 a[104:107], v5, s[52:55], s89 offen offset:2048 sc1
    buffer_load_dwordx4 a[108:111], v5, s[52:55], s89 offen offset:3072 sc1
    s_add_u32 s89, s89, 4096
    buffer_load_dwordx4 a[112:115], v5, s[52:55], s89 offen offset:0 sc1
    buffer_load_dwordx4 a[116:119], v5, s[52:55], s89 offen offset:1024 sc1
    s_mul_i32 s31, s93, -61440
    s_add_u32 s89, s89, s31
    buffer_load_dwordx4 a[120:123], v5, s[52:55], s89 offen offset:2048 sc1
    buffer_load_dwordx4 a[124:127], v5, s[52:55], s89 offen offset:3072 sc1
    s_add_u32 s89, s89, 4096
    buffer_load_dwordx4 a[128:131], v5, s[52:55], s89 offen offset:0 sc1
    buffer_load_dwordx4 a[132:135], v5, s[52:55], s89 offen offset:1024 sc1
    buffer_load_dwordx4 a[136:139], v5, s[52:55], s89 offen offset:2048 sc1
    buffer_load_dwordx4 a[140:143], v5, s[52:55], s89 offen offset:3072 sc1
    s_add_u32 s89, s89, 4096
    buffer_load_dwordx4 a[144:147], v5, s[52:55], s89 offen offset:0 sc1
    buffer_load_dwordx4 a[148:151], v5, s[52:55], s89 offen offset:1024 sc1
    buffer_load_dwordx4 a[152:155], v5, s[52:55], s89 offen offset:2048 sc1
    buffer_load_dwordx4 a[156:159], v5, s[52:55], s89 offen offset:3072 sc1
    s_add_u32 s89, s89, 4096
    buffer_load_dwordx4 a[160:163], v5, s[52:55], s89 offen offset:0 sc1
    buffer_load_dwordx4 a[164:167], v5, s[52:55], s89 offen offset:1024 sc1
    buffer_load_dwordx4 a[168:171], v5, s[52:55], s89 offen offset:2048 sc1
    buffer_load_dwordx4 a[172:175], v5, s[52:55], s89 offen offset:3072 sc1
    s_add_u32 s89, s89, 4096
    buffer_load_dwordx4 a[176:179], v5, s[52:55], s89 offen offset:0 sc1
    buffer_load_dwordx4 a[180:183], v5, s[52:55], s89 offen offset:1024 sc1
    buffer_load_dwordx4 a[184:187], v5, s[52:55], s89 offen offset:2048 sc1
    buffer_load_dwordx4 a[188:191], v5, s[52:55], s89 offen offset:3072 sc1
    s_add_u32 s89, s89, 4096
    buffer_load_dwordx4 a[192:195], v5, s[52:55], s89 offen offset:0 sc1
    buffer_load_dwordx4 a[196:199], v5, s[52:55], s89 offen offset:1024 sc1
    s_branch H_toF
H_solo:
    v_add_u32 v14, s10, v5
    ds_write_b128 v14, v[202:205] offset:32
    v_alignbit_b32 v112, v202, v201, 16
    v_alignbit_b32 v113, v203, v202, 16
    v_alignbit_b32 v114, v204, v203, 16
    v_alignbit_b32 v115, v205, v204, 16
    ds_write_b128 v14, v[112:115] offset:4192
    v_mov_b32 v116, v201
    v_mov_b32 v117, v202
    v_mov_b32 v118, v203
    v_mov_b32 v119, v204
    ds_write_b128 v14, v[116:119] offset:8352
    v_alignbit_b32 v120, v201, v200, 16
    v_alignbit_b32 v121, v202, v201, 16
    v_alignbit_b32 v122, v203, v202, 16
    v_alignbit_b32 v123, v204, v203, 16
    ds_write_b128 v14, v[120:123] offset:12512
    ds_write_b128 v14, v[208:211] offset:1056
    v_alignbit_b32 v124, v208, v207, 16
    v_alignbit_b32 v125, v209, v208, 16
    v_alignbit_b32 v126, v210, v209, 16
    v_alignbit_b32 v127, v211, v210, 16
    ds_write_b128 v14, v[124:127] offset:5216
    v_mov_b32 v128, v207
    v_mov_b32 v129, v208
    v_mov_b32 v130, v209
    v_mov_b32 v131, v210
    ds_write_b128 v14, v[128:131] offset:9376
    v_alignbit_b32 v132, v207, v206, 16
    v_alignbit_b32 v133, v208, v207, 16
    v_alignbit_b32 v134, v209, v208, 16
    v_alignbit_b32 v135, v210, v209, 16
    ds_write_b128 v14, v[132:135] offset:13536
    s_waitcnt lgkmcnt(4)
    ds_write_b128 v14, v[214:217] offset:2080
    v_alignbit_b32 v136, v214, v213, 16
    v_alignbit_b32 v137, v215, v214, 16
    v_alignbit_b32 v138, v216, v215, 16
    v_alignbit_b32 v139, v217, v216, 16
    ds_write_b128 v14, v[136:139] offset:6240
    v_mov_b32 v140, v213
    v_mov_b32 v141, v214
    v_mov_b32 v142, v215
    v_mov_b32 v143, v216
    ds_write_b128 v14, v[140:143] offset:10400
    v_alignbit_b32 v144, v213, v212, 16
    v_alignbit_b32 v145, v214, v213, 16
    v_alignbit_b32 v146, v215, v214, 16
    v_alignbit_b32 v147, v216, v215, 16
    ds_write_b128 v14, v[144:147] offset:14560
    ds_write_b128 v14, v[220:223] offset:3104
    v_alignbit_b32 v148, v220, v219, 16
    v_alignbit_b32 v149, v221, v220, 16
    v_alignbit_b32 v150, v222, v221, 16
    v_alignbit_b32 v151, v223, v222, 16
    ds_write_b128 v14, v[148:151] offset:7264
    v_mov_b32 v152, v219
    v_mov_b32 v153, v220
    v_mov_b32 v154, v221
    v_mov_b32 v155, v222
    ds_write_b128 v14, v[152:155] offset:11424
    v_alignbit_b32 v156, v219, v218, 16
    v_alignbit_b32 v157, v220, v219, 16
    v_alignbit_b32 v158, v221, v220, 16
    v_alignbit_b32 v159, v222, v221, 16
    ds_write_b128 v14, v[156:159] offset:15584
    v_mov_b32 v16, 0
    v_mov_b32 v17, 0
    v_mov_b32 v18, 0
    v_mov_b32 v19, 0
    v_bfe_u32 v20, v0, 1, 2
    v_mul_u32_u24 v20, 4160, v20
    v_and_b32 v14, 1, v0
    v_lshl_add_u32 v20, v14, 4, v20
    v_add_u32 v14, 16640, v5
    v_cmp_gt_u32 vcc, 32, v0
    s_nop 1
    v_cndmask_b32 v20, v20, v14, vcc
    v_add_u32 v20, s10, v20
    ds_write_b128 v20, v[16:19]
    v_bfe_u32 v14, v0, 2, 2
    v_mul_u32_u24 v251, 4160, v14
    v_and_b32 v14, 3, v0
    v_lshl_add_u32 v251, v14, 3, v251
    v_and_b32 v15, 48, v0
    v_sub_u32 v251, v251, v15
    v_and_b32 v253, 15, v0
    v_lshl_add_u32 v253, v253, 5, v15
    s_add_u32 s31, s10, 56
    v_add_u32 v251, s31, v251
    s_add_u32 s31, s10, 16672
    v_add_u32 v253, s31, v253
    s_waitcnt lgkmcnt(0)
    ds_read_b128 v[80:83], v253 offset:448
    ds_read_b64_tr_b16 v[16:17], v251 offset:8
    ds_read_b64_tr_b16 v[18:19], v251 offset:0
    ds_read_b128 v[84:87], v253 offset:960
    ds_read_b64_tr_b16 v[20:21], v251 offset:520
    ds_read_b64_tr_b16 v[22:23], v251 offset:512
    ds_read_b128 v[88:91], v253 offset:1472
    ds_read_b64_tr_b16 v[24:25], v251 offset:1032
    ds_read_b64_tr_b16 v[26:27], v251 offset:1024
    ds_read_b128 v[92:95], v253 offset:1984
    ds_read_b64_tr_b16 v[28:29], v251 offset:1544
    ds_read_b64_tr_b16 v[30:31], v251 offset:1536
    s_waitcnt lgkmcnt(2)
    ds_read_b128 v[96:99], v253 offset:2496
    ds_read_b64_tr_b16 v[32:33], v251 offset:2056
    ds_read_b64_tr_b16 v[34:35], v251 offset:2048
    ds_read_b128 v[100:103], v253 offset:3008
    ds_read_b64_tr_b16 v[36:37], v251 offset:2568
    ds_read_b64_tr_b16 v[38:39], v251 offset:2560
    ds_read_b128 v[104:107], v253 offset:3520
    ds_read_b64_tr_b16 v[40:41], v251 offset:3080
    ds_read_b64_tr_b16 v[42:43], v251 offset:3072
    ds_read_b128 v[108:111], v253 offset:4032
    ds_read_b64_tr_b16 v[44:45], v251 offset:3592
    ds_read_b64_tr_b16 v[46:47], v251 offset:3584
    s_waitcnt lgkmcnt(0)
    v_mfma_f32_16x16x32_bf16 v[216:219], v[16:19], v[80:83], 0
    ds_read_b128 v[112:115], v253 offset:384
    v_mfma_f32_16x16x32_bf16 v[220:223], v[16:19], v[84:87], 0
    ds_read_b64_tr_b16 v[48:49], v251 offset:72
    v_mfma_f32_16x16x32_bf16 v[224:227], v[16:19], v[88:91], 0
    buffer_load_dwordx2 v[196:197], v195, s[52:55], 0 offen sc1
    v_mfma_f32_16x16x32_bf16 v[228:231], v[16:19], v[92:95], 0
    ds_read_b64_tr_b16 v[50:51], v251 offset:64
    v_mfma_f32_16x16x32_bf16 v[232:235], v[16:19], v[96:99], 0
    ds_read_b128 v[116:119], v253 offset:896
    v_mfma_f32_16x16x32_bf16 v[236:239], v[16:19], v[100:103], 0
    ds_write_b128 v192, v[162:165] offset:32
    v_mfma_f32_16x16x32_bf16 v[240:243], v[16:19], v[104:107], 0
    ds_read_b64_tr_b16 v[52:53], v251 offset:584
    v_mfma_f32_16x16x32_bf16 v[244:247], v[16:19], v[108:111], 0
    ds_read_b64_tr_b16 v[54:55], v251 offset:576
    v_mfma_f32_16x16x32_bf16 v[220:223], v[20:23], v[80:83], v[220:223]
    v_alignbit_b32 v144, v162, v161, 16
    v_alignbit_b32 v145, v163, v162, 16
    v_mfma_f32_16x16x32_bf16 v[224:227], v[20:23], v[84:87], v[224:227]
    ds_read_b128 v[120:123], v253 offset:1408
    v_mfma_f32_16x16x32_bf16 v[228:231], v[20:23], v[88:91], v[228:231]
    ds_read_b64_tr_b16 v[56:57], v251 offset:1096
    v_mfma_f32_16x16x32_bf16 v[232:235], v[20:23], v[92:95], v[232:235]
    v_alignbit_b32 v146, v164, v163, 16
    v_alignbit_b32 v147, v165, v164, 16
    ds_read_b64_tr_b16 v[58:59], v251 offset:1088
    v_mfma_f32_16x16x32_bf16 v[236:239], v[20:23], v[96:99], v[236:239]
    ds_read_b128 v[124:127], v253 offset:1920
    v_mfma_f32_16x16x32_bf16 v[240:243], v[20:23], v[100:103], v[240:243]
    ds_write_b128 v192, v[144:147] offset:4192
    v_mfma_f32_16x16x32_bf16 v[244:247], v[20:23], v[104:107], v[244:247]
    ds_read_b64_tr_b16 v[60:61], v251 offset:1608
    v_mfma_f32_16x16x32_bf16 v[224:227], v[24:27], v[80:83], v[224:227]
    ds_read_b64_tr_b16 v[62:63], v251 offset:1600
    v_mfma_f32_16x16x32_bf16 v[228:231], v[24:27], v[84:87], v[228:231]
    v_mov_b32 v148, v161
    v_mov_b32 v149, v162
    v_mfma_f32_16x16x32_bf16 v[232:235], v[24:27], v[88:91], v[232:235]
    ds_read_b128 v[128:131], v253 offset:2432
    v_mfma_f32_16x16x32_bf16 v[236:239], v[24:27], v[92:95], v[236:239]
    ds_read_b64_tr_b16 v[64:65], v251 offset:2120
    v_mfma_f32_16x16x32_bf16 v[240:243], v[24:27], v[96:99], v[240:243]
    ds_read_b64_tr_b16 v[66:67], v251 offset:2112
    v_mfma_f32_16x16x32_bf16 v[244:247], v[24:27], v[100:103], v[244:247]
    v_mov_b32 v150, v163
    v_mov_b32 v151, v164
    v_mfma_f32_16x16x32_bf16 v[228:231], v[28:31], v[80:83], v[228:231]
    ds_read_b128 v[132:135], v253 offset:2944
    v_mfma_f32_16x16x32_bf16 v[232:235], v[28:31], v[84:87], v[232:235]
    ds_read_b64_tr_b16 v[68:69], v251 offset:2632
    ds_write_b128 v192, v[148:151] offset:8352
    v_mfma_f32_16x16x32_bf16 v[236:239], v[28:31], v[88:91], v[236:239]
    ds_read_b64_tr_b16 v[70:71], v251 offset:2624
    v_mfma_f32_16x16x32_bf16 v[240:243], v[28:31], v[92:95], v[240:243]
    ds_read_b128 v[136:139], v253 offset:3456
    v_mfma_f32_16x16x32_bf16 v[244:247], v[28:31], v[96:99], v[244:247]
    v_alignbit_b32 v152, v161, v160, 16
    v_alignbit_b32 v153, v162, v161, 16
    v_mfma_f32_16x16x32_bf16 v[232:235], v[32:35], v[80:83], v[232:235]
    ds_read_b64_tr_b16 v[72:73], v251 offset:3144
    v_mfma_f32_16x16x32_bf16 v[236:239], v[32:35], v[84:87], v[236:239]
    ds_read_b64_tr_b16 v[74:75], v251 offset:3136
    v_mfma_f32_16x16x32_bf16 v[240:243], v[32:35], v[88:91], v[240:243]
    v_alignbit_b32 v154, v163, v162, 16
    v_alignbit_b32 v155, v164, v163, 16
    v_mfma_f32_16x16x32_bf16 v[244:247], v[32:35], v[92:95], v[244:247]
    ds_read_b128 v[140:143], v253 offset:3968
    v_mfma_f32_16x16x32_bf16 v[236:239], v[36:39], v[80:83], v[236:239]
    ds_read_b64_tr_b16 v[76:77], v251 offset:3656
    v_mfma_f32_16x16x32_bf16 v[240:243], v[36:39], v[84:87], v[240:243]
    ds_write_b128 v192, v[152:155] offset:12512
    ds_read_b64_tr_b16 v[78:79], v251 offset:3648
    v_mfma_f32_16x16x32_bf16 v[244:247], v[36:39], v[88:91], v[244:247]
    v_mfma_f32_16x16x32_bf16 v[240:243], v[40:43], v[80:83], v[240:243]
    v_mfma_f32_16x16x32_bf16 v[244:247], v[40:43], v[84:87], v[244:247]
    v_mfma_f32_16x16x32_bf16 v[244:247], v[44:47], v[80:83], v[244:247]
    s_waitcnt lgkmcnt(0)
    v_mfma_f32_16x16x32_bf16 v[216:219], v[48:51], v[112:115], v[216:219]
    ds_read_b128 v[80:83], v253 offset:320
    v_mfma_f32_16x16x32_bf16 v[220:223], v[48:51], v[116:119], v[220:223]
    ds_read_b64_tr_b16 v[16:17], v251 offset:136
    v_mfma_f32_16x16x32_bf16 v[224:227], v[48:51], v[120:123], v[224:227]
    ds_write_b128 v192, v[168:171] offset:1056
    v_mfma_f32_16x16x32_bf16 v[228:231], v[48:51], v[124:127], v[228:231]
    ds_read_b64_tr_b16 v[18:19], v251 offset:128
    v_mfma_f32_16x16x32_bf16 v[232:235], v[48:51], v[128:131], v[232:235]
    ds_read_b128 v[84:87], v253 offset:832
    v_mfma_f32_16x16x32_bf16 v[236:239], v[48:51], v[132:135], v[236:239]
    v_alignbit_b32 v144, v168, v167, 16
    v_alignbit_b32 v145, v169, v168, 16
    v_mfma_f32_16x16x32_bf16 v[240:243], v[48:51], v[136:139], v[240:243]
    ds_read_b64_tr_b16 v[20:21], v251 offset:648
    v_mfma_f32_16x16x32_bf16 v[244:247], v[48:51], v[140:143], v[244:247]
    ds_read_b64_tr_b16 v[22:23], v251 offset:640
    v_mfma_f32_16x16x32_bf16 v[220:223], v[52:55], v[112:115], v[220:223]
    v_alignbit_b32 v146, v170, v169, 16
    v_alignbit_b32 v147, v171, v170, 16
    v_mfma_f32_16x16x32_bf16 v[224:227], v[52:55], v[116:119], v[224:227]
    ds_read_b128 v[88:91], v253 offset:1344
    v_mfma_f32_16x16x32_bf16 v[228:231], v[52:55], v[120:123], v[228:231]
    ds_read_b64_tr_b16 v[24:25], v251 offset:1160
    v_mfma_f32_16x16x32_bf16 v[232:235], v[52:55], v[124:127], v[232:235]
    ds_write_b128 v192, v[144:147] offset:5216
    ds_read_b64_tr_b16 v[26:27], v251 offset:1152
    v_mfma_f32_16x16x32_bf16 v[236:239], v[52:55], v[128:131], v[236:239]
    ds_read_b128 v[92:95], v253 offset:1856
    v_mfma_f32_16x16x32_bf16 v[240:243], v[52:55], v[132:135], v[240:243]
    s_waitcnt vmcnt(0)
    v_cmp_ne_u64 vcc, s[16:17], v[196:197]
    s_nop 3
    s_cbranch_vccnz re_hw
ok_hw:
    buffer_load_dword v9, v9, s[52:55], s92 offen sc1
    v_mfma_f32_16x16x32_bf16 v[244:247], v[52:55], v[136:139], v[244:247]
    ds_read_b64_tr_b16 v[28:29], v251 offset:1672
    v_mfma_f32_16x16x32_bf16 v[224:227], v[56:59], v[112:115], v[224:227]
    ds_read_b64_tr_b16 v[30:31], v251 offset:1664
    v_mfma_f32_16x16x32_bf16 v[228:231], v[56:59], v[116:119], v[228:231]
    buffer_load_dwordx4 a[0:3], v5, s[52:55], s89 offen offset:0 sc1
    v_mfma_f32_16x16x32_bf16 v[232:235], v[56:59], v[120:123], v[232:235]
    ds_read_b128 v[96:99], v253 offset:2368
    v_mfma_f32_16x16x32_bf16 v[236:239], v[56:59], v[124:127], v[236:239]
    ds_read_b64_tr_b16 v[32:33], v251 offset:2184
    v_mfma_f32_16x16x32_bf16 v[240:243], v[56:59], v[128:131], v[240:243]
    ds_read_b64_tr_b16 v[34:35], v251 offset:2176
    v_mfma_f32_16x16x32_bf16 v[244:247], v[56:59], v[132:135], v[244:247]
    buffer_load_dwordx4 a[4:7], v5, s[52:55], s89 offen offset:1024 sc1
    v_mfma_f32_16x16x32_bf16 v[228:231], v[60:63], v[112:115], v[228:231]
    ds_read_b128 v[100:103], v253 offset:2880
    v_mfma_f32_16x16x32_bf16 v[232:235], v[60:63], v[116:119], v[232:235]
    ds_read_b64_tr_b16 v[36:37], v251 offset:2696
    v_mov_b32 v148, v167
    v_mov_b32 v149, v168
    v_mfma_f32_16x16x32_bf16 v[236:239], v[60:63], v[120:123], v[236:239]
    ds_read_b64_tr_b16 v[38:39], v251 offset:2688
    v_mfma_f32_16x16x32_bf16 v[240:243], v[60:63], v[124:127], v[240:243]
    ds_read_b128 v[104:107], v253 offset:3392
    v_mfma_f32_16x16x32_bf16 v[244:247], v[60:63], v[128:131], v[244:247]
    buffer_load_dwordx4 a[8:11], v5, s[52:55], s89 offen offset:2048 sc1
    v_mfma_f32_16x16x32_bf16 v[232:235], v[64:67], v[112:115], v[232:235]
    ds_read_b64_tr_b16 v[40:41], v251 offset:3208
    v_mfma_f32_16x16x32_bf16 v[236:239], v[64:67], v[116:119], v[236:239]
    ds_read_b64_tr_b16 v[42:43], v251 offset:3200
    v_mfma_f32_16x16x32_bf16 v[240:243], v[64:67], v[120:123], v[240:243]
    buffer_load_dwordx4 a[12:15], v5, s[52:55], s89 offen offset:3072 sc1
    s_add_u32 s89, s89, 4096
    v_mfma_f32_16x16x32_bf16 v[244:247], v[64:67], v[124:127], v[244:247]
    ds_read_b128 v[108:111], v253 offset:3904
    v_mfma_f32_16x16x32_bf16 v[236:239], v[68:71], v[112:115], v[236:239]
    ds_read_b64_tr_b16 v[44:45], v251 offset:3720
    v_mfma_f32_16x16x32_bf16 v[240:243], v[68:71], v[116:119], v[240:243]
    buffer_load_dwordx4 a[16:19], v5, s[52:55], s89 offen offset:0 sc1
    ds_read_b64_tr_b16 v[46:47], v251 offset:3712
    v_mfma_f32_16x16x32_bf16 v[244:247], v[68:71], v[120:123], v[244:247]
    v_mfma_f32_16x16x32_bf16 v[240:243], v[72:75], v[112:115], v[240:243]
    v_mfma_f32_16x16x32_bf16 v[244:247], v[72:75], v[116:119], v[244:247]
    v_mfma_f32_16x16x32_bf16 v[244:247], v[76:79], v[112:115], v[244:247]
    s_waitcnt lgkmcnt(0)
    v_mfma_f32_16x16x32_bf16 v[216:219], v[16:19], v[80:83], v[216:219]
    ds_read_b128 v[112:115], v253 offset:256
    v_mfma_f32_16x16x32_bf16 v[220:223], v[16:19], v[84:87], v[220:223]
    ds_read_b64_tr_b16 v[48:49], v251 offset:200
    v_mfma_f32_16x16x32_bf16 v[224:227], v[16:19], v[88:91], v[224:227]
    buffer_load_dwordx4 a[20:23], v5, s[52:55], s89 offen offset:1024 sc1
    v_mfma_f32_16x16x32_bf16 v[228:231], v[16:19], v[92:95], v[228:231]
    ds_read_b64_tr_b16 v[50:51], v251 offset:192
    v_mfma_f32_16x16x32_bf16 v[232:235], v[16:19], v[96:99], v[232:235]
    ds_read_b128 v[116:119], v253 offset:768
    v_mfma_f32_16x16x32_bf16 v[236:239], v[16:19], v[100:103], v[236:239]
    v_mov_b32 v150, v169
    v_mov_b32 v151, v170
    v_mfma_f32_16x16x32_bf16 v[240:243], v[16:19], v[104:107], v[240:243]
    ds_read_b64_tr_b16 v[52:53], v251 offset:712
    v_mfma_f32_16x16x32_bf16 v[244:247], v[16:19], v[108:111], v[244:247]
    ds_read_b64_tr_b16 v[54:55], v251 offset:704
    v_mfma_f32_16x16x32_bf16 v[220:223], v[20:23], v[80:83], v[220:223]
    buffer_load_dwordx4 a[24:27], v5, s[52:55], s89 offen offset:2048 sc1
    v_mfma_f32_16x16x32_bf16 v[224:227], v[20:23], v[84:87], v[224:227]
    ds_read_b128 v[120:123], v253 offset:1280
    v_mfma_f32_16x16x32_bf16 v[228:231], v[20:23], v[88:91], v[228:231]
    ds_read_b64_tr_b16 v[56:57], v251 offset:1224
    v_mfma_f32_16x16x32_bf16 v[232:235], v[20:23], v[92:95], v[232:235]
    buffer_load_dwordx4 a[28:31], v5, s[52:55], s89 offen offset:3072 sc1
    s_add_u32 s89, s89, 4096
    ds_read_b64_tr_b16 v[58:59], v251 offset:1216
    v_mfma_f32_16x16x32_bf16 v[236:239], v[20:23], v[96:99], v[236:239]
    ds_read_b128 v[124:127], v253 offset:1792
    v_mfma_f32_16x16x32_bf16 v[240:243], v[20:23], v[100:103], v[240:243]
    buffer_load_dwordx4 a[32:35], v5, s[52:55], s89 offen offset:0 sc1
    v_mfma_f32_16x16x32_bf16 v[244:247], v[20:23], v[104:107], v[244:247]
    ds_read_b64_tr_b16 v[60:61], v251 offset:1736
    v_mfma_f32_16x16x32_bf16 v[224:227], v[24:27], v[80:83], v[224:227]
    ds_read_b64_tr_b16 v[62:63], v251 offset:1728
    v_mfma_f32_16x16x32_bf16 v[228:231], v[24:27], v[84:87], v[228:231]
    buffer_load_dwordx4 a[36:39], v5, s[52:55], s89 offen offset:1024 sc1
    v_mfma_f32_16x16x32_bf16 v[232:235], v[24:27], v[88:91], v[232:235]
    ds_read_b128 v[128:131], v253 offset:2304
    v_mfma_f32_16x16x32_bf16 v[236:239], v[24:27], v[92:95], v[236:239]
    ds_read_b64_tr_b16 v[64:65], v251 offset:2248
    v_mfma_f32_16x16x32_bf16 v[240:243], v[24:27], v[96:99], v[240:243]
    ds_read_b64_tr_b16 v[66:67], v251 offset:2240
    v_mfma_f32_16x16x32_bf16 v[244:247], v[24:27], v[100:103], v[244:247]
    ds_write_b128 v192, v[148:151] offset:9376
    v_mfma_f32_16x16x32_bf16 v[228:231], v[28:31], v[80:83], v[228:231]
    ds_read_b128 v[132:135], v253 offset:2816
    v_mfma_f32_16x16x32_bf16 v[232:235], v[28:31], v[84:87], v[232:235]
    ds_read_b64_tr_b16 v[68:69], v251 offset:2760
    buffer_load_dwordx4 a[40:43], v5, s[52:55], s89 offen offset:2048 sc1
    v_mfma_f32_16x16x32_bf16 v[236:239], v[28:31], v[88:91], v[236:239]
    ds_read_b64_tr_b16 v[70:71], v251 offset:2752
    v_mfma_f32_16x16x32_bf16 v[240:243], v[28:31], v[92:95], v[240:243]
    ds_read_b128 v[136:139], v253 offset:3328
    v_mfma_f32_16x16x32_bf16 v[244:247], v[28:31], v[96:99], v[244:247]
    buffer_load_dwordx4 a[44:47], v5, s[52:55], s89 offen offset:3072 sc1
    s_add_u32 s89, s89, 4096
    v_mfma_f32_16x16x32_bf16 v[232:235], v[32:35], v[80:83], v[232:235]
    ds_read_b64_tr_b16 v[72:73], v251 offset:3272
    v_mfma_f32_16x16x32_bf16 v[236:239], v[32:35], v[84:87], v[236:239]
    ds_read_b64_tr_b16 v[74:75], v251 offset:3264
    v_mfma_f32_16x16x32_bf16 v[240:243], v[32:35], v[88:91], v[240:243]
    buffer_load_dwordx4 a[48:51], v5, s[52:55], s89 offen offset:0 sc1
    v_mfma_f32_16x16x32_bf16 v[244:247], v[32:35], v[92:95], v[244:247]
    ds_read_b128 v[140:143], v253 offset:3840
    v_mfma_f32_16x16x32_bf16 v[236:239], v[36:39], v[80:83], v[236:239]
    ds_read_b64_tr_b16 v[76:77], v251 offset:3784
    v_mfma_f32_16x16x32_bf16 v[240:243], v[36:39], v[84:87], v[240:243]
    buffer_load_dwordx4 a[52:55], v5, s[52:55], s89 offen offset:1024 sc1
    ds_read_b64_tr_b16 v[78:79], v251 offset:3776
    v_mfma_f32_16x16x32_bf16 v[244:247], v[36:39], v[88:91], v[244:247]
    v_mfma_f32_16x16x32_bf16 v[240:243], v[40:43], v[80:83], v[240:243]
    v_mfma_f32_16x16x32_bf16 v[244:247], v[40:43], v[84:87], v[244:247]
    v_mfma_f32_16x16x32_bf16 v[244:247], v[44:47], v[80:83], v[244:247]
    s_waitcnt lgkmcnt(0)
    v_mfma_f32_16x16x32_bf16 v[216:219], v[48:51], v[112:115], v[216:219]
    ds_read_b128 v[80:83], v253 offset:192
    v_mfma_f32_16x16x32_bf16 v[220:223], v[48:51], v[116:119], v[220:223]
    v_alignbit_b32 v152, v167, v166, 16
    v_alignbit_b32 v153, v168, v167, 16
    v_mfma_f32_16x16x32_bf16 v[224:227], v[48:51], v[120:123], v[224:227]
    ds_read_b64_tr_b16 v[16:17], v251 offset:264
    v_mfma_f32_16x16x32_bf16 v[228:231], v[48:51], v[124:127], v[228:231]
    ds_read_b64_tr_b16 v[18:19], v251 offset:256
    v_mfma_f32_16x16x32_bf16 v[232:235], v[48:51], v[128:131], v[232:235]
    buffer_load_dwordx4 a[56:59], v5, s[52:55], s89 offen offset:2048 sc1
    v_mfma_f32_16x16x32_bf16 v[236:239], v[48:51], v[132:135], v[236:239]
    ds_read_b128 v[84:87], v253 offset:704
    v_mfma_f32_16x16x32_bf16 v[240:243], v[48:51], v[136:139], v[240:243]
    ds_read_b64_tr_b16 v[20:21], v251 offset:776
    v_mfma_f32_16x16x32_bf16 v[244:247], v[48:51], v[140:143], v[244:247]
    buffer_load_dwordx4 a[60:63], v5, s[52:55], s89 offen offset:3072 sc1
    s_add_u32 s89, s89, 4096
    v_mfma_f32_16x16x32_bf16 v[220:223], v[52:55], v[112:115], v[220:223]
    ds_read_b64_tr_b16 v[22:23], v251 offset:768
    ds_read_b128 v[88:91], v253 offset:1216
    v_mfma_f32_16x16x32_bf16 v[224:227], v[52:55], v[116:119], v[224:227]
    buffer_load_dwordx4 a[64:67], v5, s[52:55], s89 offen offset:0 sc1
    v_mfma_f32_16x16x32_bf16 v[228:231], v[52:55], v[120:123], v[228:231]
    ds_read_b64_tr_b16 v[24:25], v251 offset:1288
    v_mfma_f32_16x16x32_bf16 v[232:235], v[52:55], v[124:127], v[232:235]
    ds_read_b64_tr_b16 v[26:27], v251 offset:1280
    v_mfma_f32_16x16x32_bf16 v[236:239], v[52:55], v[128:131], v[236:239]
    buffer_load_dwordx4 a[68:71], v5, s[52:55], s89 offen offset:1024 sc1
    v_mfma_f32_16x16x32_bf16 v[240:243], v[52:55], v[132:135], v[240:243]
    ds_read_b128 v[92:95], v253 offset:1728
    v_mfma_f32_16x16x32_bf16 v[244:247], v[52:55], v[136:139], v[244:247]
    ds_read_b64_tr_b16 v[28:29], v251 offset:1800
    v_mfma_f32_16x16x32_bf16 v[224:227], v[56:59], v[112:115], v[224:227]
    v_alignbit_b32 v154, v169, v168, 16
    v_alignbit_b32 v155, v170, v169, 16
    v_mfma_f32_16x16x32_bf16 v[228:231], v[56:59], v[116:119], v[228:231]
    ds_read_b64_tr_b16 v[30:31], v251 offset:1792
    ds_read_b128 v[96:99], v253 offset:2240
    v_mfma_f32_16x16x32_bf16 v[232:235], v[56:59], v[120:123], v[232:235]
    buffer_load_dwordx4 a[72:75], v5, s[52:55], s89 offen offset:2048 sc1
    v_mfma_f32_16x16x32_bf16 v[236:239], v[56:59], v[124:127], v[236:239]
    ds_read_b64_tr_b16 v[32:33], v251 offset:2312
    v_mfma_f32_16x16x32_bf16 v[240:243], v[56:59], v[128:131], v[240:243]
    ds_read_b64_tr_b16 v[34:35], v251 offset:2304
    v_mfma_f32_16x16x32_bf16 v[244:247], v[56:59], v[132:135], v[244:247]
    buffer_load_dwordx4 a[76:79], v5, s[52:55], s89 offen offset:3072 sc1
    s_add_u32 s89, s89, 4096
    v_mfma_f32_16x16x32_bf16 v[228:231], v[60:63], v[112:115], v[228:231]
    ds_read_b128 v[100:103], v253 offset:2752
    v_mfma_f32_16x16x32_bf16 v[232:235], v[60:63], v[116:119], v[232:235]
    ds_read_b64_tr_b16 v[36:37], v251 offset:2824
    v_mfma_f32_16x16x32_bf16 v[236:239], v[60:63], v[120:123], v[236:239]
    buffer_load_dwordx4 a[80:83], v5, s[52:55], s89 offen offset:0 sc1
    v_mfma_f32_16x16x32_bf16 v[240:243], v[60:63], v[124:127], v[240:243]
    ds_read_b64_tr_b16 v[38:39], v251 offset:2816
    ds_read_b128 v[104:107], v253 offset:3264
    v_mfma_f32_16x16x32_bf16 v[244:247], v[60:63], v[128:131], v[244:247]
    buffer_load_dwordx4 a[84:87], v5, s[52:55], s89 offen offset:1024 sc1
    v_mfma_f32_16x16x32_bf16 v[232:235], v[64:67], v[112:115], v[232:235]
    ds_read_b64_tr_b16 v[40:41], v251 offset:3336
    v_mfma_f32_16x16x32_bf16 v[236:239], v[64:67], v[116:119], v[236:239]
    ds_read_b64_tr_b16 v[42:43], v251 offset:3328
    v_mfma_f32_16x16x32_bf16 v[240:243], v[64:67], v[120:123], v[240:243]
    ds_write_b128 v192, v[152:155] offset:13536
    v_mfma_f32_16x16x32_bf16 v[244:247], v[64:67], v[124:127], v[244:247]
    ds_read_b128 v[108:111], v253 offset:3776
    v_mfma_f32_16x16x32_bf16 v[236:239], v[68:71], v[112:115], v[236:239]
    ds_read_b64_tr_b16 v[44:45], v251 offset:3848
    v_mfma_f32_16x16x32_bf16 v[240:243], v[68:71], v[116:119], v[240:243]
    buffer_load_dwordx4 a[88:91], v5, s[52:55], s89 offen offset:2048 sc1
    ds_read_b64_tr_b16 v[46:47], v251 offset:3840
    v_mfma_f32_16x16x32_bf16 v[244:247], v[68:71], v[120:123], v[244:247]
    v_mfma_f32_16x16x32_bf16 v[240:243], v[72:75], v[112:115], v[240:243]
    v_mfma_f32_16x16x32_bf16 v[244:247], v[72:75], v[116:119], v[244:247]
    v_mfma_f32_16x16x32_bf16 v[244:247], v[76:79], v[112:115], v[244:247]
    s_waitcnt lgkmcnt(0)
    v_mfma_f32_16x16x32_bf16 v[216:219], v[16:19], v[80:83], v[216:219]
    ds_read_b128 v[112:115], v253 offset:128
    v_mfma_f32_16x16x32_bf16 v[220:223], v[16:19], v[84:87], v[220:223]
    ds_read_b64_tr_b16 v[48:49], v251 offset:328
    v_mfma_f32_16x16x32_bf16 v[224:227], v[16:19], v[88:91], v[224:227]
    buffer_load_dwordx4 a[92:95], v5, s[52:55], s89 offen offset:3072 sc1
    s_add_u32 s89, s89, 4096
    v_mfma_f32_16x16x32_bf16 v[228:231], v[16:19], v[92:95], v[228:231]
    ds_read_b64_tr_b16 v[50:51], v251 offset:320
    v_mfma_f32_16x16x32_bf16 v[232:235], v[16:19], v[96:99], v[232:235]
    ds_read_b128 v[116:119], v253 offset:640
    v_mfma_f32_16x16x32_bf16 v[236:239], v[16:19], v[100:103], v[236:239]
    buffer_load_dwordx4 a[96:99], v5, s[52:55], s89 offen offset:0 sc1
    v_mfma_f32_16x16x32_bf16 v[240:243], v[16:19], v[104:107], v[240:243]
    ds_read_b64_tr_b16 v[52:53], v251 offset:840
    v_mfma_f32_16x16x32_bf16 v[244:247], v[16:19], v[108:111], v[244:247]
    ds_read_b64_tr_b16 v[54:55], v251 offset:832
    v_mfma_f32_16x16x32_bf16 v[220:223], v[20:23], v[80:83], v[220:223]
    v_mov_b32 v156, 0
    v_mov_b32 v157, 0
    v_mfma_f32_16x16x32_bf16 v[224:227], v[20:23], v[84:87], v[224:227]
    ds_read_b128 v[120:123], v253 offset:1152
    v_mfma_f32_16x16x32_bf16 v[228:231], v[20:23], v[88:91], v[228:231]
    ds_read_b64_tr_b16 v[56:57], v251 offset:1352
    v_mfma_f32_16x16x32_bf16 v[232:235], v[20:23], v[92:95], v[232:235]
    buffer_load_dwordx4 a[100:103], v5, s[52:55], s89 offen offset:1024 sc1
    ds_read_b64_tr_b16 v[58:59], v251 offset:1344
    v_mfma_f32_16x16x32_bf16 v[236:239], v[20:23], v[96:99], v[236:239]
    ds_read_b128 v[124:127], v253 offset:1664
    v_mfma_f32_16x16x32_bf16 v[240:243], v[20:23], v[100:103], v[240:243]
    buffer_load_dwordx4 a[104:107], v5, s[52:55], s89 offen offset:2048 sc1
    v_mfma_f32_16x16x32_bf16 v[244:247], v[20:23], v[104:107], v[244:247]
    ds_read_b64_tr_b16 v[60:61], v251 offset:1864
    v_mfma_f32_16x16x32_bf16 v[224:227], v[24:27], v[80:83], v[224:227]
    ds_read_b64_tr_b16 v[62:63], v251 offset:1856
    v_mfma_f32_16x16x32_bf16 v[228:231], v[24:27], v[84:87], v[228:231]
    buffer_load_dwordx4 a[108:111], v5, s[52:55], s89 offen offset:3072 sc1
    s_add_u32 s89, s89, 4096
    v_mfma_f32_16x16x32_bf16 v[232:235], v[24:27], v[88:91], v[232:235]
    ds_read_b128 v[128:131], v253 offset:2176
    v_mfma_f32_16x16x32_bf16 v[236:239], v[24:27], v[92:95], v[236:239]
    ds_read_b64_tr_b16 v[64:65], v251 offset:2376
    v_mfma_f32_16x16x32_bf16 v[240:243], v[24:27], v[96:99], v[240:243]
    ds_read_b64_tr_b16 v[66:67], v251 offset:2368
    v_mfma_f32_16x16x32_bf16 v[244:247], v[24:27], v[100:103], v[244:247]
    buffer_load_dwordx4 a[112:115], v5, s[52:55], s89 offen offset:0 sc1
    v_mfma_f32_16x16x32_bf16 v[228:231], v[28:31], v[80:83], v[228:231]
    ds_read_b128 v[132:135], v253 offset:2688
    v_mfma_f32_16x16x32_bf16 v[232:235], v[28:31], v[84:87], v[232:235]
    ds_read_b64_tr_b16 v[68:69], v251 offset:2888
    v_mov_b32 v158, 0
    v_mov_b32 v159, 0
    v_mfma_f32_16x16x32_bf16 v[236:239], v[28:31], v[88:91], v[236:239]
    ds_read_b64_tr_b16 v[70:71], v251 offset:2880
    v_mfma_f32_16x16x32_bf16 v[240:243], v[28:31], v[92:95], v[240:243]
    ds_read_b128 v[136:139], v253 offset:3200
    v_mfma_f32_16x16x32_bf16 v[244:247], v[28:31], v[96:99], v[244:247]
    buffer_load_dwordx4 a[116:119], v5, s[52:55], s89 offen offset:1024 sc1
    s_mul_i32 s31, s93, -61440
    s_add_u32 s89, s89, s31
    v_mfma_f32_16x16x32_bf16 v[232:235], v[32:35], v[80:83], v[232:235]
    ds_read_b64_tr_b16 v[72:73], v251 offset:3400
    v_mfma_f32_16x16x32_bf16 v[236:239], v[32:35], v[84:87], v[236:239]
    ds_read_b64_tr_b16 v[74:75], v251 offset:3392
    v_mfma_f32_16x16x32_bf16 v[240:243], v[32:35], v[88:91], v[240:243]
    buffer_load_dwordx4 a[120:123], v5, s[52:55], s89 offen offset:2048 sc1
    v_mfma_f32_16x16x32_bf16 v[244:247], v[32:35], v[92:95], v[244:247]
    ds_read_b128 v[140:143], v253 offset:3712
    v_mfma_f32_16x16x32_bf16 v[236:239], v[36:39], v[80:83], v[236:239]
    ds_read_b64_tr_b16 v[76:77], v251 offset:3912
    v_mfma_f32_16x16x32_bf16 v[240:243], v[36:39], v[84:87], v[240:243]
    buffer_load_dwordx4 a[124:127], v5, s[52:55], s89 offen offset:3072 sc1
    s_add_u32 s89, s89, 4096
    ds_read_b64_tr_b16 v[78:79], v251 offset:3904
    v_mfma_f32_16x16x32_bf16 v[244:247], v[36:39], v[88:91], v[244:247]
    v_mfma_f32_16x16x32_bf16 v[240:243], v[40:43], v[80:83], v[240:243]
    v_mfma_f32_16x16x32_bf16 v[244:247], v[40:43], v[84:87], v[244:247]
    v_mfma_f32_16x16x32_bf16 v[244:247], v[44:47], v[80:83], v[244:247]
    s_waitcnt lgkmcnt(0)
    v_mfma_f32_16x16x32_bf16 v[216:219], v[48:51], v[112:115], v[216:219]
    ds_read_b128 v[80:83], v253 offset:64
    v_mfma_f32_16x16x32_bf16 v[220:223], v[48:51], v[116:119], v[220:223]
    ds_read_b64_tr_b16 v[16:17], v251 offset:392
    v_mfma_f32_16x16x32_bf16 v[224:227], v[48:51], v[120:123], v[224:227]
    buffer_load_dwordx4 a[128:131], v5, s[52:55], s89 offen offset:0 sc1
    v_mfma_f32_16x16x32_bf16 v[228:231], v[48:51], v[124:127], v[228:231]
    ds_read_b64_tr_b16 v[18:19], v251 offset:384
    v_mfma_f32_16x16x32_bf16 v[232:235], v[48:51], v[128:131], v[232:235]
    ds_read_b128 v[84:87], v253 offset:576
    v_mfma_f32_16x16x32_bf16 v[236:239], v[48:51], v[132:135], v[236:239]
    v_bfe_u32 v172, v0, 1, 2
    v_mul_u32_u24 v172, 4160, v172
    v_mfma_f32_16x16x32_bf16 v[240:243], v[48:51], v[136:139], v[240:243]
    ds_read_b64_tr_b16 v[20:21], v251 offset:904
    v_mfma_f32_16x16x32_bf16 v[244:247], v[48:51], v[140:143], v[244:247]
    ds_read_b64_tr_b16 v[22:23], v251 offset:896
    v_mfma_f32_16x16x32_bf16 v[220:223], v[52:55], v[112:115], v[220:223]
    buffer_load_dwordx4 a[132:135], v5, s[52:55], s89 offen offset:1024 sc1
    v_mfma_f32_16x16x32_bf16 v[224:227], v[52:55], v[116:119], v[224:227]
    ds_read_b128 v[88:91], v253 offset:1088
    v_mfma_f32_16x16x32_bf16 v[228:231], v[52:55], v[120:123], v[228:231]
    ds_read_b64_tr_b16 v[24:25], v251 offset:1416
    v_mfma_f32_16x16x32_bf16 v[232:235], v[52:55], v[124:127], v[232:235]
    buffer_load_dwordx4 a[136:139], v5, s[52:55], s89 offen offset:2048 sc1
    ds_read_b64_tr_b16 v[26:27], v251 offset:1408
    v_mfma_f32_16x16x32_bf16 v[236:239], v[52:55], v[128:131], v[236:239]
    ds_read_b128 v[92:95], v253 offset:1600
    v_mfma_f32_16x16x32_bf16 v[240:243], v[52:55], v[132:135], v[240:243]
    buffer_load_dwordx4 a[140:143], v5, s[52:55], s89 offen offset:3072 sc1
    s_add_u32 s89, s89, 4096
    v_mfma_f32_16x16x32_bf16 v[244:247], v[52:55], v[136:139], v[244:247]
    ds_read_b64_tr_b16 v[28:29], v251 offset:1928
    v_mfma_f32_16x16x32_bf16 v[224:227], v[56:59], v[112:115], v[224:227]
    ds_read_b64_tr_b16 v[30:31], v251 offset:1920
    v_mfma_f32_16x16x32_bf16 v[228:231], v[56:59], v[116:119], v[228:231]
    buffer_load_dwordx4 a[144:147], v5, s[52:55], s89 offen offset:0 sc1
    v_mfma_f32_16x16x32_bf16 v[232:235], v[56:59], v[120:123], v[232:235]
    ds_read_b128 v[96:99], v253 offset:2112
    v_mfma_f32_16x16x32_bf16 v[236:239], v[56:59], v[124:127], v[236:239]
    ds_read_b64_tr_b16 v[32:33], v251 offset:2440
    v_mfma_f32_16x16x32_bf16 v[240:243], v[56:59], v[128:131], v[240:243]
    ds_read_b64_tr_b16 v[34:35], v251 offset:2432
    v_mfma_f32_16x16x32_bf16 v[244:247], v[56:59], v[132:135], v[244:247]
    v_and_b32 v14, 1, v0
    v_mfma_f32_16x16x32_bf16 v[228:231], v[60:63], v[112:115], v[228:231]
    ds_read_b128 v[100:103], v253 offset:2624
    v_mfma_f32_16x16x32_bf16 v[232:235], v[60:63], v[116:119], v[232:235]
    ds_read_b64_tr_b16 v[36:37], v251 offset:2952
    buffer_load_dwordx4 a[148:151], v5, s[52:55], s89 offen offset:1024 sc1
    v_mfma_f32_16x16x32_bf16 v[236:239], v[60:63], v[120:123], v[236:239]
    ds_read_b64_tr_b16 v[38:39], v251 offset:2944
    v_mfma_f32_16x16x32_bf16 v[240:243], v[60:63], v[124:127], v[240:243]
    ds_read_b128 v[104:107], v253 offset:3136
    v_mfma_f32_16x16x32_bf16 v[244:247], v[60:63], v[128:131], v[244:247]
    buffer_load_dwordx4 a[152:155], v5, s[52:55], s89 offen offset:2048 sc1
    v_mfma_f32_16x16x32_bf16 v[232:235], v[64:67], v[112:115], v[232:235]
    ds_read_b64_tr_b16 v[40:41], v251 offset:3464
    v_mfma_f32_16x16x32_bf16 v[236:239], v[64:67], v[116:119], v[236:239]
    ds_read_b64_tr_b16 v[42:43], v251 offset:3456
    v_mfma_f32_16x16x32_bf16 v[240:243], v[64:67], v[120:123], v[240:243]
    buffer_load_dwordx4 a[156:159], v5, s[52:55], s89 offen offset:3072 sc1
    s_add_u32 s89, s89, 4096
    v_mfma_f32_16x16x32_bf16 v[244:247], v[64:67], v[124:127], v[244:247]
    ds_read_b128 v[108:111], v253 offset:3648
    v_mfma_f32_16x16x32_bf16 v[236:239], v[68:71], v[112:115], v[236:239]
    ds_read_b64_tr_b16 v[44:45], v251 offset:3976
    v_mfma_f32_16x16x32_bf16 v[240:243], v[68:71], v[116:119], v[240:243]
    buffer_load_dwordx4 a[160:163], v5, s[52:55], s89 offen offset:0 sc1
    ds_read_b64_tr_b16 v[46:47], v251 offset:3968
    v_mfma_f32_16x16x32_bf16 v[244:247], v[68:71], v[120:123], v[244:247]
    v_mfma_f32_16x16x32_bf16 v[240:243], v[72:75], v[112:115], v[240:243]
    v_mfma_f32_16x16x32_bf16 v[244:247], v[72:75], v[116:119], v[244:247]
    v_mfma_f32_16x16x32_bf16 v[244:247], v[76:79], v[112:115], v[244:247]
    s_waitcnt lgkmcnt(0)
    v_mfma_f32_16x16x32_bf16 v[216:219], v[16:19], v[80:83], v[216:219]
    ds_read_b128 v[112:115], v253 offset:0
    v_mfma_f32_16x16x32_bf16 v[220:223], v[16:19], v[84:87], v[220:223]
    v_lshl_add_u32 v172, v14, 4, v172
    v_add_u32 v14, 16640, v5
    v_cmp_gt_u32 vcc, 32, v0
    v_mfma_f32_16x16x32_bf16 v[224:227], v[16:19], v[88:91], v[224:227]
    ds_read_b64_tr_b16 v[48:49], v251 offset:456
    v_mfma_f32_16x16x32_bf16 v[228:231], v[16:19], v[92:95], v[228:231]
    ds_read_b64_tr_b16 v[50:51], v251 offset:448
    v_mfma_f32_16x16x32_bf16 v[232:235], v[16:19], v[96:99], v[232:235]
    buffer_load_dwordx4 a[164:167], v5, s[52:55], s89 offen offset:1024 sc1
    v_mfma_f32_16x16x32_bf16 v[236:239], v[16:19], v[100:103], v[236:239]
    ds_read_b128 v[116:119], v253 offset:512
    v_mfma_f32_16x16x32_bf16 v[240:243], v[16:19], v[104:107], v[240:243]
    ds_read_b64_tr_b16 v[52:53], v251 offset:968
    v_mfma_f32_16x16x32_bf16 v[244:247], v[16:19], v[108:111], v[244:247]
    buffer_load_dwordx4 a[168:171], v5, s[52:55], s89 offen offset:2048 sc1
    v_mfma_f32_16x16x32_bf16 v[220:223], v[20:23], v[80:83], v[220:223]
    ds_read_b64_tr_b16 v[54:55], v251 offset:960
    ds_read_b128 v[120:123], v253 offset:1024
    v_mfma_f32_16x16x32_bf16 v[224:227], v[20:23], v[84:87], v[224:227]
    buffer_load_dwordx4 a[172:175], v5, s[52:55], s89 offen offset:3072 sc1
    s_add_u32 s89, s89, 4096
    v_mfma_f32_16x16x32_bf16 v[228:231], v[20:23], v[88:91], v[228:231]
    ds_read_b64_tr_b16 v[56:57], v251 offset:1480
    v_mfma_f32_16x16x32_bf16 v[232:235], v[20:23], v[92:95], v[232:235]
    ds_read_b64_tr_b16 v[58:59], v251 offset:1472
    v_mfma_f32_16x16x32_bf16 v[236:239], v[20:23], v[96:99], v[236:239]
    buffer_load_dwordx4 a[176:179], v5, s[52:55], s89 offen offset:0 sc1
    v_mfma_f32_16x16x32_bf16 v[240:243], v[20:23], v[100:103], v[240:243]
    ds_read_b128 v[124:127], v253 offset:1536
    v_mfma_f32_16x16x32_bf16 v[244:247], v[20:23], v[104:107], v[244:247]
    ds_read_b64_tr_b16 v[60:61], v251 offset:1992
    v_mfma_f32_16x16x32_bf16 v[224:227], v[24:27], v[80:83], v[224:227]
    s_nop 1
    v_cndmask_b32 v172, v172, v14, vcc
    v_add_u32 v172, s71, v172
    v_mfma_f32_16x16x32_bf16 v[228:231], v[24:27], v[84:87], v[228:231]
    ds_read_b64_tr_b16 v[62:63], v251 offset:1984
    ds_read_b128 v[128:131], v253 offset:2048
    v_mfma_f32_16x16x32_bf16 v[232:235], v[24:27], v[88:91], v[232:235]
    buffer_load_dwordx4 a[180:183], v5, s[52:55], s89 offen offset:1024 sc1
    v_mfma_f32_16x16x32_bf16 v[236:239], v[24:27], v[92:95], v[236:239]
    ds_read_b64_tr_b16 v[64:65], v251 offset:2504
    v_mfma_f32_16x16x32_bf16 v[240:243], v[24:27], v[96:99], v[240:243]
    ds_read_b64_tr_b16 v[66:67], v251 offset:2496
    v_mfma_f32_16x16x32_bf16 v[244:247], v[24:27], v[100:103], v[244:247]
    buffer_load_dwordx4 a[184:187], v5, s[52:55], s89 offen offset:2048 sc1
    v_mfma_f32_16x16x32_bf16 v[228:231], v[28:31], v[80:83], v[228:231]
    ds_read_b128 v[132:135], v253 offset:2560
    v_mfma_f32_16x16x32_bf16 v[232:235], v[28:31], v[84:87], v[232:235]
    ds_read_b64_tr_b16 v[68:69], v251 offset:3016
    v_mfma_f32_16x16x32_bf16 v[236:239], v[28:31], v[88:91], v[236:239]
    buffer_load_dwordx4 a[188:191], v5, s[52:55], s89 offen offset:3072 sc1
    s_add_u32 s89, s89, 4096
    v_mfma_f32_16x16x32_bf16 v[240:243], v[28:31], v[92:95], v[240:243]
    ds_read_b64_tr_b16 v[70:71], v251 offset:3008
    ds_read_b128 v[136:139], v253 offset:3072
    v_mfma_f32_16x16x32_bf16 v[244:247], v[28:31], v[96:99], v[244:247]
    buffer_load_dwordx4 a[192:195], v5, s[52:55], s89 offen offset:0 sc1
    v_mfma_f32_16x16x32_bf16 v[232:235], v[32:35], v[80:83], v[232:235]
    ds_read_b64_tr_b16 v[72:73], v251 offset:3528
    v_mfma_f32_16x16x32_bf16 v[236:239], v[32:35], v[84:87], v[236:239]
    ds_read_b64_tr_b16 v[74:75], v251 offset:3520
    v_mfma_f32_16x16x32_bf16 v[240:243], v[32:35], v[88:91], v[240:243]
    ds_write_b128 v172, v[156:159]
    v_mfma_f32_16x16x32_bf16 v[244:247], v[32:35], v[92:95], v[244:247]
    ds_read_b128 v[140:143], v253 offset:3584
    v_mfma_f32_16x16x32_bf16 v[236:239], v[36:39], v[80:83], v[236:239]
    ds_read_b64_tr_b16 v[76:77], v251 offset:4040
    v_mfma_f32_16x16x32_bf16 v[240:243], v[36:39], v[84:87], v[240:243]
    buffer_load_dwordx4 a[196:199], v5, s[52:55], s89 offen offset:1024 sc1
    ds_read_b64_tr_b16 v[78:79], v251 offset:4032
    v_mfma_f32_16x16x32_bf16 v[244:247], v[36:39], v[88:91], v[244:247]
    v_mfma_f32_16x16x32_bf16 v[240:243], v[40:43], v[80:83], v[240:243]
    v_mfma_f32_16x16x32_bf16 v[244:247], v[40:43], v[84:87], v[244:247]
    v_mfma_f32_16x16x32_bf16 v[244:247], v[44:47], v[80:83], v[244:247]
    s_waitcnt lgkmcnt(0)
    v_mfma_f32_16x16x32_bf16 v[216:219], v[48:51], v[112:115], v[216:219]
    v_lshrrev_b32 v14, 1, v0
    v_and_b32 v14, 24, v14
    v_mfma_f32_16x16x32_bf16 v[220:223], v[48:51], v[116:119], v[220:223]
    v_mfma_f32_16x16x32_bf16 v[224:227], v[48:51], v[120:123], v[224:227]
    v_and_b32 v15, 15, v0
    v_lshl_add_u32 v14, v15, 5, v14
    v_mfma_f32_16x16x32_bf16 v[228:231], v[48:51], v[124:127], v[228:231]
    v_add_u32 v14, s10, v14
    v_add_u32 v15, s10, v5
    v_mfma_f32_16x16x32_bf16 v[232:235], v[48:51], v[128:131], v[232:235]
    ds_read_b64 v[144:145], v14 offset:32
    v_mfma_f32_16x16x32_bf16 v[236:239], v[48:51], v[132:135], v[236:239]
    ds_read_b64 v[146:147], v14 offset:544
    v_mfma_f32_16x16x32_bf16 v[240:243], v[48:51], v[136:139], v[240:243]
    ds_read_b64 v[148:149], v14 offset:1056
    v_mfma_f32_16x16x32_bf16 v[244:247], v[48:51], v[140:143], v[244:247]
    ds_read_b64 v[150:151], v14 offset:1568
    v_mfma_f32_16x16x32_bf16 v[220:223], v[52:55], v[112:115], v[220:223]
    v_mfma_f32_16x16x32_bf16 v[224:227], v[52:55], v[116:119], v[224:227]
    ds_read_b64 v[152:153], v14 offset:2080
    v_mfma_f32_16x16x32_bf16 v[228:231], v[52:55], v[120:123], v[228:231]
    ds_read_b64 v[154:155], v14 offset:2592
    v_mfma_f32_16x16x32_bf16 v[232:235], v[52:55], v[124:127], v[232:235]
    ds_read_b64 v[156:157], v14 offset:3104
    v_mfma_f32_16x16x32_bf16 v[236:239], v[52:55], v[128:131], v[236:239]
    ds_read_b64 v[158:159], v14 offset:3616
    v_mfma_f32_16x16x32_bf16 v[240:243], v[52:55], v[132:135], v[240:243]
    s_and_b32 s31, s9, 1
    s_lshl_b32 s31, s31, 4
    v_mfma_f32_16x16x32_bf16 v[244:247], v[52:55], v[136:139], v[244:247]
    s_lshr_b32 s34, s7, s31
    s_lshl_b32 s34, s34, 16
    v_mfma_f32_16x16x32_bf16 v[224:227], v[56:59], v[112:115], v[224:227]
    v_mfma_f32_16x16x32_bf16 v[228:231], v[56:59], v[116:119], v[228:231]
    s_lshl_b32 s36, s9, 12
    s_add_u32 s36, s36, 0xd00000
    v_mfma_f32_16x16x32_bf16 v[232:235], v[56:59], v[120:123], v[232:235]
    s_waitcnt lgkmcnt(0)
    v_mfma_f32_16x16x32_bf16 v[236:239], v[56:59], v[124:127], v[236:239]
    v_lshlrev_b32 v16, 16, v144
    v_and_b32 v17, 0xffff0000, v144
    v_mfma_f32_16x16x32_bf16 v[240:243], v[56:59], v[128:131], v[240:243]
    v_lshlrev_b32 v18, 16, v145
    v_and_b32 v19, 0xffff0000, v145
    v_mfma_f32_16x16x32_bf16 v[244:247], v[56:59], v[132:135], v[244:247]
    v_lshlrev_b32 v20, 16, v146
    v_and_b32 v21, 0xffff0000, v146
    v_mfma_f32_16x16x32_bf16 v[228:231], v[60:63], v[112:115], v[228:231]
    v_lshlrev_b32 v22, 16, v147
    v_and_b32 v23, 0xffff0000, v147
    v_mfma_f32_16x16x32_bf16 v[232:235], v[60:63], v[116:119], v[232:235]
    v_mfma_f32_16x16x32_bf16 v[236:239], v[60:63], v[120:123], v[236:239]
    v_lshlrev_b32 v24, 16, v148
    v_and_b32 v25, 0xffff0000, v148
    v_mfma_f32_16x16x32_bf16 v[240:243], v[60:63], v[124:127], v[240:243]
    v_lshlrev_b32 v26, 16, v149
    v_and_b32 v27, 0xffff0000, v149
    v_mfma_f32_16x16x32_bf16 v[244:247], v[60:63], v[128:131], v[244:247]
    v_lshlrev_b32 v28, 16, v150
    v_and_b32 v29, 0xffff0000, v150
    v_mfma_f32_16x16x32_bf16 v[232:235], v[64:67], v[112:115], v[232:235]
    v_lshlrev_b32 v30, 16, v151
    v_and_b32 v31, 0xffff0000, v151
    v_mfma_f32_16x16x32_bf16 v[236:239], v[64:67], v[116:119], v[236:239]
    v_lshlrev_b32 v32, 16, v152
    v_and_b32 v33, 0xffff0000, v152
    v_mfma_f32_16x16x32_bf16 v[240:243], v[64:67], v[120:123], v[240:243]
    v_lshlrev_b32 v34, 16, v153
    v_and_b32 v35, 0xffff0000, v153
    v_mfma_f32_16x16x32_bf16 v[244:247], v[64:67], v[124:127], v[244:247]
    v_mfma_f32_16x16x32_bf16 v[236:239], v[68:71], v[112:115], v[236:239]
    v_lshlrev_b32 v36, 16, v154
    v_and_b32 v37, 0xffff0000, v154
    v_mfma_f32_16x16x32_bf16 v[240:243], v[68:71], v[116:119], v[240:243]
    v_lshlrev_b32 v38, 16, v155
    v_and_b32 v39, 0xffff0000, v155
    v_mfma_f32_16x16x32_bf16 v[244:247], v[68:71], v[120:123], v[244:247]
    v_lshlrev_b32 v40, 16, v156
    v_and_b32 v41, 0xffff0000, v156
    v_mfma_f32_16x16x32_bf16 v[240:243], v[72:75], v[112:115], v[240:243]
    v_lshlrev_b32 v42, 16, v157
    v_and_b32 v43, 0xffff0000, v157
    v_mfma_f32_16x16x32_bf16 v[244:247], v[72:75], v[116:119], v[244:247]
    v_lshlrev_b32 v44, 16, v158
    v_and_b32 v45, 0xffff0000, v158
    v_mfma_f32_16x16x32_bf16 v[244:247], v[76:79], v[112:115], v[244:247]
    v_lshlrev_b32 v46, 16, v159
    v_and_b32 v47, 0xffff0000, v159
    s_nop 6
    v_fmac_f32 v216, s34, v16
    v_fmac_f32 v217, s34, v17
    v_fmac_f32 v218, s34, v18
    v_fmac_f32 v219, s34, v19
    v_fmac_f32 v220, s34, v20
    v_fmac_f32 v221, s34, v21
    v_fmac_f32 v222, s34, v22
    v_fmac_f32 v223, s34, v23
    v_fmac_f32 v224, s34, v24
    v_fmac_f32 v225, s34, v25
    v_fmac_f32 v226, s34, v26
    v_fmac_f32 v227, s34, v27
    v_fmac_f32 v228, s34, v28
    v_fmac_f32 v229, s34, v29
    v_fmac_f32 v230, s34, v30
    v_fmac_f32 v231, s34, v31
    v_fmac_f32 v232, s34, v32
    v_fmac_f32 v233, s34, v33
    v_fmac_f32 v234, s34, v34
    v_fmac_f32 v235, s34, v35
    v_fmac_f32 v236, s34, v36
    v_fmac_f32 v237, s34, v37
    v_fmac_f32 v238, s34, v38
    v_fmac_f32 v239, s34, v39
    v_fmac_f32 v240, s34, v40
    v_fmac_f32 v241, s34, v41
    v_fmac_f32 v242, s34, v42
    v_fmac_f32 v243, s34, v43
    v_fmac_f32 v244, s34, v44
    v_fmac_f32 v245, s34, v45
    v_fmac_f32 v246, s34, v46
    v_fmac_f32 v247, s34, v47
    v_cvt_pk_bf16_f32 v144, v216, v217
    v_cvt_pk_bf16_f32 v145, v218, v219
    ds_write_b64 v14, v[144:145] offset:16640
    v_cvt_pk_bf16_f32 v146, v220, v221
    v_cvt_pk_bf16_f32 v147, v222, v223
    ds_write_b64 v14, v[146:147] offset:17152
    v_cvt_pk_bf16_f32 v148, v224, v225
    v_cvt_pk_bf16_f32 v149, v226, v227
    ds_write_b64 v14, v[148:149] offset:17664
    v_cvt_pk_bf16_f32 v150, v228, v229
    v_cvt_pk_bf16_f32 v151, v230, v231
    ds_write_b64 v14, v[150:151] offset:18176
    v_cvt_pk_bf16_f32 v152, v232, v233
    v_cvt_pk_bf16_f32 v153, v234, v235
    ds_write_b64 v14, v[152:153] offset:18688
    v_cvt_pk_bf16_f32 v154, v236, v237
    v_cvt_pk_bf16_f32 v155, v238, v239
    ds_write_b64 v14, v[154:155] offset:19200
    v_cvt_pk_bf16_f32 v156, v240, v241
    v_cvt_pk_bf16_f32 v157, v242, v243
    ds_write_b64 v14, v[156:157] offset:19712
    v_cvt_pk_bf16_f32 v158, v244, v245
    v_cvt_pk_bf16_f32 v159, v246, v247
    ds_write_b64 v14, v[158:159] offset:20224
    ds_read_b128 v[160:163], v15 offset:16640
    ds_read_b128 v[164:167], v15 offset:17664
    ds_read_b128 v[168:171], v15 offset:18688
    ds_read_b128 v[172:175], v15 offset:19712
    s_waitcnt lgkmcnt(0)
    v_min_u32 v160, -2, v160
    buffer_store_dwordx4 v[160:163], v5, s[52:55], s36 offen offset:0 sc1
    v_min_u32 v164, -2, v164
    buffer_store_dwordx4 v[164:167], v5, s[52:55], s36 offen offset:1024 sc1
    v_min_u32 v168, -2, v168
    buffer_store_dwordx4 v[168:171], v5, s[52:55], s36 offen offset:2048 sc1
    v_min_u32 v172, -2, v172
    buffer_store_dwordx4 v[172:175], v5, s[52:55], s36 offen offset:3072 sc1
H_toF:
    v_bfe_u32 v14, v0, 2, 2
    v_mul_u32_u24 v251, 4160, v14
    v_and_b32 v14, 3, v0
    v_lshl_add_u32 v251, v14, 3, v251
    v_and_b32 v15, 48, v0
    v_sub_u32 v251, v251, v15
    v_and_b32 v253, 15, v0
    v_lshl_add_u32 v253, v253, 5, v15
    s_lshl_b32 s35, s8, 8
    s_add_u32 s31, s35, s71
    s_add_u32 s31, s31, 56
    v_add_u32 v251, s31, v251
    s_sub_u32 s31, s71, s35
    s_add_u32 s31, s31, 16928
    v_add_u32 v253, s31, v253
    s_waitcnt vmcnt(30) lgkmcnt(0)
    s_barrier
    buffer_store_dwordx2 v[198:199], v252, s[52:55], s78 offen offset:64 sc1
    ds_read_b128 v[80:83], v253 offset:192
    ds_read_b64_tr_b16 v[16:17], v251 offset:8
    ds_read_b64_tr_b16 v[18:19], v251 offset:0
    ds_read_b128 v[84:87], v253 offset:704
    ds_read_b64_tr_b16 v[20:21], v251 offset:520
    ds_read_b64_tr_b16 v[22:23], v251 offset:512
    ds_read_b128 v[88:91], v253 offset:1216
    ds_read_b64_tr_b16 v[24:25], v251 offset:1032
    ds_read_b64_tr_b16 v[26:27], v251 offset:1024
    ds_read_b128 v[92:95], v253 offset:1728
    ds_read_b64_tr_b16 v[28:29], v251 offset:1544
    ds_read_b64_tr_b16 v[30:31], v251 offset:1536
    s_waitcnt lgkmcnt(2)
    ds_read_b128 v[96:99], v253 offset:2240
    ds_read_b64_tr_b16 v[32:33], v251 offset:2056
    ds_read_b64_tr_b16 v[34:35], v251 offset:2048
    ds_read_b128 v[100:103], v253 offset:2752
    ds_read_b64_tr_b16 v[36:37], v251 offset:2568
    ds_read_b64_tr_b16 v[38:39], v251 offset:2560
    ds_read_b128 v[104:107], v253 offset:3264
    ds_read_b64_tr_b16 v[40:41], v251 offset:3080
    ds_read_b64_tr_b16 v[42:43], v251 offset:3072
    ds_read_b128 v[108:111], v253 offset:3776
    ds_read_b64_tr_b16 v[44:45], v251 offset:3592
    ds_read_b64_tr_b16 v[46:47], v251 offset:3584
    s_waitcnt lgkmcnt(0)
    v_mfma_f32_16x16x32_bf16 v[216:219], v[16:19], v[80:83], 0
    ds_read_b128 v[112:115], v253 offset:128
    v_mfma_f32_16x16x32_bf16 v[220:223], v[16:19], v[84:87], 0
    v_mfma_f32_16x16x32_bf16 v[224:227], v[16:19], v[88:91], 0
    ds_read_b64_tr_b16 v[48:49], v251 offset:72
    v_mfma_f32_16x16x32_bf16 v[228:231], v[16:19], v[92:95], 0
    buffer_load_dwordx4 a[200:203], v5, s[52:55], s89 offen offset:2048 sc1
    v_mfma_f32_16x16x32_bf16 v[232:235], v[16:19], v[96:99], 0
    ds_read_b64_tr_b16 v[50:51], v251 offset:64
    v_mfma_f32_16x16x32_bf16 v[236:239], v[16:19], v[100:103], 0
    ds_read_b128 v[116:119], v253 offset:640
    v_mfma_f32_16x16x32_bf16 v[240:243], v[16:19], v[104:107], 0
    ds_read_b64_tr_b16 v[52:53], v251 offset:584
    v_mfma_f32_16x16x32_bf16 v[244:247], v[16:19], v[108:111], 0
    ds_read_b64_tr_b16 v[54:55], v251 offset:576
    v_mfma_f32_16x16x32_bf16 v[220:223], v[20:23], v[80:83], v[220:223]
    buffer_load_dwordx4 a[204:207], v5, s[52:55], s89 offen offset:3072 sc1
    s_add_u32 s89, s89, 4096
    v_mfma_f32_16x16x32_bf16 v[224:227], v[20:23], v[84:87], v[224:227]
    ds_read_b128 v[120:123], v253 offset:1152
    v_mfma_f32_16x16x32_bf16 v[228:231], v[20:23], v[88:91], v[228:231]
    ds_read_b64_tr_b16 v[56:57], v251 offset:1096
    v_mfma_f32_16x16x32_bf16 v[232:235], v[20:23], v[92:95], v[232:235]
    ds_read_b64_tr_b16 v[58:59], v251 offset:1088
    v_mfma_f32_16x16x32_bf16 v[236:239], v[20:23], v[96:99], v[236:239]
    ds_read_b128 v[124:127], v253 offset:1664
    v_mfma_f32_16x16x32_bf16 v[240:243], v[20:23], v[100:103], v[240:243]
    buffer_load_dwordx4 a[208:211], v5, s[52:55], s89 offen offset:0 sc1
    v_mfma_f32_16x16x32_bf16 v[244:247], v[20:23], v[104:107], v[244:247]
    ds_read_b64_tr_b16 v[60:61], v251 offset:1608
    v_mfma_f32_16x16x32_bf16 v[224:227], v[24:27], v[80:83], v[224:227]
    ds_read_b64_tr_b16 v[62:63], v251 offset:1600
    v_mfma_f32_16x16x32_bf16 v[228:231], v[24:27], v[84:87], v[228:231]
    ds_read_b128 v[128:131], v253 offset:2176
    v_mfma_f32_16x16x32_bf16 v[232:235], v[24:27], v[88:91], v[232:235]
    v_mfma_f32_16x16x32_bf16 v[236:239], v[24:27], v[92:95], v[236:239]
    ds_read_b64_tr_b16 v[64:65], v251 offset:2120
    v_mfma_f32_16x16x32_bf16 v[240:243], v[24:27], v[96:99], v[240:243]
    buffer_load_dwordx4 a[212:215], v5, s[52:55], s89 offen offset:1024 sc1
    v_mfma_f32_16x16x32_bf16 v[244:247], v[24:27], v[100:103], v[244:247]
    ds_read_b64_tr_b16 v[66:67], v251 offset:2112
    v_mfma_f32_16x16x32_bf16 v[228:231], v[28:31], v[80:83], v[228:231]
    ds_read_b128 v[132:135], v253 offset:2688
    v_mfma_f32_16x16x32_bf16 v[232:235], v[28:31], v[84:87], v[232:235]
    ds_read_b64_tr_b16 v[68:69], v251 offset:2632
    v_mfma_f32_16x16x32_bf16 v[236:239], v[28:31], v[88:91], v[236:239]
    ds_read_b64_tr_b16 v[70:71], v251 offset:2624
    v_mfma_f32_16x16x32_bf16 v[240:243], v[28:31], v[92:95], v[240:243]
    buffer_load_dwordx4 a[216:219], v5, s[52:55], s89 offen offset:2048 sc1
    v_mfma_f32_16x16x32_bf16 v[244:247], v[28:31], v[96:99], v[244:247]
    ds_read_b128 v[136:139], v253 offset:3200
    v_mfma_f32_16x16x32_bf16 v[232:235], v[32:35], v[80:83], v[232:235]
    ds_read_b64_tr_b16 v[72:73], v251 offset:3144
    v_mfma_f32_16x16x32_bf16 v[236:239], v[32:35], v[84:87], v[236:239]
    ds_read_b64_tr_b16 v[74:75], v251 offset:3136
    v_mfma_f32_16x16x32_bf16 v[240:243], v[32:35], v[88:91], v[240:243]
    ds_read_b128 v[140:143], v253 offset:3712
    v_mfma_f32_16x16x32_bf16 v[244:247], v[32:35], v[92:95], v[244:247]
    buffer_load_dwordx4 a[220:223], v5, s[52:55], s89 offen offset:3072 sc1
    s_add_u32 s89, s89, 4096
    v_mfma_f32_16x16x32_bf16 v[236:239], v[36:39], v[80:83], v[236:239]
    ds_read_b64_tr_b16 v[76:77], v251 offset:3656
    v_mfma_f32_16x16x32_bf16 v[240:243], v[36:39], v[84:87], v[240:243]
    ds_read_b64_tr_b16 v[78:79], v251 offset:3648
    v_mfma_f32_16x16x32_bf16 v[244:247], v[36:39], v[88:91], v[244:247]
    v_mfma_f32_16x16x32_bf16 v[240:243], v[40:43], v[80:83], v[240:243]
    v_mfma_f32_16x16x32_bf16 v[244:247], v[40:43], v[84:87], v[244:247]
    v_mfma_f32_16x16x32_bf16 v[244:247], v[44:47], v[80:83], v[244:247]
    s_waitcnt lgkmcnt(0)
    v_mfma_f32_16x16x32_bf16 v[216:219], v[48:51], v[112:115], v[216:219]
    ds_read_b128 v[80:83], v253 offset:64
    v_mfma_f32_16x16x32_bf16 v[220:223], v[48:51], v[116:119], v[220:223]
    v_mfma_f32_16x16x32_bf16 v[224:227], v[48:51], v[120:123], v[224:227]
    ds_read_b64_tr_b16 v[16:17], v251 offset:136
    v_mfma_f32_16x16x32_bf16 v[228:231], v[48:51], v[124:127], v[228:231]
    ds_read_b64_tr_b16 v[18:19], v251 offset:128
    v_mfma_f32_16x16x32_bf16 v[232:235], v[48:51], v[128:131], v[232:235]
    buffer_load_dwordx4 a[224:227], v5, s[52:55], s89 offen offset:0 sc1
    v_mfma_f32_16x16x32_bf16 v[236:239], v[48:51], v[132:135], v[236:239]
    ds_read_b128 v[84:87], v253 offset:576
    v_mfma_f32_16x16x32_bf16 v[240:243], v[48:51], v[136:139], v[240:243]
    ds_read_b64_tr_b16 v[20:21], v251 offset:648
    v_mfma_f32_16x16x32_bf16 v[244:247], v[48:51], v[140:143], v[244:247]
    ds_read_b64_tr_b16 v[22:23], v251 offset:640
    v_mfma_f32_16x16x32_bf16 v[220:223], v[52:55], v[112:115], v[220:223]
    ds_read_b128 v[88:91], v253 offset:1088
    v_mfma_f32_16x16x32_bf16 v[224:227], v[52:55], v[116:119], v[224:227]
    ds_read_b64_tr_b16 v[24:25], v251 offset:1160
    v_mfma_f32_16x16x32_bf16 v[228:231], v[52:55], v[120:123], v[228:231]
    buffer_load_dwordx4 a[228:231], v5, s[52:55], s89 offen offset:1024 sc1
    v_mfma_f32_16x16x32_bf16 v[232:235], v[52:55], v[124:127], v[232:235]
    v_mfma_f32_16x16x32_bf16 v[236:239], v[52:55], v[128:131], v[236:239]
    ds_read_b64_tr_b16 v[26:27], v251 offset:1152
    v_mfma_f32_16x16x32_bf16 v[240:243], v[52:55], v[132:135], v[240:243]
    ds_read_b128 v[92:95], v253 offset:1600
    v_mfma_f32_16x16x32_bf16 v[244:247], v[52:55], v[136:139], v[244:247]
    ds_read_b64_tr_b16 v[28:29], v251 offset:1672
    v_mfma_f32_16x16x32_bf16 v[224:227], v[56:59], v[112:115], v[224:227]
    ds_read_b64_tr_b16 v[30:31], v251 offset:1664
    v_mfma_f32_16x16x32_bf16 v[228:231], v[56:59], v[116:119], v[228:231]
    buffer_load_dwordx4 a[232:235], v5, s[52:55], s89 offen offset:2048 sc1
    v_mfma_f32_16x16x32_bf16 v[232:235], v[56:59], v[120:123], v[232:235]
    ds_read_b128 v[96:99], v253 offset:2112
    v_mfma_f32_16x16x32_bf16 v[236:239], v[56:59], v[124:127], v[236:239]
    ds_read_b64_tr_b16 v[32:33], v251 offset:2184
    v_mfma_f32_16x16x32_bf16 v[240:243], v[56:59], v[128:131], v[240:243]
    ds_read_b64_tr_b16 v[34:35], v251 offset:2176
    v_mfma_f32_16x16x32_bf16 v[244:247], v[56:59], v[132:135], v[244:247]
    ds_read_b128 v[100:103], v253 offset:2624
    v_mfma_f32_16x16x32_bf16 v[228:231], v[60:63], v[112:115], v[228:231]
    ds_read_b64_tr_b16 v[36:37], v251 offset:2696
    v_mfma_f32_16x16x32_bf16 v[232:235], v[60:63], v[116:119], v[232:235]
    v_mfma_f32_16x16x32_bf16 v[236:239], v[60:63], v[120:123], v[236:239]
    buffer_load_dwordx4 a[236:239], v5, s[52:55], s89 offen offset:3072 sc1
    s_add_u32 s89, s89, 4096
    s_mul_i32 s31, s93, 30720
    s_add_u32 s89, s89, s31
    v_mfma_f32_16x16x32_bf16 v[240:243], v[60:63], v[124:127], v[240:243]
    ds_read_b64_tr_b16 v[38:39], v251 offset:2688
    v_mfma_f32_16x16x32_bf16 v[244:247], v[60:63], v[128:131], v[244:247]
    ds_read_b128 v[104:107], v253 offset:3136
    v_mfma_f32_16x16x32_bf16 v[232:235], v[64:67], v[112:115], v[232:235]
    ds_read_b64_tr_b16 v[40:41], v251 offset:3208
    v_mfma_f32_16x16x32_bf16 v[236:239], v[64:67], v[116:119], v[236:239]
    ds_read_b64_tr_b16 v[42:43], v251 offset:3200
    v_mfma_f32_16x16x32_bf16 v[240:243], v[64:67], v[120:123], v[240:243]
    ds_read_b128 v[108:111], v253 offset:3648
    v_mfma_f32_16x16x32_bf16 v[244:247], v[64:67], v[124:127], v[244:247]
    buffer_load_dwordx4 v[176:179], v5, s[52:55], s89 offen offset:0 sc1
    v_mfma_f32_16x16x32_bf16 v[236:239], v[68:71], v[112:115], v[236:239]
    ds_read_b64_tr_b16 v[44:45], v251 offset:3720
    v_mfma_f32_16x16x32_bf16 v[240:243], v[68:71], v[116:119], v[240:243]
    ds_read_b64_tr_b16 v[46:47], v251 offset:3712
    v_mfma_f32_16x16x32_bf16 v[244:247], v[68:71], v[120:123], v[244:247]
    v_mfma_f32_16x16x32_bf16 v[240:243], v[72:75], v[112:115], v[240:243]
    v_mfma_f32_16x16x32_bf16 v[244:247], v[72:75], v[116:119], v[244:247]
    v_mfma_f32_16x16x32_bf16 v[244:247], v[76:79], v[112:115], v[244:247]
    s_waitcnt lgkmcnt(0)
    v_mfma_f32_16x16x32_bf16 v[216:219], v[16:19], v[80:83], v[216:219]
    ds_read_b128 v[112:115], v253 offset:0
    v_mfma_f32_16x16x32_bf16 v[220:223], v[16:19], v[84:87], v[220:223]
    v_mfma_f32_16x16x32_bf16 v[224:227], v[16:19], v[88:91], v[224:227]
    ds_read_b64_tr_b16 v[48:49], v251 offset:200
    v_mfma_f32_16x16x32_bf16 v[228:231], v[16:19], v[92:95], v[228:231]
    ds_read_b64_tr_b16 v[50:51], v251 offset:192
    v_mfma_f32_16x16x32_bf16 v[232:235], v[16:19], v[96:99], v[232:235]
    buffer_load_dwordx4 v[180:183], v5, s[52:55], s89 offen offset:1024 sc1
    v_mfma_f32_16x16x32_bf16 v[236:239], v[16:19], v[100:103], v[236:239]
    ds_read_b128 v[116:119], v253 offset:512
    v_mfma_f32_16x16x32_bf16 v[240:243], v[16:19], v[104:107], v[240:243]
    ds_read_b64_tr_b16 v[52:53], v251 offset:712
    v_mfma_f32_16x16x32_bf16 v[244:247], v[16:19], v[108:111], v[244:247]
    ds_read_b64_tr_b16 v[54:55], v251 offset:704
    v_mfma_f32_16x16x32_bf16 v[220:223], v[20:23], v[80:83], v[220:223]
    ds_read_b128 v[120:123], v253 offset:1024
    v_mfma_f32_16x16x32_bf16 v[224:227], v[20:23], v[84:87], v[224:227]
    ds_read_b64_tr_b16 v[56:57], v251 offset:1224
    v_mfma_f32_16x16x32_bf16 v[228:231], v[20:23], v[88:91], v[228:231]
    buffer_load_dwordx4 v[184:187], v5, s[52:55], s89 offen offset:2048 sc1
    v_mfma_f32_16x16x32_bf16 v[232:235], v[20:23], v[92:95], v[232:235]
    v_mfma_f32_16x16x32_bf16 v[236:239], v[20:23], v[96:99], v[236:239]
    ds_read_b64_tr_b16 v[58:59], v251 offset:1216
    v_mfma_f32_16x16x32_bf16 v[240:243], v[20:23], v[100:103], v[240:243]
    ds_read_b128 v[124:127], v253 offset:1536
    v_mfma_f32_16x16x32_bf16 v[244:247], v[20:23], v[104:107], v[244:247]
    ds_read_b64_tr_b16 v[60:61], v251 offset:1736
    v_mfma_f32_16x16x32_bf16 v[224:227], v[24:27], v[80:83], v[224:227]
    ds_read_b64_tr_b16 v[62:63], v251 offset:1728
    v_mfma_f32_16x16x32_bf16 v[228:231], v[24:27], v[84:87], v[228:231]
    buffer_load_dwordx4 v[188:191], v5, s[52:55], s89 offen offset:3072 sc1
    s_add_u32 s89, s89, 4096
    v_mfma_f32_16x16x32_bf16 v[232:235], v[24:27], v[88:91], v[232:235]
    ds_read_b128 v[128:131], v253 offset:2048
    v_mfma_f32_16x16x32_bf16 v[236:239], v[24:27], v[92:95], v[236:239]
    ds_read_b64_tr_b16 v[64:65], v251 offset:2248
    v_mfma_f32_16x16x32_bf16 v[240:243], v[24:27], v[96:99], v[240:243]
    ds_read_b64_tr_b16 v[66:67], v251 offset:2240
    v_mfma_f32_16x16x32_bf16 v[244:247], v[24:27], v[100:103], v[244:247]
    ds_read_b128 v[132:135], v253 offset:2560
    v_mfma_f32_16x16x32_bf16 v[228:231], v[28:31], v[80:83], v[228:231]
    ds_read_b64_tr_b16 v[68:69], v251 offset:2760
    v_mfma_f32_16x16x32_bf16 v[232:235], v[28:31], v[84:87], v[232:235]
    v_mfma_f32_16x16x32_bf16 v[236:239], v[28:31], v[88:91], v[236:239]
    buffer_load_dwordx4 v[192:195], v5, s[52:55], s89 offen offset:0 sc1
    v_mfma_f32_16x16x32_bf16 v[240:243], v[28:31], v[92:95], v[240:243]
    ds_read_b64_tr_b16 v[70:71], v251 offset:2752
    v_mfma_f32_16x16x32_bf16 v[244:247], v[28:31], v[96:99], v[244:247]
    ds_read_b128 v[136:139], v253 offset:3072
    v_mfma_f32_16x16x32_bf16 v[232:235], v[32:35], v[80:83], v[232:235]
    ds_read_b64_tr_b16 v[72:73], v251 offset:3272
    v_mfma_f32_16x16x32_bf16 v[236:239], v[32:35], v[84:87], v[236:239]
    ds_read_b64_tr_b16 v[74:75], v251 offset:3264
    v_mfma_f32_16x16x32_bf16 v[240:243], v[32:35], v[88:91], v[240:243]
    ds_read_b128 v[140:143], v253 offset:3584
    v_mfma_f32_16x16x32_bf16 v[244:247], v[32:35], v[92:95], v[244:247]
    buffer_load_dwordx4 v[196:199], v5, s[80:83], s89 offen offset:1024 sc1
    v_mfma_f32_16x16x32_bf16 v[236:239], v[36:39], v[80:83], v[236:239]
    ds_read_b64_tr_b16 v[76:77], v251 offset:3784
    v_mfma_f32_16x16x32_bf16 v[240:243], v[36:39], v[84:87], v[240:243]
    ds_read_b64_tr_b16 v[78:79], v251 offset:3776
    v_mfma_f32_16x16x32_bf16 v[244:247], v[36:39], v[88:91], v[244:247]
    v_mfma_f32_16x16x32_bf16 v[240:243], v[40:43], v[80:83], v[240:243]
    v_mfma_f32_16x16x32_bf16 v[244:247], v[40:43], v[84:87], v[244:247]
    v_mfma_f32_16x16x32_bf16 v[244:247], v[44:47], v[80:83], v[244:247]
    s_waitcnt lgkmcnt(0)
    v_mfma_f32_16x16x32_bf16 v[216:219], v[48:51], v[112:115], v[216:219]
    buffer_load_dwordx4 v[200:203], v5, s[80:83], s89 offen offset:2048 sc1
    v_mfma_f32_16x16x32_bf16 v[220:223], v[48:51], v[116:119], v[220:223]
    buffer_load_dwordx4 v[204:207], v5, s[80:83], s89 offen offset:3072 sc1
    s_add_u32 s89, s89, 4096
    v_mfma_f32_16x16x32_bf16 v[224:227], v[48:51], v[120:123], v[224:227]
    buffer_load_dwordx4 v[208:211], v5, s[80:83], s89 offen offset:0 sc1
    v_mfma_f32_16x16x32_bf16 v[228:231], v[48:51], v[124:127], v[228:231]
    buffer_load_dwordx4 v[212:215], v5, s[80:83], s89 offen offset:1024 sc1
    v_mfma_f32_16x16x32_bf16 v[232:235], v[48:51], v[128:131], v[232:235]
    buffer_load_dwordx2 v[174:175], v250, s[52:55], 0 offen sc1
    v_mfma_f32_16x16x32_bf16 v[236:239], v[48:51], v[132:135], v[236:239]
    s_lshl_b32 s31, s30, 12
    s_add_u32 s31, s31, 81920
    v_mfma_f32_16x16x32_bf16 v[240:243], v[48:51], v[136:139], v[240:243]
    v_add_u32 v254, s31, v5
    v_mfma_f32_16x16x32_bf16 v[244:247], v[48:51], v[140:143], v[244:247]
    v_lshrrev_b32 v14, 1, v0
    v_and_b32 v14, 24, v14
    v_mfma_f32_16x16x32_bf16 v[220:223], v[52:55], v[112:115], v[220:223]
    v_and_b32 v15, 15, v0
    v_lshl_add_u32 v14, v15, 5, v14
    v_mfma_f32_16x16x32_bf16 v[224:227], v[52:55], v[116:119], v[224:227]
    v_add_u32 v14, s1, v14
    v_add_u32 v15, s1, v5
    v_mfma_f32_16x16x32_bf16 v[228:231], v[52:55], v[120:123], v[228:231]
    ds_read_b64 v[16:17], v14 offset:32
    v_mfma_f32_16x16x32_bf16 v[232:235], v[52:55], v[124:127], v[232:235]
    ds_read_b64 v[18:19], v14 offset:544
    v_mfma_f32_16x16x32_bf16 v[236:239], v[52:55], v[128:131], v[236:239]
    ds_read_b64 v[20:21], v14 offset:1056
    v_mfma_f32_16x16x32_bf16 v[240:243], v[52:55], v[132:135], v[240:243]
    ds_read_b64 v[22:23], v14 offset:1568
    v_mfma_f32_16x16x32_bf16 v[244:247], v[52:55], v[136:139], v[244:247]
    s_and_b32 s31, s70, 1
    s_lshl_b32 s31, s31, 4
    v_mfma_f32_16x16x32_bf16 v[224:227], v[56:59], v[112:115], v[224:227]
    s_lshr_b32 s34, s50, s31
    s_lshl_b32 s34, s34, 16
    v_mfma_f32_16x16x32_bf16 v[228:231], v[56:59], v[116:119], v[228:231]
    v_mfma_f32_16x16x32_bf16 v[232:235], v[56:59], v[120:123], v[232:235]
    v_mfma_f32_16x16x32_bf16 v[236:239], v[56:59], v[124:127], v[236:239]
    s_waitcnt lgkmcnt(0)
    v_mfma_f32_16x16x32_bf16 v[240:243], v[56:59], v[128:131], v[240:243]
    v_lshlrev_b32 v24, 16, v16
    v_and_b32 v25, 0xffff0000, v16
    v_mfma_f32_16x16x32_bf16 v[244:247], v[56:59], v[132:135], v[244:247]
    v_lshlrev_b32 v26, 16, v17
    v_and_b32 v27, 0xffff0000, v17
    v_mfma_f32_16x16x32_bf16 v[228:231], v[60:63], v[112:115], v[228:231]
    v_lshlrev_b32 v28, 16, v18
    v_and_b32 v29, 0xffff0000, v18
    v_mfma_f32_16x16x32_bf16 v[232:235], v[60:63], v[116:119], v[232:235]
    v_lshlrev_b32 v30, 16, v19
    v_and_b32 v31, 0xffff0000, v19
    v_mfma_f32_16x16x32_bf16 v[236:239], v[60:63], v[120:123], v[236:239]
    v_lshlrev_b32 v32, 16, v20
    v_and_b32 v33, 0xffff0000, v20
    v_mfma_f32_16x16x32_bf16 v[240:243], v[60:63], v[124:127], v[240:243]
    v_lshlrev_b32 v34, 16, v21
    v_and_b32 v35, 0xffff0000, v21
    v_mfma_f32_16x16x32_bf16 v[244:247], v[60:63], v[128:131], v[244:247]
    v_lshlrev_b32 v36, 16, v22
    v_and_b32 v37, 0xffff0000, v22
    v_mfma_f32_16x16x32_bf16 v[232:235], v[64:67], v[112:115], v[232:235]
    v_lshlrev_b32 v38, 16, v23
    v_and_b32 v39, 0xffff0000, v23
    v_mfma_f32_16x16x32_bf16 v[236:239], v[64:67], v[116:119], v[236:239]
    v_mul_f32 v24, s34, v24
    v_mul_f32 v25, s34, v25
    v_mfma_f32_16x16x32_bf16 v[240:243], v[64:67], v[120:123], v[240:243]
    v_mul_f32 v26, s34, v26
    v_mul_f32 v27, s34, v27
    v_mfma_f32_16x16x32_bf16 v[244:247], v[64:67], v[124:127], v[244:247]
    v_mul_f32 v28, s34, v28
    v_mul_f32 v29, s34, v29
    v_mfma_f32_16x16x32_bf16 v[236:239], v[68:71], v[112:115], v[236:239]
    v_mul_f32 v30, s34, v30
    v_mul_f32 v31, s34, v31
    v_mfma_f32_16x16x32_bf16 v[240:243], v[68:71], v[116:119], v[240:243]
    v_mul_f32 v32, s34, v32
    v_mul_f32 v33, s34, v33
    v_mfma_f32_16x16x32_bf16 v[244:247], v[68:71], v[120:123], v[244:247]
    v_mul_f32 v34, s34, v34
    v_mul_f32 v35, s34, v35
    v_mfma_f32_16x16x32_bf16 v[240:243], v[72:75], v[112:115], v[240:243]
    v_mul_f32 v36, s34, v36
    v_mul_f32 v37, s34, v37
    v_mfma_f32_16x16x32_bf16 v[244:247], v[72:75], v[116:119], v[244:247]
    v_mul_f32 v38, s34, v38
    v_mul_f32 v39, s34, v39
    v_mfma_f32_16x16x32_bf16 v[244:247], v[76:79], v[112:115], v[244:247]
    s_branch C_e
nr_g:
    s_add_u32 s51, s51, 0x1000
    s_cmp_gt_u32 s51, 0x40000000
    s_cbranch_scc1 nk_g
    v_mov_b32 v15, 0
    buffer_load_dwordx2 v[198:199], v15, s[56:59], 0 offen sc1
    s_waitcnt vmcnt(0)
    s_branch nc_g
re_g:
    s_add_u32 s51, s51, 4097
    s_cmp_gt_u32 s51, 0x40000000
    s_cbranch_scc1 rx_g
    s_sleep 4
    buffer_load_dwordx2 v[196:197], v195, s[52:55], 0 offen sc1
    s_waitcnt vmcnt(0)
    v_cmp_ne_u64 vcc, s[16:17], v[196:197]
    s_nop 3
    s_cbranch_vccnz re_g
rx_g:
    s_branch ok_g
re_h:
    s_add_u32 s51, s51, 4352
    s_cmp_gt_u32 s51, 0x40000000
    s_cbranch_scc1 rx_h
    s_sleep 1
    buffer_load_dwordx2 v[174:175], v250, s[52:55], 0 offen sc1
    s_waitcnt vmcnt(0)
    v_cmp_ne_u64 vcc, s[16:17], v[174:175]
    s_nop 3
    s_cbranch_vccnz re_h
rx_h:
    s_branch ok_h
re_y:
    s_add_u32 s51, s51, 4096
    s_cmp_gt_u32 s51, 0x40000000
    s_cbranch_scc1 rx_y
    buffer_load_dwordx4 v[228:231], v12, s[52:55], s96 offen sc1
    buffer_load_dwordx4 v[232:235], v12, s[52:55], s97 offen sc1
    buffer_load_dwordx4 v[236:239], v13, s[52:55], s0 offen sc1
    s_waitcnt vmcnt(0)
    v_max3_u32 v246, v228, v232, v236
    v_cmp_eq_u32 vcc, -1, v246
    s_nop 3
    s_cbranch_vccnz re_y
rx_y:
    s_branch ok_y
nr_h:
    s_add_u32 s51, s51, 0x1000
    s_cmp_gt_u32 s51, 0x40000000
    s_cbranch_scc1 nk_h
    v_mov_b32 v15, 0
    buffer_load_dwordx2 v[198:199], v15, s[56:59], 0 offen sc1
    s_waitcnt vmcnt(0)
    s_branch nc_h
re_hu:
    s_add_u32 s51, s51, 4112
    s_cmp_gt_u32 s51, 0x40000000
    s_cbranch_scc1 rx_hu
    s_sleep 1
    buffer_load_dwordx2 v[248:249], v214, s[52:55], 0 offen sc1
    s_waitcnt vmcnt(0)
    v_cmp_ne_u64 vcc, s[16:17], v[248:249]
    s_nop 3
    s_cbranch_vccnz re_hu
rx_hu:
    s_branch ok_hu
re_hw2:
    s_add_u32 s51, s51, 4097
    s_cmp_gt_u32 s51, 0x40000000
    s_cbranch_scc1 rx_hw2
    s_sleep 8
    buffer_load_dwordx2 v[196:197], v195, s[52:55], 0 offen sc1
    s_waitcnt vmcnt(0)
    v_cmp_ne_u64 vcc, s[16:17], v[196:197]
    s_nop 3
    s_cbranch_vccnz re_hw2
rx_hw2:
    s_branch ok_hw2
re_hw:
    s_add_u32 s51, s51, 4097
    s_cmp_gt_u32 s51, 0x40000000
    s_cbranch_scc1 rx_hw
    s_sleep 4
    buffer_load_dwordx2 v[196:197], v195, s[52:55], 0 offen sc1
    s_waitcnt vmcnt(0)
    v_cmp_ne_u64 vcc, s[16:17], v[196:197]
    s_nop 3
    s_cbranch_vccnz re_hw
rx_hw:
    s_branch ok_hw
L_end:
    s_endpgm
L_codeend:
.section .rodata,"a"
.p2align 6
.amdhsa_kernel parallel_sum__ssm_conv_h3__swiglu_ffn__prompt_kernel
  .amdhsa_next_free_vgpr 512
  .amdhsa_next_free_sgpr 102
  .amdhsa_accum_offset 256
  .amdhsa_group_segment_fixed_size 0
  .amdhsa_kernarg_size 104
  .amdhsa_user_sgpr_count 2
  .amdhsa_user_sgpr_kernarg_segment_ptr 1
  .amdhsa_system_sgpr_workgroup_id_x 1
  .amdhsa_float_denorm_mode_32 3
.end_amdhsa_kernel
```
